```python
import torch

def _softmax(x, axis=-1):
    return torch.softmax(x, dim=axis)
def _gelu(x):
    return torch.nn.functional.gelu(x, approximate="tanh")
def _silu(x):
    return torch.nn.functional.silu(x)
def _sigmoid(x):
    return torch.sigmoid(x)
def _layernorm(x, axis=-1, eps=1e-5):
    m = x.mean(dim=axis, keepdim=True)
    v = x.var(dim=axis, keepdim=True, unbiased=False)
    return (x - m) / torch.sqrt(v + eps)
def _scatter_add(tgt, idx, src, axis=0):
    return tgt.clone().index_add_(axis, idx, src)
def _segment_sum(src, seg, n):
    out = torch.zeros((n,) + src.shape[1:], dtype=src.dtype)
    return out.index_add_(0, seg, src)
def _pad(x, pw):
    flat = tuple(v for pair in reversed(pw) for v in pair)
    return torch.nn.functional.pad(x, flat)

kernel_name = 'parallel_sum__ssm_conv_h3__mixer_s_mlp__prompt'

def setup_inputs():

    _w = (lambda a: (lambda t: t.to(torch.bfloat16) if t.is_floating_point() else t)(torch.as_tensor(a)))
    def _A_setup():
        B, S, D = 1, 2048, 640
        ks = 4
        return {
            "q": _w((lambda *s: torch.randn(*s, dtype=torch.bfloat16) * 0.05)(B, S, D)),
            "k": _w((lambda *s: torch.randn(*s, dtype=torch.bfloat16) * 0.8)(B, S, D)),
            "v": _w((lambda *s: torch.randn(*s, dtype=torch.bfloat16) * 0.8)(B, S, D)),
            "shift_k": _w((lambda *s: torch.randn(*s, dtype=torch.bfloat16) * 0.8)(D, ks) * 0.5),
            "ssm_k": _w((lambda *s: torch.randn(*s, dtype=torch.bfloat16) * 1.6)(D, S) * (1.0 / S ** 0.5)),
            "ssm_D": _w((lambda *s: torch.randn(*s, dtype=torch.bfloat16) * 0.8)(D)),
        }
    _A_in = _A_setup()

    def _B_setup():
        B, S, D, F = 1, 2048, 640, 1536
        return {
            "x":  _w((lambda *s: torch.randn(*s, dtype=torch.bfloat16) * 0.05)(B, S, D)),
            "w1": _w((lambda *s: torch.randn(*s, dtype=torch.bfloat16) * 3.2)(D, D) * (D ** -0.5)),
            "w2": _w((lambda *s: torch.randn(*s, dtype=torch.bfloat16) * 3.2)(D, D) * (D ** -0.5)),
            "w3": _w((lambda *s: torch.randn(*s, dtype=torch.bfloat16) * 3.2)(D, F) * (D ** -0.5)),
            "w4": _w((lambda *s: torch.randn(*s, dtype=torch.bfloat16) * 3.2)(F, D) * (F ** -0.5)),
        }
    _B_in = _B_setup()

    return {
        "A_q": _A_in["q"],
        "A_k": _A_in["k"],
        "A_v": _A_in["v"],
        "A_shift_k": _A_in["shift_k"],
        "A_ssm_k": _A_in["ssm_k"],
        "A_ssm_D": _A_in["ssm_D"],
        "B_x": _B_in["x"],
        "B_w1": _B_in["w1"],
        "B_w2": _B_in["w2"],
        "B_w3": _B_in["w3"],
        "B_w4": _B_in["w4"],
    }

def reference(A_q, A_k, A_v, A_shift_k, A_ssm_k, A_ssm_D, B_x, B_w1, B_w2, B_w3, B_w4):
    def _A_ref(q, k, v, shift_k, ssm_k, ssm_D):
        B, S, D = q.shape
        ks = shift_k.shape[-1]
        k_pad = _pad(k, ((0, 0), (ks - 1, 0), (0, 0)))
        k_shift = torch.zeros_like(k)
        for t in range(ks):
            k_shift = k_shift + k_pad[:, t:t + S, :] * shift_k[:, ks - 1 - t][None, None, :]
        kv = k_shift * v
        L = 2 * S
        kv_pad = _pad(kv, ((0, 0), (0, S), (0, 0)))
        kf_pad = _pad(ssm_k, ((0, 0), (0, S)))
        kv_f = (lambda x, axes=(-2,-1): torch.fft.rfft2(x.float(), dim=axes))(kv_pad[:, None, :, :], axes=(1, 2))
        kf_f = (lambda x, axes=(-2,-1): torch.fft.rfft2(x.float(), dim=axes))(kf_pad[:, None, :], axes=(1, 2))
        kf_f = (lambda x, *d: x.permute(*d))(kf_f, 1, 2, 0)
        y_f = kv_f * kf_f[None, :, :, :]
        y = (lambda x, s, axes=(-2,-1): torch.fft.irfft2(x, s=s, dim=axes).to(torch.bfloat16))(y_f, (1, L), axes=(1, 2))[:, 0, :S, :]
        y = y + kv * ssm_D[None, None, :]
        return q * y

    def _B_ref(x, w1, w2, w3, w4):
        B, S, D = x.shape
        h = _gelu(_layernorm(x, axis=-1) @ w1)
        c = D // 4
        g0 = _pad(h[:, :, 0*c:1*c], ((0, 0), (1, 0), (0, 0)))[:, :S, :]
        g1 = _pad(h[:, :, 1*c:2*c], ((0, 0), (0, 1), (0, 0)))[:, 1:, :]
        g2 = _pad(h[:, :, 2*c:3*c], ((0, 0), (2, 0), (0, 0)))[:, :S, :]
        g3 = _pad(h[:, :, 3*c:   ], ((0, 0), (0, 2), (0, 0)))[:, 2:, :]
        hs = torch.concatenate([g0, g1, g2, g3], axis=-1) @ w2
        x1 = x + hs
        h2 = _gelu(_layernorm(x1, axis=-1) @ w3) @ w4
        return x1 + h2

    x = A_q
    xn = _layernorm(x, axis=-1)
    return x + _A_ref(xn, A_k, A_v, A_shift_k, A_ssm_k, A_ssm_D) + _B_ref(xn, B_w1, B_w2, B_w3, B_w4)
```

```asm
; @launch grid=(256,1,1) block=(256,1,1) lds=163840
.amdgcn_target "amdgcn-amd-amdhsa--gfx950"
.text
.globl parallel_sum__ssm_conv_h3__mixer_s_mlp__prompt_kernel
.p2align 8
.type parallel_sum__ssm_conv_h3__mixer_s_mlp__prompt_kernel,@function
parallel_sum__ssm_conv_h3__mixer_s_mlp__prompt_kernel:
    s_cmp_ge_u32 s2, 256
    s_cbranch_scc1 L_end
    s_load_dwordx16 s[48:63], s[0:1], 0
    s_load_dwordx8 s[64:71], s[0:1], 64
    s_load_dwordx4 s[72:75], s[0:1], 96
    s_memrealtime s[40:41]
    s_lshr_b32 s23, s2, 3
    s_min_u32 s24, s23, 13
    s_lshl_b32 s24, s24, 3
    s_load_dwordx2 s[42:43], s[0:1], s24
    s_getpc_b64 s[26:27]
    v_lshlrev_b32 v3, 7, v0
    v_mov_b32 v5, s27
    v_add_co_u32 v4, vcc, s26, v3
    s_nop 1
    v_addc_co_u32 v5, vcc, 0, v5, vcc
    global_load_dword v250, v[4:5], off
    v_add_co_u32 v4, vcc, (L_end - parallel_sum__ssm_conv_h3__mixer_s_mlp__prompt_kernel - 32768 - 64), v4
    s_nop 1
    v_addc_co_u32 v5, vcc, 0, v5, vcc
    global_load_dword v251, v[4:5], off
    v_lshrrev_b32 v1, 6, v0
    s_nop 1
    v_readfirstlane_b32 s30, v1
    v_and_b32 v1, 63, v0
    v_lshlrev_b32 v2, 4, v1
    s_and_b32 s20, s2, 7
    s_lshr_b32 s23, s2, 3
    s_lshr_b32 s21, s23, 3
    s_lshl_b32 s24, s20, 2
    s_add_u32 s21, s21, s24
    s_and_b32 s22, s23, 7
    s_lshr_b32 s44, s23, 4
    s_lshl_b32 s24, s20, 1
    s_add_u32 s44, s44, s24
    s_and_b32 s45, s23, 15
    s_waitcnt lgkmcnt(0)
    s_mov_b32 s4, s74
    s_mov_b32 s5, s75
    s_mov_b32 s6, 0x2000000
    s_mov_b32 s7, 0x20000
    s_mov_b32 s16, s72
    s_mov_b32 s17, s73
    s_mov_b32 s18, 0x100
    s_mov_b32 s19, 0x20000
    s_mul_i32 s60, s2, 3
    s_add_u32 s60, s60, s30
    s_mul_i32 s61, s30, 13056
    s_add_u32 s61, s61, 122880
    s_cmp_eq_u32 s30, 3
    s_cselect_b32 s60, 640, s60
    s_or_b32 s20, s2, s30
    s_cmp_lg_u32 s20, 0
    s_cbranch_scc1 L_notag
    s_or_b32 s40, s40, 1
    v_mov_b32 v3, s40
    v_mov_b32 v4, 0
    s_mov_b64 exec, 1
    buffer_store_dword v3, v4, s[16:19], 0 offen sc1
    s_mov_b64 exec, -1
L_notag:
    s_mov_b32 s8, s48
    s_mov_b32 s9, s49
    s_mov_b32 s10, 0x280000
    s_mov_b32 s11, 0x20000
    v_lshrrev_b32 v3, 5, v0
    v_and_b32 v4, 31, v0
    v_mul_u32_u24 v3, 1280, v3
    v_lshl_add_u32 v3, v4, 3, v3
    s_lshl_b32 s20, s21, 3
    s_add_u32 s20, s20, s22
    s_mul_i32 s20, s20, 10240
    buffer_load_dwordx2 v[20:21], v3, s[8:11], s20 offen offset:0
    buffer_load_dwordx2 v[22:23], v3, s[8:11], s20 offen offset:256
    buffer_load_dwordx2 v[24:25], v3, s[8:11], s20 offen offset:512
    buffer_load_dwordx2 v[26:27], v3, s[8:11], s20 offen offset:768
    buffer_load_dwordx2 v[28:29], v3, s[8:11], s20 offen offset:1024
    s_lshl_b32 s20, s30, 8
    s_add_u32 s20, s20, s2
    s_cmp_ge_u32 s20, 200
    s_cbranch_scc1 W1_m1
    s_mov_b32 s8, s62
    s_mov_b32 s9, s63
    s_mov_b32 s10, 0xc8000
    s_mov_b32 s11, 0x20000
    s_sub_u32 s20, s20, 0
    s_movk_i32 s23, 1280
    s_movk_i32 s24, 10
    s_mov_b32 s25, 6554
    s_movk_i32 s26, 5
    s_mov_b32 s27, 13108
    s_movk_i32 s28, 20
    s_mov_b32 s29, 16777216
    s_branch W1_go
W1_m1:
    s_cmp_ge_u32 s20, 400
    s_cbranch_scc1 W1_m2
    s_mov_b32 s8, s64
    s_mov_b32 s9, s65
    s_mov_b32 s10, 0xc8000
    s_mov_b32 s11, 0x20000
    s_sub_u32 s20, s20, 200
    s_movk_i32 s23, 1280
    s_movk_i32 s24, 10
    s_mov_b32 s25, 6554
    s_movk_i32 s26, 5
    s_mov_b32 s27, 13108
    s_movk_i32 s28, 20
    s_mov_b32 s29, 17825792
    s_branch W1_go
W1_m2:
    s_cmp_ge_u32 s20, 880
    s_cbranch_scc1 W1_m3
    s_mov_b32 s8, s66
    s_mov_b32 s9, s67
    s_mov_b32 s10, 0x1e0000
    s_mov_b32 s11, 0x20000
    s_sub_u32 s20, s20, 400
    s_movk_i32 s23, 3072
    s_movk_i32 s24, 24
    s_mov_b32 s25, 2731
    s_movk_i32 s26, 6
    s_mov_b32 s27, 10923
    s_movk_i32 s28, 20
    s_mov_b32 s29, 18874368
    s_branch W1_go
W1_m3:
    s_mov_b32 s8, s68
    s_mov_b32 s9, s69
    s_mov_b32 s10, 0x1e0000
    s_mov_b32 s11, 0x20000
    s_sub_u32 s20, s20, 880
    s_movk_i32 s23, 1280
    s_movk_i32 s24, 10
    s_mov_b32 s25, 6554
    s_movk_i32 s26, 5
    s_mov_b32 s27, 13108
    s_movk_i32 s28, 48
    s_mov_b32 s29, 20971520
W1_go:
    s_mul_i32 s40, s20, s25
    s_lshr_b32 s40, s40, 16
    s_mul_i32 s41, s40, s24
    s_sub_u32 s41, s20, s41
    v_lshrrev_b32 v3, 3, v1
    v_and_b32 v4, 7, v1
    v_mul_lo_u32 v3, v3, s23
    v_lshl_add_u32 v3, v4, 4, v3
    s_mul_i32 s42, s40, s23
    s_lshl_b32 s42, s42, 5
    s_lshl_b32 s43, s41, 7
    s_add_u32 s42, s42, s43
    s_lshl_b32 s43, s23, 3
    s_lshl_b32 s20, s30, 13
    s_add_u32 m0, s20, 0
    s_nop 0
    buffer_load_dwordx4 v3, s[8:11], s42 offen lds
    s_add_u32 s42, s42, s43
    s_add_u32 m0, s20, 1024
    s_nop 0
    buffer_load_dwordx4 v3, s[8:11], s42 offen lds
    s_add_u32 s42, s42, s43
    s_add_u32 m0, s20, 2048
    s_nop 0
    buffer_load_dwordx4 v3, s[8:11], s42 offen lds
    s_add_u32 s42, s42, s43
    s_add_u32 m0, s20, 3072
    s_nop 0
    buffer_load_dwordx4 v3, s[8:11], s42 offen lds
    s_add_u32 s42, s42, s43
    s_lshl_b32 s42, s41, 2
    s_add_u32 s42, s42, 0
    s_mul_i32 s43, s42, s27
    s_lshr_b32 s43, s43, 16
    s_mul_i32 s20, s43, s26
    s_sub_u32 s20, s42, s20
    s_mul_i32 s43, s43, s28
    s_add_u32 s43, s43, s40
    s_mul_i32 s43, s43, s26
    s_add_u32 s43, s43, s20
    s_lshl_b32 s43, s43, 10
    s_add_u32 s32, s43, s29
    s_lshl_b32 s42, s41, 2
    s_add_u32 s42, s42, 1
    s_mul_i32 s43, s42, s27
    s_lshr_b32 s43, s43, 16
    s_mul_i32 s20, s43, s26
    s_sub_u32 s20, s42, s20
    s_mul_i32 s43, s43, s28
    s_add_u32 s43, s43, s40
    s_mul_i32 s43, s43, s26
    s_add_u32 s43, s43, s20
    s_lshl_b32 s43, s43, 10
    s_add_u32 s33, s43, s29
    s_lshl_b32 s42, s41, 2
    s_add_u32 s42, s42, 2
    s_mul_i32 s43, s42, s27
    s_lshr_b32 s43, s43, 16
    s_mul_i32 s20, s43, s26
    s_sub_u32 s20, s42, s20
    s_mul_i32 s43, s43, s28
    s_add_u32 s43, s43, s40
    s_mul_i32 s43, s43, s26
    s_add_u32 s43, s43, s20
    s_lshl_b32 s43, s43, 10
    s_add_u32 s34, s43, s29
    s_lshl_b32 s42, s41, 2
    s_add_u32 s42, s42, 3
    s_mul_i32 s43, s42, s27
    s_lshr_b32 s43, s43, 16
    s_mul_i32 s20, s43, s26
    s_sub_u32 s20, s42, s20
    s_mul_i32 s43, s43, s28
    s_add_u32 s43, s43, s40
    s_mul_i32 s43, s43, s26
    s_add_u32 s43, s43, s20
    s_lshl_b32 s43, s43, 10
    s_add_u32 s35, s43, s29
    s_waitcnt vmcnt(4)
    v_lshlrev_b32 v32, 16, v20
    v_and_b32 v33, 0xffff0000, v20
    v_lshlrev_b32 v34, 16, v21
    v_and_b32 v35, 0xffff0000, v21
    v_lshlrev_b32 v36, 16, v22
    v_and_b32 v37, 0xffff0000, v22
    v_lshlrev_b32 v38, 16, v23
    v_and_b32 v39, 0xffff0000, v23
    v_lshlrev_b32 v40, 16, v24
    v_and_b32 v41, 0xffff0000, v24
    v_lshlrev_b32 v42, 16, v25
    v_and_b32 v43, 0xffff0000, v25
    v_lshlrev_b32 v44, 16, v26
    v_and_b32 v45, 0xffff0000, v26
    v_lshlrev_b32 v46, 16, v27
    v_and_b32 v47, 0xffff0000, v27
    v_lshlrev_b32 v48, 16, v28
    v_and_b32 v49, 0xffff0000, v28
    v_lshlrev_b32 v50, 16, v29
    v_and_b32 v51, 0xffff0000, v29
    v_bfe_u32 v3, v0, 3, 2
    v_and_b32 v4, 3, v0
    v_lshlrev_b32 v3, 9, v3
    v_lshl_add_u32 v3, v4, 7, v3
    v_lshrrev_b32 v4, 5, v0
    v_lshl_add_u32 v3, v4, 4, v3
    v_bfe_u32 v4, v0, 2, 1
    v_lshl_add_u32 v3, v4, 3, v3
    v_add_f32 v6, v32, v33
    v_add_f32 v8, v34, v35
    v_add_f32 v6, v6, v36
    v_add_f32 v8, v8, v37
    v_add_f32 v6, v6, v38
    v_add_f32 v8, v8, v39
    v_add_f32 v6, v6, v40
    v_add_f32 v8, v8, v41
    v_add_f32 v6, v6, v42
    v_add_f32 v8, v8, v43
    v_add_f32 v6, v6, v44
    v_add_f32 v8, v8, v45
    v_add_f32 v6, v6, v46
    v_add_f32 v8, v8, v47
    v_add_f32 v6, v6, v48
    v_add_f32 v8, v8, v49
    v_add_f32 v6, v6, v50
    v_add_f32 v8, v8, v51
    v_add_f32 v6, v6, v8
    s_nop 1
    v_add_f32_dpp v6, v6, v6 row_ror:8 row_mask:0xf bank_mask:0xf
    s_nop 1
    v_add_f32_dpp v6, v6, v6 row_ror:4 row_mask:0xf bank_mask:0xf
    s_nop 1
    v_add_f32_dpp v6, v6, v6 row_ror:2 row_mask:0xf bank_mask:0xf
    s_nop 1
    v_add_f32_dpp v6, v6, v6 row_ror:1 row_mask:0xf bank_mask:0xf
    ds_swizzle_b32 v8, v6 offset:0x401F
    s_waitcnt lgkmcnt(0)
    v_add_f32 v6, v6, v8
    v_mul_f32 v6, 0x3acccccd, v6
    v_sub_f32 v52, v32, v6
    v_sub_f32 v53, v33, v6
    v_sub_f32 v54, v34, v6
    v_sub_f32 v55, v35, v6
    v_sub_f32 v56, v36, v6
    v_sub_f32 v57, v37, v6
    v_sub_f32 v58, v38, v6
    v_sub_f32 v59, v39, v6
    v_sub_f32 v60, v40, v6
    v_sub_f32 v61, v41, v6
    v_sub_f32 v62, v42, v6
    v_sub_f32 v63, v43, v6
    v_sub_f32 v64, v44, v6
    v_sub_f32 v65, v45, v6
    v_sub_f32 v66, v46, v6
    v_sub_f32 v67, v47, v6
    v_sub_f32 v68, v48, v6
    v_sub_f32 v69, v49, v6
    v_sub_f32 v70, v50, v6
    v_sub_f32 v71, v51, v6
    v_mul_f32 v8, v52, v52
    v_mul_f32 v9, v53, v53
    v_fmac_f32 v8, v54, v54
    v_fmac_f32 v9, v55, v55
    v_fmac_f32 v8, v56, v56
    v_fmac_f32 v9, v57, v57
    v_fmac_f32 v8, v58, v58
    v_fmac_f32 v9, v59, v59
    v_fmac_f32 v8, v60, v60
    v_fmac_f32 v9, v61, v61
    v_fmac_f32 v8, v62, v62
    v_fmac_f32 v9, v63, v63
    v_fmac_f32 v8, v64, v64
    v_fmac_f32 v9, v65, v65
    v_fmac_f32 v8, v66, v66
    v_fmac_f32 v9, v67, v67
    v_fmac_f32 v8, v68, v68
    v_fmac_f32 v9, v69, v69
    v_fmac_f32 v8, v70, v70
    v_fmac_f32 v9, v71, v71
    v_add_f32 v8, v8, v9
    s_nop 1
    v_add_f32_dpp v8, v8, v8 row_ror:8 row_mask:0xf bank_mask:0xf
    s_nop 1
    v_add_f32_dpp v8, v8, v8 row_ror:4 row_mask:0xf bank_mask:0xf
    s_nop 1
    v_add_f32_dpp v8, v8, v8 row_ror:2 row_mask:0xf bank_mask:0xf
    s_nop 1
    v_add_f32_dpp v8, v8, v8 row_ror:1 row_mask:0xf bank_mask:0xf
    ds_swizzle_b32 v9, v8 offset:0x401F
    s_waitcnt lgkmcnt(0)
    v_add_f32 v8, v8, v9
    v_mul_f32 v8, 0x3acccccd, v8
    v_cvt_pk_bf16_f32 v6, v6, v6
    v_and_b32 v6, 0xffff0000, v6
    v_cvt_pk_bf16_f32 v8, v8, v8
    v_and_b32 v8, 0xffff0000, v8
    v_add_f32 v8, 0x3727c5ac, v8
    v_cvt_pk_bf16_f32 v8, v8, v8
    v_and_b32 v8, 0xffff0000, v8
    v_sqrt_f32 v8, v8
    s_nop 0
    v_cvt_pk_bf16_f32 v8, v8, v8
    v_and_b32 v8, 0xffff0000, v8
    v_rcp_f32 v8, v8
    v_sub_f32 v52, v32, v6
    v_sub_f32 v53, v33, v6
    v_cvt_pk_bf16_f32 v52, v52, v53
    v_and_b32 v53, 0xffff0000, v52
    v_lshlrev_b32 v52, 16, v52
    v_mul_f32 v52, v52, v8
    v_mul_f32 v53, v53, v8
    v_sub_f32 v54, v34, v6
    v_sub_f32 v55, v35, v6
    v_cvt_pk_bf16_f32 v54, v54, v55
    v_and_b32 v55, 0xffff0000, v54
    v_lshlrev_b32 v54, 16, v54
    v_mul_f32 v54, v54, v8
    v_mul_f32 v55, v55, v8
    v_sub_f32 v56, v36, v6
    v_sub_f32 v57, v37, v6
    v_cvt_pk_bf16_f32 v56, v56, v57
    v_and_b32 v57, 0xffff0000, v56
    v_lshlrev_b32 v56, 16, v56
    v_mul_f32 v56, v56, v8
    v_mul_f32 v57, v57, v8
    v_sub_f32 v58, v38, v6
    v_sub_f32 v59, v39, v6
    v_cvt_pk_bf16_f32 v58, v58, v59
    v_and_b32 v59, 0xffff0000, v58
    v_lshlrev_b32 v58, 16, v58
    v_mul_f32 v58, v58, v8
    v_mul_f32 v59, v59, v8
    v_sub_f32 v60, v40, v6
    v_sub_f32 v61, v41, v6
    v_cvt_pk_bf16_f32 v60, v60, v61
    v_and_b32 v61, 0xffff0000, v60
    v_lshlrev_b32 v60, 16, v60
    v_mul_f32 v60, v60, v8
    v_mul_f32 v61, v61, v8
    v_sub_f32 v62, v42, v6
    v_sub_f32 v63, v43, v6
    v_cvt_pk_bf16_f32 v62, v62, v63
    v_and_b32 v63, 0xffff0000, v62
    v_lshlrev_b32 v62, 16, v62
    v_mul_f32 v62, v62, v8
    v_mul_f32 v63, v63, v8
    v_sub_f32 v64, v44, v6
    v_sub_f32 v65, v45, v6
    v_cvt_pk_bf16_f32 v64, v64, v65
    v_and_b32 v65, 0xffff0000, v64
    v_lshlrev_b32 v64, 16, v64
    v_mul_f32 v64, v64, v8
    v_mul_f32 v65, v65, v8
    v_sub_f32 v66, v46, v6
    v_sub_f32 v67, v47, v6
    v_cvt_pk_bf16_f32 v66, v66, v67
    v_and_b32 v67, 0xffff0000, v66
    v_lshlrev_b32 v66, 16, v66
    v_mul_f32 v66, v66, v8
    v_mul_f32 v67, v67, v8
    v_sub_f32 v68, v48, v6
    v_sub_f32 v69, v49, v6
    v_cvt_pk_bf16_f32 v68, v68, v69
    v_and_b32 v69, 0xffff0000, v68
    v_lshlrev_b32 v68, 16, v68
    v_mul_f32 v68, v68, v8
    v_mul_f32 v69, v69, v8
    v_sub_f32 v70, v50, v6
    v_sub_f32 v71, v51, v6
    v_cvt_pk_bf16_f32 v70, v70, v71
    v_and_b32 v71, 0xffff0000, v70
    v_lshlrev_b32 v70, 16, v70
    v_mul_f32 v70, v70, v8
    v_mul_f32 v71, v71, v8
    v_cvt_pk_bf16_f32 v20, v52, v53
    v_cvt_pk_bf16_f32 v21, v54, v55
    v_cvt_pk_bf16_f32 v22, v56, v57
    v_cvt_pk_bf16_f32 v23, v58, v59
    v_cvt_pk_bf16_f32 v24, v60, v61
    v_cvt_pk_bf16_f32 v25, v62, v63
    v_cvt_pk_bf16_f32 v26, v64, v65
    v_cvt_pk_bf16_f32 v27, v66, v67
    v_cvt_pk_bf16_f32 v28, v68, v69
    v_cvt_pk_bf16_f32 v29, v70, v71
    ds_write_b64 v3, v[20:21] offset:32768
    ds_write_b64 v3, v[22:23] offset:34816
    ds_write_b64 v3, v[24:25] offset:36864
    ds_write_b64 v3, v[26:27] offset:38912
    ds_write_b64 v3, v[28:29] offset:40960
    v_lshlrev_b32 v32, 16, v20
    v_and_b32 v33, 0xffff0000, v20
    v_lshlrev_b32 v34, 16, v21
    v_and_b32 v35, 0xffff0000, v21
    v_lshlrev_b32 v36, 16, v22
    v_and_b32 v37, 0xffff0000, v22
    v_lshlrev_b32 v38, 16, v23
    v_and_b32 v39, 0xffff0000, v23
    v_lshlrev_b32 v40, 16, v24
    v_and_b32 v41, 0xffff0000, v24
    v_lshlrev_b32 v42, 16, v25
    v_and_b32 v43, 0xffff0000, v25
    v_lshlrev_b32 v44, 16, v26
    v_and_b32 v45, 0xffff0000, v26
    v_lshlrev_b32 v46, 16, v27
    v_and_b32 v47, 0xffff0000, v27
    v_lshlrev_b32 v48, 16, v28
    v_and_b32 v49, 0xffff0000, v28
    v_lshlrev_b32 v50, 16, v29
    v_and_b32 v51, 0xffff0000, v29
    v_add_f32 v6, v32, v33
    v_add_f32 v8, v34, v35
    v_add_f32 v6, v6, v36
    v_add_f32 v8, v8, v37
    v_add_f32 v6, v6, v38
    v_add_f32 v8, v8, v39
    v_add_f32 v6, v6, v40
    v_add_f32 v8, v8, v41
    v_add_f32 v6, v6, v42
    v_add_f32 v8, v8, v43
    v_add_f32 v6, v6, v44
    v_add_f32 v8, v8, v45
    v_add_f32 v6, v6, v46
    v_add_f32 v8, v8, v47
    v_add_f32 v6, v6, v48
    v_add_f32 v8, v8, v49
    v_add_f32 v6, v6, v50
    v_add_f32 v8, v8, v51
    v_add_f32 v6, v6, v8
    s_nop 1
    v_add_f32_dpp v6, v6, v6 row_ror:8 row_mask:0xf bank_mask:0xf
    s_nop 1
    v_add_f32_dpp v6, v6, v6 row_ror:4 row_mask:0xf bank_mask:0xf
    s_nop 1
    v_add_f32_dpp v6, v6, v6 row_ror:2 row_mask:0xf bank_mask:0xf
    s_nop 1
    v_add_f32_dpp v6, v6, v6 row_ror:1 row_mask:0xf bank_mask:0xf
    ds_swizzle_b32 v8, v6 offset:0x401F
    s_waitcnt lgkmcnt(0)
    v_add_f32 v6, v6, v8
    v_mul_f32 v6, 0x3acccccd, v6
    v_sub_f32 v52, v32, v6
    v_sub_f32 v53, v33, v6
    v_sub_f32 v54, v34, v6
    v_sub_f32 v55, v35, v6
    v_sub_f32 v56, v36, v6
    v_sub_f32 v57, v37, v6
    v_sub_f32 v58, v38, v6
    v_sub_f32 v59, v39, v6
    v_sub_f32 v60, v40, v6
    v_sub_f32 v61, v41, v6
    v_sub_f32 v62, v42, v6
    v_sub_f32 v63, v43, v6
    v_sub_f32 v64, v44, v6
    v_sub_f32 v65, v45, v6
    v_sub_f32 v66, v46, v6
    v_sub_f32 v67, v47, v6
    v_sub_f32 v68, v48, v6
    v_sub_f32 v69, v49, v6
    v_sub_f32 v70, v50, v6
    v_sub_f32 v71, v51, v6
    v_mul_f32 v8, v52, v52
    v_mul_f32 v9, v53, v53
    v_fmac_f32 v8, v54, v54
    v_fmac_f32 v9, v55, v55
    v_fmac_f32 v8, v56, v56
    v_fmac_f32 v9, v57, v57
    v_fmac_f32 v8, v58, v58
    v_fmac_f32 v9, v59, v59
    v_fmac_f32 v8, v60, v60
    v_fmac_f32 v9, v61, v61
    v_fmac_f32 v8, v62, v62
    v_fmac_f32 v9, v63, v63
    v_fmac_f32 v8, v64, v64
    v_fmac_f32 v9, v65, v65
    v_fmac_f32 v8, v66, v66
    v_fmac_f32 v9, v67, v67
    v_fmac_f32 v8, v68, v68
    v_fmac_f32 v9, v69, v69
    v_fmac_f32 v8, v70, v70
    v_fmac_f32 v9, v71, v71
    v_add_f32 v8, v8, v9
    s_nop 1
    v_add_f32_dpp v8, v8, v8 row_ror:8 row_mask:0xf bank_mask:0xf
    s_nop 1
    v_add_f32_dpp v8, v8, v8 row_ror:4 row_mask:0xf bank_mask:0xf
    s_nop 1
    v_add_f32_dpp v8, v8, v8 row_ror:2 row_mask:0xf bank_mask:0xf
    s_nop 1
    v_add_f32_dpp v8, v8, v8 row_ror:1 row_mask:0xf bank_mask:0xf
    ds_swizzle_b32 v9, v8 offset:0x401F
    s_waitcnt lgkmcnt(0)
    v_add_f32 v8, v8, v9
    v_mul_f32 v8, 0x3acccccd, v8
    v_cvt_pk_bf16_f32 v6, v6, v6
    v_and_b32 v6, 0xffff0000, v6
    v_cvt_pk_bf16_f32 v8, v8, v8
    v_and_b32 v8, 0xffff0000, v8
    v_add_f32 v8, 0x3727c5ac, v8
    v_cvt_pk_bf16_f32 v8, v8, v8
    v_and_b32 v8, 0xffff0000, v8
    v_sqrt_f32 v8, v8
    s_nop 0
    v_cvt_pk_bf16_f32 v8, v8, v8
    v_and_b32 v8, 0xffff0000, v8
    v_rcp_f32 v8, v8
    v_sub_f32 v52, v32, v6
    v_sub_f32 v53, v33, v6
    v_cvt_pk_bf16_f32 v52, v52, v53
    v_and_b32 v53, 0xffff0000, v52
    v_lshlrev_b32 v52, 16, v52
    v_mul_f32 v52, v52, v8
    v_mul_f32 v53, v53, v8
    v_sub_f32 v54, v34, v6
    v_sub_f32 v55, v35, v6
    v_cvt_pk_bf16_f32 v54, v54, v55
    v_and_b32 v55, 0xffff0000, v54
    v_lshlrev_b32 v54, 16, v54
    v_mul_f32 v54, v54, v8
    v_mul_f32 v55, v55, v8
    v_sub_f32 v56, v36, v6
    v_sub_f32 v57, v37, v6
    v_cvt_pk_bf16_f32 v56, v56, v57
    v_and_b32 v57, 0xffff0000, v56
    v_lshlrev_b32 v56, 16, v56
    v_mul_f32 v56, v56, v8
    v_mul_f32 v57, v57, v8
    v_sub_f32 v58, v38, v6
    v_sub_f32 v59, v39, v6
    v_cvt_pk_bf16_f32 v58, v58, v59
    v_and_b32 v59, 0xffff0000, v58
    v_lshlrev_b32 v58, 16, v58
    v_mul_f32 v58, v58, v8
    v_mul_f32 v59, v59, v8
    v_sub_f32 v60, v40, v6
    v_sub_f32 v61, v41, v6
    v_cvt_pk_bf16_f32 v60, v60, v61
    v_and_b32 v61, 0xffff0000, v60
    v_lshlrev_b32 v60, 16, v60
    v_mul_f32 v60, v60, v8
    v_mul_f32 v61, v61, v8
    v_sub_f32 v62, v42, v6
    v_sub_f32 v63, v43, v6
    v_cvt_pk_bf16_f32 v62, v62, v63
    v_and_b32 v63, 0xffff0000, v62
    v_lshlrev_b32 v62, 16, v62
    v_mul_f32 v62, v62, v8
    v_mul_f32 v63, v63, v8
    v_sub_f32 v64, v44, v6
    v_sub_f32 v65, v45, v6
    v_cvt_pk_bf16_f32 v64, v64, v65
    v_and_b32 v65, 0xffff0000, v64
    v_lshlrev_b32 v64, 16, v64
    v_mul_f32 v64, v64, v8
    v_mul_f32 v65, v65, v8
    v_sub_f32 v66, v46, v6
    v_sub_f32 v67, v47, v6
    v_cvt_pk_bf16_f32 v66, v66, v67
    v_and_b32 v67, 0xffff0000, v66
    v_lshlrev_b32 v66, 16, v66
    v_mul_f32 v66, v66, v8
    v_mul_f32 v67, v67, v8
    v_sub_f32 v68, v48, v6
    v_sub_f32 v69, v49, v6
    v_cvt_pk_bf16_f32 v68, v68, v69
    v_and_b32 v69, 0xffff0000, v68
    v_lshlrev_b32 v68, 16, v68
    v_mul_f32 v68, v68, v8
    v_mul_f32 v69, v69, v8
    v_sub_f32 v70, v50, v6
    v_sub_f32 v71, v51, v6
    v_cvt_pk_bf16_f32 v70, v70, v71
    v_and_b32 v71, 0xffff0000, v70
    v_lshlrev_b32 v70, 16, v70
    v_mul_f32 v70, v70, v8
    v_mul_f32 v71, v71, v8
    v_cvt_pk_bf16_f32 v32, v52, v53
    v_cvt_pk_bf16_f32 v33, v54, v55
    v_cvt_pk_bf16_f32 v34, v56, v57
    v_cvt_pk_bf16_f32 v35, v58, v59
    v_cvt_pk_bf16_f32 v36, v60, v61
    v_cvt_pk_bf16_f32 v37, v62, v63
    v_cvt_pk_bf16_f32 v38, v64, v65
    v_cvt_pk_bf16_f32 v39, v66, v67
    v_cvt_pk_bf16_f32 v40, v68, v69
    v_cvt_pk_bf16_f32 v41, v70, v71
    ds_write_b64 v3, v[32:33] offset:43008
    ds_write_b64 v3, v[34:35] offset:45056
    ds_write_b64 v3, v[36:37] offset:47104
    ds_write_b64 v3, v[38:39] offset:49152
    ds_write_b64 v3, v[40:41] offset:51200
    v_mov_b32 v4, 0
    s_mov_b32 s47, 0x40000
L_tag:
    buffer_load_dword v5, v4, s[16:19], 0 offen sc1
    s_waitcnt vmcnt(0)
    v_readfirstlane_b32 s31, v5
    s_sub_u32 s47, s47, 1
    s_cmp_eq_u32 s47, 0
    s_cbranch_scc1 L_tagx
    s_cmp_eq_u32 s31, 0
    s_cbranch_scc1 L_tag
L_tagx:
    s_cmp_lg_u32 s30, 0
    s_cbranch_scc1 L_a1
    v_lshrrev_b32 v3, 2, v1
    v_and_b32 v4, 3, v1
    v_lshlrev_b32 v3, 7, v3
    v_lshl_add_u32 v3, v4, 3, v3
    s_lshl_b32 s20, s30, 13
    v_add_u32 v3, s20, v3
    ds_read_b64_tr_b16 v[40:41], v3 offset:0
    ds_read_b64_tr_b16 v[42:43], v3 offset:2048
    ds_read_b64_tr_b16 v[44:45], v3 offset:32
    ds_read_b64_tr_b16 v[46:47], v3 offset:2080
    ds_read_b64_tr_b16 v[48:49], v3 offset:64
    ds_read_b64_tr_b16 v[50:51], v3 offset:2112
    ds_read_b64_tr_b16 v[52:53], v3 offset:96
    ds_read_b64_tr_b16 v[54:55], v3 offset:2144
    s_waitcnt lgkmcnt(0)
    buffer_store_dwordx4 v[40:43], v2, s[4:7], s32 offen sc1
    buffer_store_dwordx4 v[44:47], v2, s[4:7], s33 offen sc1
    buffer_store_dwordx4 v[48:51], v2, s[4:7], s34 offen sc1
    buffer_store_dwordx4 v[52:55], v2, s[4:7], s35 offen sc1
L_a1:
    s_waitcnt lgkmcnt(0)
    s_barrier
    v_lshlrev_b32 v3, 4, v0
    v_lshrrev_b32 v4, 3, v0
    v_and_b32 v5, 7, v0
    v_lshlrev_b32 v4, 8, v4
    v_lshl_add_u32 v4, v5, 4, v4
    ds_read_b128 v[20:23], v3 offset:32768
    ds_read_b128 v[24:27], v3 offset:36864
    ds_read_b128 v[28:31], v3 offset:40960
    ds_read_b128 v[32:35], v3 offset:45056
    ds_read_b128 v[36:39], v3 offset:49152
    s_lshl_b32 s20, s21, 2
    s_lshr_b32 s23, s22, 1
    s_add_u32 s20, s20, s23
    s_mul_i32 s20, s20, 20480
    s_and_b32 s23, s22, 1
    s_lshl_b32 s23, s23, 7
    s_add_u32 s20, s20, s23
    s_cmp_ge_u32 s30, 2
    s_cselect_b32 s24, 2600960, 0
    s_add_u32 s23, s20, 2625536
    s_waitcnt lgkmcnt(0)
    buffer_store_dwordx4 v[32:35], v4, s[4:7], s23 offen sc1
    s_add_u32 s23, s20, 2633728
    buffer_store_dwordx4 v[36:39], v4, s[4:7], s23 offen sc1
    s_add_u32 s23, s20, s24
    s_add_u32 s23, s23, 16384
    buffer_store_dwordx4 v[28:31], v4, s[4:7], s23 offen sc1
    s_add_u32 s23, s20, 0
    buffer_store_dwordx4 v[20:23], v4, s[4:7], s23 offen sc1
    s_add_u32 s23, s20, 8192
    buffer_store_dwordx4 v[24:27], v4, s[4:7], s23 offen sc1
    s_lshl_b32 s20, s30, 8
    s_add_u32 s20, s20, s2
    s_add_u32 s20, s20, 1024
    s_min_u32 s20, s20, 1359
    s_mov_b32 s8, s68
    s_mov_b32 s9, s69
    s_mov_b32 s10, 0x1e0000
    s_mov_b32 s11, 0x20000
    s_sub_u32 s20, s20, 880
    s_movk_i32 s23, 1280
    s_movk_i32 s24, 10
    s_mov_b32 s25, 6554
    s_movk_i32 s26, 5
    s_mov_b32 s27, 13108
    s_movk_i32 s28, 48
    s_mov_b32 s29, 20971520
W2_go:
    s_mul_i32 s40, s20, s25
    s_lshr_b32 s40, s40, 16
    s_mul_i32 s41, s40, s24
    s_sub_u32 s41, s20, s41
    v_lshrrev_b32 v3, 3, v1
    v_and_b32 v4, 7, v1
    v_mul_lo_u32 v3, v3, s23
    v_lshl_add_u32 v3, v4, 4, v3
    s_mul_i32 s42, s40, s23
    s_lshl_b32 s42, s42, 5
    s_lshl_b32 s43, s41, 7
    s_add_u32 s42, s42, s43
    s_lshl_b32 s43, s23, 3
    s_lshl_b32 s20, s30, 13
    s_add_u32 m0, s20, 4096
    s_nop 0
    buffer_load_dwordx4 v3, s[8:11], s42 offen lds
    s_add_u32 s42, s42, s43
    s_add_u32 m0, s20, 5120
    s_nop 0
    buffer_load_dwordx4 v3, s[8:11], s42 offen lds
    s_add_u32 s42, s42, s43
    s_add_u32 m0, s20, 6144
    s_nop 0
    buffer_load_dwordx4 v3, s[8:11], s42 offen lds
    s_add_u32 s42, s42, s43
    s_add_u32 m0, s20, 7168
    s_nop 0
    buffer_load_dwordx4 v3, s[8:11], s42 offen lds
    s_add_u32 s42, s42, s43
    s_lshl_b32 s42, s41, 2
    s_add_u32 s42, s42, 0
    s_mul_i32 s43, s42, s27
    s_lshr_b32 s43, s43, 16
    s_mul_i32 s20, s43, s26
    s_sub_u32 s20, s42, s20
    s_mul_i32 s43, s43, s28
    s_add_u32 s43, s43, s40
    s_mul_i32 s43, s43, s26
    s_add_u32 s43, s43, s20
    s_lshl_b32 s43, s43, 10
    s_add_u32 s36, s43, s29
    s_lshl_b32 s42, s41, 2
    s_add_u32 s42, s42, 1
    s_mul_i32 s43, s42, s27
    s_lshr_b32 s43, s43, 16
    s_mul_i32 s20, s43, s26
    s_sub_u32 s20, s42, s20
    s_mul_i32 s43, s43, s28
    s_add_u32 s43, s43, s40
    s_mul_i32 s43, s43, s26
    s_add_u32 s43, s43, s20
    s_lshl_b32 s43, s43, 10
    s_add_u32 s37, s43, s29
    s_lshl_b32 s42, s41, 2
    s_add_u32 s42, s42, 2
    s_mul_i32 s43, s42, s27
    s_lshr_b32 s43, s43, 16
    s_mul_i32 s20, s43, s26
    s_sub_u32 s20, s42, s20
    s_mul_i32 s43, s43, s28
    s_add_u32 s43, s43, s40
    s_mul_i32 s43, s43, s26
    s_add_u32 s43, s43, s20
    s_lshl_b32 s43, s43, 10
    s_add_u32 s38, s43, s29
    s_lshl_b32 s42, s41, 2
    s_add_u32 s42, s42, 3
    s_mul_i32 s43, s42, s27
    s_lshr_b32 s43, s43, 16
    s_mul_i32 s20, s43, s26
    s_sub_u32 s20, s42, s20
    s_mul_i32 s43, s43, s28
    s_add_u32 s43, s43, s40
    s_mul_i32 s43, s43, s26
    s_add_u32 s43, s43, s20
    s_lshl_b32 s43, s43, 10
    s_add_u32 s39, s43, s29
    s_mov_b32 s12, s50
    s_mov_b32 s13, s51
    s_mov_b32 s14, 0x280000
    s_mov_b32 s15, 0x20000
    s_mov_b32 s16, s52
    s_mov_b32 s17, s53
    s_mov_b32 s18, 0x280000
    s_mov_b32 s19, 0x20000
    s_mov_b32 s8, s54
    s_mov_b32 s9, s55
    s_mov_b32 s10, 0x1400
    s_mov_b32 s11, 0x20000
    s_mul_i32 s20, s22, 640
    buffer_load_dwordx4 v[136:139], v2, s[8:11], s20 offen
    v_mov_b32 v5, 0x7fff0000
    v_lshlrev_b32 v4, 2, v1
    v_cmp_gt_u32 vcc, 40, v1
    s_lshl_b32 s20, s21, 2
    s_add_u32 s20, s20, s30
    v_cndmask_b32 v4, v5, v4, vcc
    s_mul_i32 s23, s20, 20480
    s_mul_i32 s24, s22, 160
    s_add_u32 s23, s23, s24
    s_sub_u32 s24, s23, 3840
    s_cmp_eq_u32 s20, 0
    s_cselect_b32 s24, 0, s24
    s_cselect_b32 s25, 0x7fff0000, 0
    v_max_u32 v5, s25, v4
    buffer_load_dword v100, v5, s[12:15], s24 offen offset:0
    buffer_load_dword v101, v5, s[12:15], s24 offen offset:1280
    buffer_load_dword v102, v5, s[12:15], s24 offen offset:2560
    buffer_load_dword v103, v4, s[12:15], s23 offen offset:0
    buffer_load_dword v104, v4, s[12:15], s23 offen offset:1280
    buffer_load_dword v105, v4, s[12:15], s23 offen offset:2560
    buffer_load_dword v106, v4, s[12:15], s23 offen offset:3840
    buffer_load_dword v120, v4, s[16:19], s23 offen offset:0
    buffer_load_dword v121, v4, s[16:19], s23 offen offset:1280
    buffer_load_dword v122, v4, s[16:19], s23 offen offset:2560
    buffer_load_dword v123, v4, s[16:19], s23 offen offset:3840
    s_add_u32 s23, s23, 5120
    buffer_load_dword v107, v4, s[12:15], s23 offen offset:0
    buffer_load_dword v108, v4, s[12:15], s23 offen offset:1280
    buffer_load_dword v109, v4, s[12:15], s23 offen offset:2560
    buffer_load_dword v110, v4, s[12:15], s23 offen offset:3840
    buffer_load_dword v124, v4, s[16:19], s23 offen offset:0
    buffer_load_dword v125, v4, s[16:19], s23 offen offset:1280
    buffer_load_dword v126, v4, s[16:19], s23 offen offset:2560
    buffer_load_dword v127, v4, s[16:19], s23 offen offset:3840
    s_add_u32 s23, s23, 5120
    buffer_load_dword v111, v4, s[12:15], s23 offen offset:0
    buffer_load_dword v112, v4, s[12:15], s23 offen offset:1280
    buffer_load_dword v113, v4, s[12:15], s23 offen offset:2560
    buffer_load_dword v114, v4, s[12:15], s23 offen offset:3840
    buffer_load_dword v128, v4, s[16:19], s23 offen offset:0
    buffer_load_dword v129, v4, s[16:19], s23 offen offset:1280
    buffer_load_dword v130, v4, s[16:19], s23 offen offset:2560
    buffer_load_dword v131, v4, s[16:19], s23 offen offset:3840
    s_add_u32 s23, s23, 5120
    buffer_load_dword v115, v4, s[12:15], s23 offen offset:0
    buffer_load_dword v116, v4, s[12:15], s23 offen offset:1280
    buffer_load_dword v117, v4, s[12:15], s23 offen offset:2560
    buffer_load_dword v118, v4, s[12:15], s23 offen offset:3840
    buffer_load_dword v132, v4, s[16:19], s23 offen offset:0
    buffer_load_dword v133, v4, s[16:19], s23 offen offset:1280
    buffer_load_dword v134, v4, s[16:19], s23 offen offset:2560
    buffer_load_dword v135, v4, s[16:19], s23 offen offset:3840
    s_add_u32 s23, s23, 5120
    s_waitcnt vmcnt(40)
    s_barrier
    s_cmp_lg_u32 s30, 0
    s_cbranch_scc1 Lsig3
    s_lshl_b32 s20, s2, 2
    s_add_u32 s20, s20, 29884416
    v_mov_b32 v14, s31
    v_mov_b32 v15, 0
    s_mov_b64 exec, 1
    buffer_store_dword v14, v15, s[4:7], s20 offen sc1
    s_mov_b64 exec, -1
Lsig3:
    s_cmp_ge_u32 s60, 640
    s_cbranch_scc1 L_b0
    s_mov_b32 s8, s56
    s_mov_b32 s9, s57
    s_mov_b32 s10, 0x280000
    s_mov_b32 s11, 0x20000
    s_mov_b32 s12, s58
    s_mov_b32 s13, s59
    s_mov_b32 s14, 0x500
    s_mov_b32 s15, 0x20000
    s_lshl_b32 s20, s60, 12
    s_add_u32 m0, s61, 4192
    v_subrev_u32 v3, 4, v2
    s_lshl_b32 s23, s60, 1
    buffer_load_dwordx4 v2, s[8:11], s20 offen offset:0 lds
    buffer_load_dwordx4 v2, s[8:11], s20 offen offset:1024 lds
    buffer_load_dwordx4 v2, s[8:11], s20 offen offset:2048 lds
    buffer_load_dwordx4 v2, s[8:11], s20 offen offset:3072 lds
    buffer_load_dwordx4 v[176:179], v2, s[8:11], s20 offen offset:0
    buffer_load_dwordx4 v[180:183], v2, s[8:11], s20 offen offset:1024
    buffer_load_dwordx4 v[184:187], v2, s[8:11], s20 offen offset:2048
    buffer_load_dwordx4 v[188:191], v2, s[8:11], s20 offen offset:3072
    buffer_load_dword v192, v3, s[8:11], s20 offen
    buffer_load_dword v193, v2, s[8:11], s20 offen offset:1020
    buffer_load_dword v194, v2, s[8:11], s20 offen offset:2044
    buffer_load_dword v195, v2, s[8:11], s20 offen offset:3068
    v_mov_b32 v4, 0
    buffer_load_ushort v239, v4, s[12:15], s23 offen
L_b0:
    s_cmp_eq_u32 s30, 0
    s_cbranch_scc1 L_b1
    v_lshrrev_b32 v3, 2, v1
    v_and_b32 v4, 3, v1
    v_lshlrev_b32 v3, 7, v3
    v_lshl_add_u32 v3, v4, 3, v3
    s_lshl_b32 s20, s30, 13
    v_add_u32 v3, s20, v3
    ds_read_b64_tr_b16 v[40:41], v3 offset:0
    ds_read_b64_tr_b16 v[42:43], v3 offset:2048
    ds_read_b64_tr_b16 v[44:45], v3 offset:32
    ds_read_b64_tr_b16 v[46:47], v3 offset:2080
    ds_read_b64_tr_b16 v[48:49], v3 offset:64
    ds_read_b64_tr_b16 v[50:51], v3 offset:2112
    ds_read_b64_tr_b16 v[52:53], v3 offset:96
    ds_read_b64_tr_b16 v[54:55], v3 offset:2144
    s_waitcnt lgkmcnt(0)
    buffer_store_dwordx4 v[40:43], v2, s[4:7], s32 offen sc1
    buffer_store_dwordx4 v[44:47], v2, s[4:7], s33 offen sc1
    buffer_store_dwordx4 v[48:51], v2, s[4:7], s34 offen sc1
    buffer_store_dwordx4 v[52:55], v2, s[4:7], s35 offen sc1
L_b1:
    s_waitcnt vmcnt(0)
    s_lshl_b32 s20, s30, 8
    s_add_u32 s20, s20, s2
    s_cmp_ge_u32 s20, 336
    s_cbranch_scc1 L_b2
    v_lshrrev_b32 v3, 2, v1
    v_and_b32 v4, 3, v1
    v_lshlrev_b32 v3, 7, v3
    v_lshl_add_u32 v3, v4, 3, v3
    s_lshl_b32 s20, s30, 13
    v_add_u32 v3, s20, v3
    ds_read_b64_tr_b16 v[140:141], v3 offset:4096
    ds_read_b64_tr_b16 v[142:143], v3 offset:6144
    ds_read_b64_tr_b16 v[144:145], v3 offset:4128
    ds_read_b64_tr_b16 v[146:147], v3 offset:6176
    ds_read_b64_tr_b16 v[148:149], v3 offset:4160
    ds_read_b64_tr_b16 v[150:151], v3 offset:6208
    ds_read_b64_tr_b16 v[152:153], v3 offset:4192
    ds_read_b64_tr_b16 v[154:155], v3 offset:6240
    s_waitcnt lgkmcnt(0)
    buffer_store_dwordx4 v[140:143], v2, s[4:7], s36 offen sc1
    buffer_store_dwordx4 v[144:147], v2, s[4:7], s37 offen sc1
    buffer_store_dwordx4 v[148:151], v2, s[4:7], s38 offen sc1
    buffer_store_dwordx4 v[152:155], v2, s[4:7], s39 offen sc1
L_b2:
    v_lshlrev_b32 v8, 16, v136
    v_and_b32 v9, 0xffff0000, v136
    v_lshlrev_b32 v10, 16, v137
    v_and_b32 v11, 0xffff0000, v137
    v_lshlrev_b32 v12, 16, v138
    v_and_b32 v13, 0xffff0000, v138
    v_lshlrev_b32 v14, 16, v139
    v_and_b32 v15, 0xffff0000, v139
    v_lshlrev_b32 v20, 16, v100
    v_and_b32 v40, 0xffff0000, v100
    v_lshlrev_b32 v21, 16, v101
    v_and_b32 v41, 0xffff0000, v101
    v_lshlrev_b32 v22, 16, v102
    v_and_b32 v42, 0xffff0000, v102
    v_lshlrev_b32 v23, 16, v103
    v_and_b32 v43, 0xffff0000, v103
    v_lshlrev_b32 v24, 16, v104
    v_and_b32 v44, 0xffff0000, v104
    v_lshlrev_b32 v25, 16, v105
    v_and_b32 v45, 0xffff0000, v105
    v_lshlrev_b32 v26, 16, v106
    v_and_b32 v46, 0xffff0000, v106
    v_lshlrev_b32 v27, 16, v107
    v_and_b32 v47, 0xffff0000, v107
    v_lshlrev_b32 v28, 16, v108
    v_and_b32 v48, 0xffff0000, v108
    v_lshlrev_b32 v29, 16, v109
    v_and_b32 v49, 0xffff0000, v109
    v_lshlrev_b32 v30, 16, v110
    v_and_b32 v50, 0xffff0000, v110
    v_lshlrev_b32 v31, 16, v111
    v_and_b32 v51, 0xffff0000, v111
    v_lshlrev_b32 v32, 16, v112
    v_and_b32 v52, 0xffff0000, v112
    v_lshlrev_b32 v33, 16, v113
    v_and_b32 v53, 0xffff0000, v113
    v_lshlrev_b32 v34, 16, v114
    v_and_b32 v54, 0xffff0000, v114
    v_lshlrev_b32 v35, 16, v115
    v_and_b32 v55, 0xffff0000, v115
    v_lshlrev_b32 v36, 16, v116
    v_and_b32 v56, 0xffff0000, v116
    v_lshlrev_b32 v37, 16, v117
    v_and_b32 v57, 0xffff0000, v117
    v_lshlrev_b32 v38, 16, v118
    v_and_b32 v58, 0xffff0000, v118
    v_mul_f32 v60, v20, v11
    v_fmac_f32 v60, v21, v10
    v_fmac_f32 v60, v22, v9
    v_fmac_f32 v60, v23, v8
    v_mul_f32 v61, v21, v11
    v_fmac_f32 v61, v22, v10
    v_fmac_f32 v61, v23, v9
    v_fmac_f32 v61, v24, v8
    v_mul_f32 v62, v22, v11
    v_fmac_f32 v62, v23, v10
    v_fmac_f32 v62, v24, v9
    v_fmac_f32 v62, v25, v8
    v_mul_f32 v63, v23, v11
    v_fmac_f32 v63, v24, v10
    v_fmac_f32 v63, v25, v9
    v_fmac_f32 v63, v26, v8
    v_mul_f32 v64, v24, v11
    v_fmac_f32 v64, v25, v10
    v_fmac_f32 v64, v26, v9
    v_fmac_f32 v64, v27, v8
    v_mul_f32 v65, v25, v11
    v_fmac_f32 v65, v26, v10
    v_fmac_f32 v65, v27, v9
    v_fmac_f32 v65, v28, v8
    v_mul_f32 v66, v26, v11
    v_fmac_f32 v66, v27, v10
    v_fmac_f32 v66, v28, v9
    v_fmac_f32 v66, v29, v8
    v_mul_f32 v67, v27, v11
    v_fmac_f32 v67, v28, v10
    v_fmac_f32 v67, v29, v9
    v_fmac_f32 v67, v30, v8
    v_mul_f32 v68, v28, v11
    v_fmac_f32 v68, v29, v10
    v_fmac_f32 v68, v30, v9
    v_fmac_f32 v68, v31, v8
    v_mul_f32 v69, v29, v11
    v_fmac_f32 v69, v30, v10
    v_fmac_f32 v69, v31, v9
    v_fmac_f32 v69, v32, v8
    v_mul_f32 v70, v30, v11
    v_fmac_f32 v70, v31, v10
    v_fmac_f32 v70, v32, v9
    v_fmac_f32 v70, v33, v8
    v_mul_f32 v71, v31, v11
    v_fmac_f32 v71, v32, v10
    v_fmac_f32 v71, v33, v9
    v_fmac_f32 v71, v34, v8
    v_mul_f32 v72, v32, v11
    v_fmac_f32 v72, v33, v10
    v_fmac_f32 v72, v34, v9
    v_fmac_f32 v72, v35, v8
    v_mul_f32 v73, v33, v11
    v_fmac_f32 v73, v34, v10
    v_fmac_f32 v73, v35, v9
    v_fmac_f32 v73, v36, v8
    v_mul_f32 v74, v34, v11
    v_fmac_f32 v74, v35, v10
    v_fmac_f32 v74, v36, v9
    v_fmac_f32 v74, v37, v8
    v_mul_f32 v75, v35, v11
    v_fmac_f32 v75, v36, v10
    v_fmac_f32 v75, v37, v9
    v_fmac_f32 v75, v38, v8
    v_mul_f32 v76, v40, v15
    v_fmac_f32 v76, v41, v14
    v_fmac_f32 v76, v42, v13
    v_fmac_f32 v76, v43, v12
    v_mul_f32 v77, v41, v15
    v_fmac_f32 v77, v42, v14
    v_fmac_f32 v77, v43, v13
    v_fmac_f32 v77, v44, v12
    v_mul_f32 v78, v42, v15
    v_fmac_f32 v78, v43, v14
    v_fmac_f32 v78, v44, v13
    v_fmac_f32 v78, v45, v12
    v_mul_f32 v79, v43, v15
    v_fmac_f32 v79, v44, v14
    v_fmac_f32 v79, v45, v13
    v_fmac_f32 v79, v46, v12
    v_mul_f32 v80, v44, v15
    v_fmac_f32 v80, v45, v14
    v_fmac_f32 v80, v46, v13
    v_fmac_f32 v80, v47, v12
    v_mul_f32 v81, v45, v15
    v_fmac_f32 v81, v46, v14
    v_fmac_f32 v81, v47, v13
    v_fmac_f32 v81, v48, v12
    v_mul_f32 v82, v46, v15
    v_fmac_f32 v82, v47, v14
    v_fmac_f32 v82, v48, v13
    v_fmac_f32 v82, v49, v12
    v_mul_f32 v83, v47, v15
    v_fmac_f32 v83, v48, v14
    v_fmac_f32 v83, v49, v13
    v_fmac_f32 v83, v50, v12
    v_mul_f32 v84, v48, v15
    v_fmac_f32 v84, v49, v14
    v_fmac_f32 v84, v50, v13
    v_fmac_f32 v84, v51, v12
    v_mul_f32 v85, v49, v15
    v_fmac_f32 v85, v50, v14
    v_fmac_f32 v85, v51, v13
    v_fmac_f32 v85, v52, v12
    v_mul_f32 v86, v50, v15
    v_fmac_f32 v86, v51, v14
    v_fmac_f32 v86, v52, v13
    v_fmac_f32 v86, v53, v12
    v_mul_f32 v87, v51, v15
    v_fmac_f32 v87, v52, v14
    v_fmac_f32 v87, v53, v13
    v_fmac_f32 v87, v54, v12
    v_mul_f32 v88, v52, v15
    v_fmac_f32 v88, v53, v14
    v_fmac_f32 v88, v54, v13
    v_fmac_f32 v88, v55, v12
    v_mul_f32 v89, v53, v15
    v_fmac_f32 v89, v54, v14
    v_fmac_f32 v89, v55, v13
    v_fmac_f32 v89, v56, v12
    v_mul_f32 v90, v54, v15
    v_fmac_f32 v90, v55, v14
    v_fmac_f32 v90, v56, v13
    v_fmac_f32 v90, v57, v12
    v_mul_f32 v91, v55, v15
    v_fmac_f32 v91, v56, v14
    v_fmac_f32 v91, v57, v13
    v_fmac_f32 v91, v58, v12
    v_cvt_pk_bf16_f32 v16, v60, v76
    v_lshlrev_b32 v17, 16, v120
    v_and_b32 v18, 0xffff0000, v120
    v_lshlrev_b32 v60, 16, v16
    v_and_b32 v76, 0xffff0000, v16
    v_mul_f32 v60, v60, v17
    v_mul_f32 v76, v76, v18
    v_cvt_pk_bf16_f32 v16, v61, v77
    v_lshlrev_b32 v17, 16, v121
    v_and_b32 v18, 0xffff0000, v121
    v_lshlrev_b32 v61, 16, v16
    v_and_b32 v77, 0xffff0000, v16
    v_mul_f32 v61, v61, v17
    v_mul_f32 v77, v77, v18
    v_cvt_pk_bf16_f32 v16, v62, v78
    v_lshlrev_b32 v17, 16, v122
    v_and_b32 v18, 0xffff0000, v122
    v_lshlrev_b32 v62, 16, v16
    v_and_b32 v78, 0xffff0000, v16
    v_mul_f32 v62, v62, v17
    v_mul_f32 v78, v78, v18
    v_cvt_pk_bf16_f32 v16, v63, v79
    v_lshlrev_b32 v17, 16, v123
    v_and_b32 v18, 0xffff0000, v123
    v_lshlrev_b32 v63, 16, v16
    v_and_b32 v79, 0xffff0000, v16
    v_mul_f32 v63, v63, v17
    v_mul_f32 v79, v79, v18
    v_cvt_pk_bf16_f32 v16, v64, v80
    v_lshlrev_b32 v17, 16, v124
    v_and_b32 v18, 0xffff0000, v124
    v_lshlrev_b32 v64, 16, v16
    v_and_b32 v80, 0xffff0000, v16
    v_mul_f32 v64, v64, v17
    v_mul_f32 v80, v80, v18
    v_cvt_pk_bf16_f32 v16, v65, v81
    v_lshlrev_b32 v17, 16, v125
    v_and_b32 v18, 0xffff0000, v125
    v_lshlrev_b32 v65, 16, v16
    v_and_b32 v81, 0xffff0000, v16
    v_mul_f32 v65, v65, v17
    v_mul_f32 v81, v81, v18
    v_cvt_pk_bf16_f32 v16, v66, v82
    v_lshlrev_b32 v17, 16, v126
    v_and_b32 v18, 0xffff0000, v126
    v_lshlrev_b32 v66, 16, v16
    v_and_b32 v82, 0xffff0000, v16
    v_mul_f32 v66, v66, v17
    v_mul_f32 v82, v82, v18
    v_cvt_pk_bf16_f32 v16, v67, v83
    v_lshlrev_b32 v17, 16, v127
    v_and_b32 v18, 0xffff0000, v127
    v_lshlrev_b32 v67, 16, v16
    v_and_b32 v83, 0xffff0000, v16
    v_mul_f32 v67, v67, v17
    v_mul_f32 v83, v83, v18
    v_cvt_pk_bf16_f32 v16, v68, v84
    v_lshlrev_b32 v17, 16, v128
    v_and_b32 v18, 0xffff0000, v128
    v_lshlrev_b32 v68, 16, v16
    v_and_b32 v84, 0xffff0000, v16
    v_mul_f32 v68, v68, v17
    v_mul_f32 v84, v84, v18
    v_cvt_pk_bf16_f32 v16, v69, v85
    v_lshlrev_b32 v17, 16, v129
    v_and_b32 v18, 0xffff0000, v129
    v_lshlrev_b32 v69, 16, v16
    v_and_b32 v85, 0xffff0000, v16
    v_mul_f32 v69, v69, v17
    v_mul_f32 v85, v85, v18
    v_cvt_pk_bf16_f32 v16, v70, v86
    v_lshlrev_b32 v17, 16, v130
    v_and_b32 v18, 0xffff0000, v130
    v_lshlrev_b32 v70, 16, v16
    v_and_b32 v86, 0xffff0000, v16
    v_mul_f32 v70, v70, v17
    v_mul_f32 v86, v86, v18
    v_cvt_pk_bf16_f32 v16, v71, v87
    v_lshlrev_b32 v17, 16, v131
    v_and_b32 v18, 0xffff0000, v131
    v_lshlrev_b32 v71, 16, v16
    v_and_b32 v87, 0xffff0000, v16
    v_mul_f32 v71, v71, v17
    v_mul_f32 v87, v87, v18
    v_cvt_pk_bf16_f32 v16, v72, v88
    v_lshlrev_b32 v17, 16, v132
    v_and_b32 v18, 0xffff0000, v132
    v_lshlrev_b32 v72, 16, v16
    v_and_b32 v88, 0xffff0000, v16
    v_mul_f32 v72, v72, v17
    v_mul_f32 v88, v88, v18
    v_cvt_pk_bf16_f32 v16, v73, v89
    v_lshlrev_b32 v17, 16, v133
    v_and_b32 v18, 0xffff0000, v133
    v_lshlrev_b32 v73, 16, v16
    v_and_b32 v89, 0xffff0000, v16
    v_mul_f32 v73, v73, v17
    v_mul_f32 v89, v89, v18
    v_cvt_pk_bf16_f32 v16, v74, v90
    v_lshlrev_b32 v17, 16, v134
    v_and_b32 v18, 0xffff0000, v134
    v_lshlrev_b32 v74, 16, v16
    v_and_b32 v90, 0xffff0000, v16
    v_mul_f32 v74, v74, v17
    v_mul_f32 v90, v90, v18
    v_cvt_pk_bf16_f32 v16, v75, v91
    v_lshlrev_b32 v17, 16, v135
    v_and_b32 v18, 0xffff0000, v135
    v_lshlrev_b32 v75, 16, v16
    v_and_b32 v91, 0xffff0000, v16
    v_mul_f32 v75, v75, v17
    v_mul_f32 v91, v91, v18
    v_cvt_pk_bf16_f32 v20, v75, v74
    v_cvt_pk_bf16_f32 v21, v73, v72
    v_cvt_pk_bf16_f32 v22, v71, v70
    v_cvt_pk_bf16_f32 v23, v69, v68
    v_cvt_pk_bf16_f32 v24, v67, v66
    v_cvt_pk_bf16_f32 v25, v65, v64
    v_cvt_pk_bf16_f32 v26, v63, v62
    v_cvt_pk_bf16_f32 v27, v61, v60
    v_cvt_pk_bf16_f32 v28, v91, v90
    v_cvt_pk_bf16_f32 v29, v89, v88
    v_cvt_pk_bf16_f32 v30, v87, v86
    v_cvt_pk_bf16_f32 v31, v85, v84
    v_cvt_pk_bf16_f32 v32, v83, v82
    v_cvt_pk_bf16_f32 v33, v81, v80
    v_cvt_pk_bf16_f32 v34, v79, v78
    v_cvt_pk_bf16_f32 v35, v77, v76
    s_lshl_b32 s20, s30, 5
    s_sub_u32 s20, 53344, s20
    v_mul_u32_u24 v3, 288, v1
    v_add_u32 v3, s20, v3
    s_mov_b32 exec_hi, 0xff
    ds_write_b128 v3, v[20:23] offset:0
    ds_write_b128 v3, v[24:27] offset:16
    ds_write_b128 v3, v[28:31] offset:144
    ds_write_b128 v3, v[32:35] offset:160
    s_mov_b32 exec_hi, -1
    s_cmp_ge_u32 s60, 640
    s_cbranch_scc1 L_b3
    v_mov_b32 v8, 0
    v_mov_b32 v9, 0
    v_mov_b32 v10, 0
    v_mov_b32 v11, 0
    v_add_u32 v5, s61, v2
    s_mov_b32 exec_hi, 0
    ds_write_b128 v5, v[8:11] offset:12416
    s_mov_b64 exec, 3
    ds_write_b128 v5, v[8:11] offset:0
    ds_write_b128 v5, v[8:11] offset:4160
    s_mov_b64 exec, -1
    v_mov_b32 v200, 0
    v_mov_b32 v201, 0
    v_mov_b32 v202, 0
    v_mov_b32 v203, 0
    v_mov_b32 v204, 0
    v_mov_b32 v205, 0
    v_mov_b32 v206, 0
    v_mov_b32 v207, 0
    v_mov_b32 v208, 0
    v_mov_b32 v209, 0
    v_mov_b32 v210, 0
    v_mov_b32 v211, 0
    v_mov_b32 v212, 0
    v_mov_b32 v213, 0
    v_mov_b32 v214, 0
    v_mov_b32 v215, 0
    v_mov_b32 v216, 0
    v_mov_b32 v217, 0
    v_mov_b32 v218, 0
    v_mov_b32 v219, 0
    v_mov_b32 v220, 0
    v_mov_b32 v221, 0
    v_mov_b32 v222, 0
    v_mov_b32 v223, 0
    v_mov_b32 v224, 0
    v_mov_b32 v225, 0
    v_mov_b32 v226, 0
    v_mov_b32 v227, 0
    v_mov_b32 v228, 0
    v_mov_b32 v229, 0
    v_mov_b32 v230, 0
    v_mov_b32 v231, 0
    v_and_b32 v6, 15, v1
    v_lshrrev_b32 v7, 4, v1
    v_cmp_eq_u32 vcc, 0, v1
    v_and_b32 v232, 1, v6
    v_mul_u32_u24 v232, 4160, v232
    v_lshrrev_b32 v233, 1, v6
    v_lshl_add_u32 v232, v233, 2, v232
    v_lshl_add_u32 v232, v7, 4, v232
    s_add_u32 s25, s61, 4
    v_add_u32 v232, s25, v232
    v_add_u32 v233, 1024, v232
    v_add_u32 v234, 2048, v232
    v_add_u32 v235, 3072, v232
    v_lshlrev_b32 v12, 5, v6
    v_lshlrev_b32 v13, 4, v7
    v_sub_u32 v13, v13, v12
    s_add_u32 s25, s61, 8800
    v_add_u32 v236, s25, v13
    v_lshlrev_b32 v13, 3, v7
    v_add_u32 v238, v12, v13
    s_add_u32 s25, s61, 8824
    v_sub_u32 v237, s25, v238
    v_cndmask_b32 v192, v192, v8, vcc
    v_lshlrev_b32 v239, 16, v239
    v_alignbit_b32 v240, v176, v192, 16
    v_alignbit_b32 v241, v177, v176, 16
    v_alignbit_b32 v242, v178, v177, 16
    v_alignbit_b32 v243, v179, v178, 16
    ds_write_b128 v5, v[240:243] offset:32
    v_alignbit_b32 v244, v180, v193, 16
    v_alignbit_b32 v245, v181, v180, 16
    v_alignbit_b32 v246, v182, v181, 16
    v_alignbit_b32 v247, v183, v182, 16
    ds_write_b128 v5, v[244:247] offset:1056
    v_alignbit_b32 v248, v184, v194, 16
    v_alignbit_b32 v249, v185, v184, 16
    v_alignbit_b32 v250, v186, v185, 16
    v_alignbit_b32 v251, v187, v186, 16
    ds_write_b128 v5, v[248:251] offset:2080
    v_alignbit_b32 v252, v188, v195, 16
    v_alignbit_b32 v253, v189, v188, 16
    v_alignbit_b32 v254, v190, v189, 16
    v_alignbit_b32 v255, v191, v190, 16
    ds_write_b128 v5, v[252:255] offset:3104
L_b3:
    s_waitcnt lgkmcnt(0)
    s_barrier
    v_lshrrev_b32 v4, 3, v0
    v_and_b32 v5, 7, v0
    v_lshlrev_b32 v5, 4, v5
    v_mul_u32_u24 v3, 144, v4
    v_add_u32 v3, v3, v5
    v_lshl_add_u32 v4, v4, 12, v5
    ds_read_b128 v[20:23], v3 offset:53248
    ds_read_b128 v[24:27], v3 offset:57856
    ds_read_b128 v[28:31], v3 offset:62464
    s_mul_i32 s20, s22, 327680
    s_lshl_b32 s23, s21, 7
    s_sub_u32 s20, s20, s23
    s_add_u32 s20, s20, 23072640
    s_waitcnt lgkmcnt(0)
    buffer_store_dwordx4 v[20:23], v4, s[4:7], s20 offen sc1
    s_add_u32 s20, s20, 131072
    buffer_store_dwordx4 v[24:27], v4, s[4:7], s20 offen sc1
    s_add_u32 s20, s20, 131072
    s_cmp_ge_u32 s30, 2
    s_cbranch_scc1 KV4
    buffer_store_dwordx4 v[28:31], v4, s[4:7], s20 offen sc1
    s_add_u32 s20, s20, 131072
KV4:
    s_waitcnt vmcnt(0)
    s_barrier
    s_cmp_lg_u32 s30, 0
    s_cbranch_scc1 Lsig5
    s_lshl_b32 s20, s2, 2
    s_add_u32 s20, s20, 29885440
    v_mov_b32 v14, s31
    v_mov_b32 v15, 0
    s_mov_b64 exec, 1
    buffer_store_dword v14, v15, s[4:7], s20 offen sc1
    s_mov_b64 exec, -1
Lsig5:
    s_mov_b32 s46, 29884416
    s_mov_b32 s47, 0x40000
Lpoll6:
    buffer_load_dwordx4 v[12:15], v2, s[4:7], s46 offen sc1
    s_waitcnt vmcnt(0)
    v_xor_b32 v12, s31, v12
    v_xor_b32 v13, s31, v13
    v_xor_b32 v14, s31, v14
    v_xor_b32 v15, s31, v15
    v_or3_b32 v12, v12, v13, v14
    v_or_b32 v12, v12, v15
    v_cmp_ne_u32 vcc, 0, v12
    s_sub_u32 s47, s47, 1
    s_cmp_eq_u32 s47, 0
    s_cbranch_scc1 Lpoll6_x
    s_nop 2
    s_cbranch_vccnz Lpoll6
Lpoll6_x:
    s_lshl_b32 s24, s21, 2
    s_add_u32 s24, s24, s30
    s_mul_i32 s24, s24, 1
    s_mul_i32 s25, s24, 20480
    s_add_u32 s25, s25, 2621440
    s_add_u32 s26, s25, 20480
    s_mul_i32 s27, s22, 102400
    s_add_u32 s27, s27, 16777216
    s_mul_i32 s29, s30, 5120
    s_add_u32 s28, s27, s29
    s_add_u32 m0, s29, 0
    s_add_u32 s33, s28, 0
    buffer_load_dwordx4 v2, s[4:7], s33 offen offset:0 sc1 lds
    buffer_load_dwordx4 v2, s[4:7], s33 offen offset:1024 sc1 lds
    buffer_load_dwordx4 v2, s[4:7], s33 offen offset:2048 sc1 lds
    buffer_load_dwordx4 v2, s[4:7], s33 offen offset:3072 sc1 lds
    s_add_u32 m0, s29, 4096
    s_add_u32 s33, s28, 4096
    buffer_load_dwordx4 v2, s[4:7], s33 offen offset:0 sc1 lds
    s_add_u32 s35, s25, 0
    buffer_load_dwordx4 a[0:3], v2, s[4:7], s35 offen offset:0 sc1
    buffer_load_dwordx4 a[4:7], v2, s[4:7], s35 offen offset:1024 sc1
    buffer_load_dwordx4 a[8:11], v2, s[4:7], s35 offen offset:2048 sc1
    buffer_load_dwordx4 a[12:15], v2, s[4:7], s35 offen offset:3072 sc1
    s_add_u32 m0, s29, 20480
    s_add_u32 s33, s28, 20480
    buffer_load_dwordx4 v2, s[4:7], s33 offen offset:0 sc1 lds
    buffer_load_dwordx4 v2, s[4:7], s33 offen offset:1024 sc1 lds
    buffer_load_dwordx4 v2, s[4:7], s33 offen offset:2048 sc1 lds
    buffer_load_dwordx4 v2, s[4:7], s33 offen offset:3072 sc1 lds
    s_add_u32 m0, s29, 24576
    s_add_u32 s33, s28, 24576
    buffer_load_dwordx4 v2, s[4:7], s33 offen offset:0 sc1 lds
    s_add_u32 s35, s25, 4096
    buffer_load_dwordx4 a[16:19], v2, s[4:7], s35 offen offset:0 sc1
    buffer_load_dwordx4 a[20:23], v2, s[4:7], s35 offen offset:1024 sc1
    buffer_load_dwordx4 a[24:27], v2, s[4:7], s35 offen offset:2048 sc1
    buffer_load_dwordx4 a[28:31], v2, s[4:7], s35 offen offset:3072 sc1
    s_add_u32 m0, s29, 40960
    s_add_u32 s33, s28, 40960
    buffer_load_dwordx4 v2, s[4:7], s33 offen offset:0 sc1 lds
    buffer_load_dwordx4 v2, s[4:7], s33 offen offset:1024 sc1 lds
    buffer_load_dwordx4 v2, s[4:7], s33 offen offset:2048 sc1 lds
    buffer_load_dwordx4 v2, s[4:7], s33 offen offset:3072 sc1 lds
    s_add_u32 m0, s29, 45056
    s_add_u32 s33, s28, 45056
    buffer_load_dwordx4 v2, s[4:7], s33 offen offset:0 sc1 lds
    s_add_u32 s35, s25, 8192
    buffer_load_dwordx4 a[32:35], v2, s[4:7], s35 offen offset:0 sc1
    buffer_load_dwordx4 a[36:39], v2, s[4:7], s35 offen offset:1024 sc1
    buffer_load_dwordx4 a[40:43], v2, s[4:7], s35 offen offset:2048 sc1
    buffer_load_dwordx4 a[44:47], v2, s[4:7], s35 offen offset:3072 sc1
    v_mov_b32 v16, 0
    v_mov_b32 v17, 0
    v_mov_b32 v18, 0
    v_mov_b32 v19, 0
    v_mov_b32 v20, 0
    v_mov_b32 v21, 0
    v_mov_b32 v22, 0
    v_mov_b32 v23, 0
    v_mov_b32 v24, 0
    v_mov_b32 v25, 0
    v_mov_b32 v26, 0
    v_mov_b32 v27, 0
    v_mov_b32 v28, 0
    v_mov_b32 v29, 0
    v_mov_b32 v30, 0
    v_mov_b32 v31, 0
    v_mov_b32 v32, 0
    v_mov_b32 v33, 0
    v_mov_b32 v34, 0
    v_mov_b32 v35, 0
    v_add_u32 v3, 0x10000, v2
    v_add_u32 v4, 0x20000, v2
    s_waitcnt vmcnt(22)
    s_barrier
    ds_read_b128 v[36:39], v2 offset:0
    ds_read_b128 v[40:43], v2 offset:1024
    ds_read_b128 v[44:47], v2 offset:2048
    ds_read_b128 v[48:51], v2 offset:3072
    ds_read_b128 v[52:55], v2 offset:4096
    ds_read_b128 v[56:59], v2 offset:5120
    ds_read_b128 v[60:63], v2 offset:6144
    ds_read_b128 v[64:67], v2 offset:7168
    ds_read_b128 v[68:71], v2 offset:8192
    ds_read_b128 v[72:75], v2 offset:9216
    s_waitcnt vmcnt(21)
    s_waitcnt lgkmcnt(9)
    v_mfma_f32_16x16x32_bf16 v[16:19], v[36:39], a[0:3], v[16:19]
    s_add_u32 m0, s29, 61440
    s_add_u32 s33, s28, 61440
    buffer_load_dwordx4 v2, s[4:7], s33 offen offset:0 sc1 lds
    s_waitcnt lgkmcnt(8)
    v_mfma_f32_16x16x32_bf16 v[20:23], v[40:43], a[0:3], v[20:23]
    buffer_load_dwordx4 v2, s[4:7], s33 offen offset:1024 sc1 lds
    s_waitcnt lgkmcnt(7)
    v_mfma_f32_16x16x32_bf16 v[24:27], v[44:47], a[0:3], v[24:27]
    s_waitcnt lgkmcnt(6)
    v_mfma_f32_16x16x32_bf16 v[28:31], v[48:51], a[0:3], v[28:31]
    buffer_load_dwordx4 v2, s[4:7], s33 offen offset:2048 sc1 lds
    s_waitcnt lgkmcnt(5)
    v_mfma_f32_16x16x32_bf16 v[32:35], v[52:55], a[0:3], v[32:35]
    ds_read_b128 v[36:39], v2 offset:10240
    ds_read_b128 v[40:43], v2 offset:11264
    ds_read_b128 v[44:47], v2 offset:12288
    ds_read_b128 v[48:51], v2 offset:13312
    ds_read_b128 v[52:55], v2 offset:14336
    s_waitcnt vmcnt(23)
    s_waitcnt lgkmcnt(9)
    v_mfma_f32_16x16x32_bf16 v[16:19], v[56:59], a[4:7], v[16:19]
    buffer_load_dwordx4 v2, s[4:7], s33 offen offset:3072 sc1 lds
    s_waitcnt lgkmcnt(8)
    v_mfma_f32_16x16x32_bf16 v[20:23], v[60:63], a[4:7], v[20:23]
    s_add_u32 m0, s29, 65536
    s_add_u32 s33, s28, 65536
    buffer_load_dwordx4 v2, s[4:7], s33 offen offset:0 sc1 lds
    s_waitcnt lgkmcnt(7)
    v_mfma_f32_16x16x32_bf16 v[24:27], v[64:67], a[4:7], v[24:27]
    s_waitcnt lgkmcnt(6)
    v_mfma_f32_16x16x32_bf16 v[28:31], v[68:71], a[4:7], v[28:31]
    s_add_u32 s35, s25, 12288
    buffer_load_dwordx4 a[48:51], v2, s[4:7], s35 offen offset:0 sc1
    s_waitcnt lgkmcnt(5)
    v_mfma_f32_16x16x32_bf16 v[32:35], v[72:75], a[4:7], v[32:35]
    ds_read_b128 v[56:59], v2 offset:15360
    ds_read_b128 v[60:63], v2 offset:16384
    ds_read_b128 v[64:67], v2 offset:17408
    ds_read_b128 v[68:71], v2 offset:18432
    ds_read_b128 v[72:75], v2 offset:19456
    s_waitcnt vmcnt(25)
    s_waitcnt lgkmcnt(9)
    v_mfma_f32_16x16x32_bf16 v[16:19], v[36:39], a[8:11], v[16:19]
    buffer_load_dwordx4 a[52:55], v2, s[4:7], s35 offen offset:1024 sc1
    s_waitcnt lgkmcnt(8)
    v_mfma_f32_16x16x32_bf16 v[20:23], v[40:43], a[8:11], v[20:23]
    buffer_load_dwordx4 a[56:59], v2, s[4:7], s35 offen offset:2048 sc1
    s_waitcnt lgkmcnt(7)
    v_mfma_f32_16x16x32_bf16 v[24:27], v[44:47], a[8:11], v[24:27]
    s_waitcnt lgkmcnt(6)
    v_mfma_f32_16x16x32_bf16 v[28:31], v[48:51], a[8:11], v[28:31]
    buffer_load_dwordx4 a[60:63], v2, s[4:7], s35 offen offset:3072 sc1
    s_waitcnt lgkmcnt(5)
    v_mfma_f32_16x16x32_bf16 v[32:35], v[52:55], a[8:11], v[32:35]
    s_waitcnt vmcnt(22)
    s_barrier
    ds_read_b128 v[36:39], v2 offset:20480
    ds_read_b128 v[40:43], v2 offset:21504
    ds_read_b128 v[44:47], v2 offset:22528
    ds_read_b128 v[48:51], v2 offset:23552
    ds_read_b128 v[52:55], v2 offset:24576
    s_waitcnt lgkmcnt(9)
    v_mfma_f32_16x16x32_bf16 v[16:19], v[56:59], a[12:15], v[16:19]
    s_add_u32 m0, s29, 81920
    s_add_u32 s33, s28, 81920
    buffer_load_dwordx4 v2, s[4:7], s33 offen offset:0 sc1 lds
    s_waitcnt lgkmcnt(8)
    v_mfma_f32_16x16x32_bf16 v[20:23], v[60:63], a[12:15], v[20:23]
    buffer_load_dwordx4 v2, s[4:7], s33 offen offset:1024 sc1 lds
    s_waitcnt lgkmcnt(7)
    v_mfma_f32_16x16x32_bf16 v[24:27], v[64:67], a[12:15], v[24:27]
    s_waitcnt lgkmcnt(6)
    v_mfma_f32_16x16x32_bf16 v[28:31], v[68:71], a[12:15], v[28:31]
    buffer_load_dwordx4 v2, s[4:7], s33 offen offset:2048 sc1 lds
    s_waitcnt lgkmcnt(5)
    v_mfma_f32_16x16x32_bf16 v[32:35], v[72:75], a[12:15], v[32:35]
    ds_read_b128 v[56:59], v2 offset:25600
    ds_read_b128 v[60:63], v2 offset:26624
    ds_read_b128 v[64:67], v2 offset:27648
    ds_read_b128 v[68:71], v2 offset:28672
    ds_read_b128 v[72:75], v2 offset:29696
    s_waitcnt vmcnt(24)
    s_waitcnt lgkmcnt(9)
    v_mfma_f32_16x16x32_bf16 v[16:19], v[36:39], a[16:19], v[16:19]
    buffer_load_dwordx4 v2, s[4:7], s33 offen offset:3072 sc1 lds
    s_waitcnt lgkmcnt(8)
    v_mfma_f32_16x16x32_bf16 v[20:23], v[40:43], a[16:19], v[20:23]
    s_add_u32 m0, s29, 86016
    s_add_u32 s33, s28, 86016
    buffer_load_dwordx4 v2, s[4:7], s33 offen offset:0 sc1 lds
    s_waitcnt lgkmcnt(7)
    v_mfma_f32_16x16x32_bf16 v[24:27], v[44:47], a[16:19], v[24:27]
    s_waitcnt lgkmcnt(6)
    v_mfma_f32_16x16x32_bf16 v[28:31], v[48:51], a[16:19], v[28:31]
    s_add_u32 s35, s25, 16384
    buffer_load_dwordx4 a[64:67], v2, s[4:7], s35 offen offset:0 sc1
    s_waitcnt lgkmcnt(5)
    v_mfma_f32_16x16x32_bf16 v[32:35], v[52:55], a[16:19], v[32:35]
    ds_read_b128 v[36:39], v2 offset:30720
    ds_read_b128 v[40:43], v2 offset:31744
    ds_read_b128 v[44:47], v2 offset:32768
    ds_read_b128 v[48:51], v2 offset:33792
    ds_read_b128 v[52:55], v2 offset:34816
    s_waitcnt vmcnt(26)
    s_waitcnt lgkmcnt(9)
    v_mfma_f32_16x16x32_bf16 v[16:19], v[56:59], a[20:23], v[16:19]
    buffer_load_dwordx4 a[68:71], v2, s[4:7], s35 offen offset:1024 sc1
    s_waitcnt lgkmcnt(8)
    v_mfma_f32_16x16x32_bf16 v[20:23], v[60:63], a[20:23], v[20:23]
    buffer_load_dwordx4 a[72:75], v2, s[4:7], s35 offen offset:2048 sc1
    s_waitcnt lgkmcnt(7)
    v_mfma_f32_16x16x32_bf16 v[24:27], v[64:67], a[20:23], v[24:27]
    s_waitcnt lgkmcnt(6)
    v_mfma_f32_16x16x32_bf16 v[28:31], v[68:71], a[20:23], v[28:31]
    buffer_load_dwordx4 a[76:79], v2, s[4:7], s35 offen offset:3072 sc1
    s_waitcnt lgkmcnt(5)
    v_mfma_f32_16x16x32_bf16 v[32:35], v[72:75], a[20:23], v[32:35]
    ds_read_b128 v[56:59], v2 offset:35840
    ds_read_b128 v[60:63], v2 offset:36864
    ds_read_b128 v[64:67], v2 offset:37888
    ds_read_b128 v[68:71], v2 offset:38912
    ds_read_b128 v[72:75], v2 offset:39936
    s_waitcnt vmcnt(28)
    s_waitcnt lgkmcnt(9)
    v_mfma_f32_16x16x32_bf16 v[16:19], v[36:39], a[24:27], v[16:19]
    s_waitcnt lgkmcnt(8)
    v_mfma_f32_16x16x32_bf16 v[20:23], v[40:43], a[24:27], v[20:23]
    s_waitcnt lgkmcnt(7)
    v_mfma_f32_16x16x32_bf16 v[24:27], v[44:47], a[24:27], v[24:27]
    s_waitcnt lgkmcnt(6)
    v_mfma_f32_16x16x32_bf16 v[28:31], v[48:51], a[24:27], v[28:31]
    s_waitcnt lgkmcnt(5)
    v_mfma_f32_16x16x32_bf16 v[32:35], v[52:55], a[24:27], v[32:35]
    s_waitcnt vmcnt(22)
    s_barrier
    ds_read_b128 v[36:39], v2 offset:40960
    ds_read_b128 v[40:43], v2 offset:41984
    ds_read_b128 v[44:47], v2 offset:43008
    ds_read_b128 v[48:51], v2 offset:44032
    ds_read_b128 v[52:55], v2 offset:45056
    s_waitcnt lgkmcnt(9)
    v_mfma_f32_16x16x32_bf16 v[16:19], v[56:59], a[28:31], v[16:19]
    s_waitcnt lgkmcnt(8)
    v_mfma_f32_16x16x32_bf16 v[20:23], v[60:63], a[28:31], v[20:23]
    s_waitcnt lgkmcnt(7)
    v_mfma_f32_16x16x32_bf16 v[24:27], v[64:67], a[28:31], v[24:27]
    s_waitcnt lgkmcnt(6)
    v_mfma_f32_16x16x32_bf16 v[28:31], v[68:71], a[28:31], v[28:31]
    s_waitcnt lgkmcnt(5)
    v_mfma_f32_16x16x32_bf16 v[32:35], v[72:75], a[28:31], v[32:35]
    ds_read_b128 v[56:59], v2 offset:46080
    ds_read_b128 v[60:63], v2 offset:47104
    ds_read_b128 v[64:67], v2 offset:48128
    ds_read_b128 v[68:71], v2 offset:49152
    ds_read_b128 v[72:75], v2 offset:50176
    s_waitcnt vmcnt(21)
    s_waitcnt lgkmcnt(9)
    v_mfma_f32_16x16x32_bf16 v[16:19], v[36:39], a[32:35], v[16:19]
    s_waitcnt lgkmcnt(8)
    v_mfma_f32_16x16x32_bf16 v[20:23], v[40:43], a[32:35], v[20:23]
    s_waitcnt lgkmcnt(7)
    v_mfma_f32_16x16x32_bf16 v[24:27], v[44:47], a[32:35], v[24:27]
    s_waitcnt lgkmcnt(6)
    v_mfma_f32_16x16x32_bf16 v[28:31], v[48:51], a[32:35], v[28:31]
    s_waitcnt lgkmcnt(5)
    v_mfma_f32_16x16x32_bf16 v[32:35], v[52:55], a[32:35], v[32:35]
    ds_read_b128 v[36:39], v2 offset:51200
    ds_read_b128 v[40:43], v2 offset:52224
    ds_read_b128 v[44:47], v2 offset:53248
    ds_read_b128 v[48:51], v2 offset:54272
    ds_read_b128 v[52:55], v2 offset:55296
    s_waitcnt vmcnt(20)
    s_waitcnt lgkmcnt(9)
    v_mfma_f32_16x16x32_bf16 v[16:19], v[56:59], a[36:39], v[16:19]
    s_waitcnt lgkmcnt(8)
    v_mfma_f32_16x16x32_bf16 v[20:23], v[60:63], a[36:39], v[20:23]
    s_waitcnt lgkmcnt(7)
    v_mfma_f32_16x16x32_bf16 v[24:27], v[64:67], a[36:39], v[24:27]
    s_waitcnt lgkmcnt(6)
    v_mfma_f32_16x16x32_bf16 v[28:31], v[68:71], a[36:39], v[28:31]
    s_waitcnt lgkmcnt(5)
    v_mfma_f32_16x16x32_bf16 v[32:35], v[72:75], a[36:39], v[32:35]
    ds_read_b128 v[56:59], v2 offset:56320
    ds_read_b128 v[60:63], v2 offset:57344
    ds_read_b128 v[64:67], v2 offset:58368
    ds_read_b128 v[68:71], v2 offset:59392
    ds_read_b128 v[72:75], v2 offset:60416
    s_waitcnt vmcnt(19)
    s_waitcnt lgkmcnt(9)
    v_mfma_f32_16x16x32_bf16 v[16:19], v[36:39], a[40:43], v[16:19]
    s_waitcnt lgkmcnt(8)
    v_mfma_f32_16x16x32_bf16 v[20:23], v[40:43], a[40:43], v[20:23]
    s_waitcnt lgkmcnt(7)
    v_mfma_f32_16x16x32_bf16 v[24:27], v[44:47], a[40:43], v[24:27]
    s_waitcnt lgkmcnt(6)
    v_mfma_f32_16x16x32_bf16 v[28:31], v[48:51], a[40:43], v[28:31]
    s_waitcnt lgkmcnt(5)
    v_mfma_f32_16x16x32_bf16 v[32:35], v[52:55], a[40:43], v[32:35]
    s_waitcnt vmcnt(13)
    s_barrier
    ds_read_b128 v[36:39], v2 offset:61440
    ds_read_b128 v[40:43], v2 offset:62464
    ds_read_b128 v[44:47], v2 offset:63488
    ds_read_b128 v[48:51], v2 offset:64512
    ds_read_b128 v[52:55], v3 offset:0
    s_waitcnt lgkmcnt(9)
    v_mfma_f32_16x16x32_bf16 v[16:19], v[56:59], a[44:47], v[16:19]
    s_waitcnt lgkmcnt(8)
    v_mfma_f32_16x16x32_bf16 v[20:23], v[60:63], a[44:47], v[20:23]
    s_waitcnt lgkmcnt(7)
    v_mfma_f32_16x16x32_bf16 v[24:27], v[64:67], a[44:47], v[24:27]
    s_waitcnt lgkmcnt(6)
    v_mfma_f32_16x16x32_bf16 v[28:31], v[68:71], a[44:47], v[28:31]
    s_waitcnt lgkmcnt(5)
    v_mfma_f32_16x16x32_bf16 v[32:35], v[72:75], a[44:47], v[32:35]
    ds_read_b128 v[56:59], v3 offset:1024
    ds_read_b128 v[60:63], v3 offset:2048
    ds_read_b128 v[64:67], v3 offset:3072
    ds_read_b128 v[68:71], v3 offset:4096
    ds_read_b128 v[72:75], v3 offset:5120
    s_waitcnt vmcnt(12)
    s_waitcnt lgkmcnt(9)
    v_mfma_f32_16x16x32_bf16 v[16:19], v[36:39], a[48:51], v[16:19]
    s_waitcnt lgkmcnt(8)
    v_mfma_f32_16x16x32_bf16 v[20:23], v[40:43], a[48:51], v[20:23]
    s_waitcnt lgkmcnt(7)
    v_mfma_f32_16x16x32_bf16 v[24:27], v[44:47], a[48:51], v[24:27]
    s_waitcnt lgkmcnt(6)
    v_mfma_f32_16x16x32_bf16 v[28:31], v[48:51], a[48:51], v[28:31]
    s_waitcnt lgkmcnt(5)
    v_mfma_f32_16x16x32_bf16 v[32:35], v[52:55], a[48:51], v[32:35]
    ds_read_b128 v[36:39], v3 offset:6144
    ds_read_b128 v[40:43], v3 offset:7168
    ds_read_b128 v[44:47], v3 offset:8192
    ds_read_b128 v[48:51], v3 offset:9216
    ds_read_b128 v[52:55], v3 offset:10240
    s_waitcnt vmcnt(11)
    s_waitcnt lgkmcnt(9)
    v_mfma_f32_16x16x32_bf16 v[16:19], v[56:59], a[52:55], v[16:19]
    s_waitcnt lgkmcnt(8)
    v_mfma_f32_16x16x32_bf16 v[20:23], v[60:63], a[52:55], v[20:23]
    s_waitcnt lgkmcnt(7)
    v_mfma_f32_16x16x32_bf16 v[24:27], v[64:67], a[52:55], v[24:27]
    s_waitcnt lgkmcnt(6)
    v_mfma_f32_16x16x32_bf16 v[28:31], v[68:71], a[52:55], v[28:31]
    s_waitcnt lgkmcnt(5)
    v_mfma_f32_16x16x32_bf16 v[32:35], v[72:75], a[52:55], v[32:35]
    ds_read_b128 v[56:59], v3 offset:11264
    ds_read_b128 v[60:63], v3 offset:12288
    ds_read_b128 v[64:67], v3 offset:13312
    ds_read_b128 v[68:71], v3 offset:14336
    ds_read_b128 v[72:75], v3 offset:15360
    s_waitcnt vmcnt(10)
    s_waitcnt lgkmcnt(9)
    v_mfma_f32_16x16x32_bf16 v[16:19], v[36:39], a[56:59], v[16:19]
    s_waitcnt lgkmcnt(8)
    v_mfma_f32_16x16x32_bf16 v[20:23], v[40:43], a[56:59], v[20:23]
    s_waitcnt lgkmcnt(7)
    v_mfma_f32_16x16x32_bf16 v[24:27], v[44:47], a[56:59], v[24:27]
    s_waitcnt lgkmcnt(6)
    v_mfma_f32_16x16x32_bf16 v[28:31], v[48:51], a[56:59], v[28:31]
    s_waitcnt lgkmcnt(5)
    v_mfma_f32_16x16x32_bf16 v[32:35], v[52:55], a[56:59], v[32:35]
    s_waitcnt vmcnt(4)
    s_barrier
    ds_read_b128 v[36:39], v3 offset:16384
    ds_read_b128 v[40:43], v3 offset:17408
    ds_read_b128 v[44:47], v3 offset:18432
    ds_read_b128 v[48:51], v3 offset:19456
    ds_read_b128 v[52:55], v3 offset:20480
    s_waitcnt lgkmcnt(9)
    v_mfma_f32_16x16x32_bf16 v[16:19], v[56:59], a[60:63], v[16:19]
    s_waitcnt lgkmcnt(8)
    v_mfma_f32_16x16x32_bf16 v[20:23], v[60:63], a[60:63], v[20:23]
    s_waitcnt lgkmcnt(7)
    v_mfma_f32_16x16x32_bf16 v[24:27], v[64:67], a[60:63], v[24:27]
    s_waitcnt lgkmcnt(6)
    v_mfma_f32_16x16x32_bf16 v[28:31], v[68:71], a[60:63], v[28:31]
    s_waitcnt lgkmcnt(5)
    v_mfma_f32_16x16x32_bf16 v[32:35], v[72:75], a[60:63], v[32:35]
    ds_read_b128 v[56:59], v3 offset:21504
    ds_read_b128 v[60:63], v3 offset:22528
    ds_read_b128 v[64:67], v3 offset:23552
    ds_read_b128 v[68:71], v3 offset:24576
    ds_read_b128 v[72:75], v3 offset:25600
    s_waitcnt vmcnt(3)
    s_waitcnt lgkmcnt(9)
    v_mfma_f32_16x16x32_bf16 v[16:19], v[36:39], a[64:67], v[16:19]
    s_waitcnt lgkmcnt(8)
    v_mfma_f32_16x16x32_bf16 v[20:23], v[40:43], a[64:67], v[20:23]
    s_waitcnt lgkmcnt(7)
    v_mfma_f32_16x16x32_bf16 v[24:27], v[44:47], a[64:67], v[24:27]
    s_waitcnt lgkmcnt(6)
    v_mfma_f32_16x16x32_bf16 v[28:31], v[48:51], a[64:67], v[28:31]
    s_waitcnt lgkmcnt(5)
    v_mfma_f32_16x16x32_bf16 v[32:35], v[52:55], a[64:67], v[32:35]
    ds_read_b128 v[36:39], v3 offset:26624
    ds_read_b128 v[40:43], v3 offset:27648
    ds_read_b128 v[44:47], v3 offset:28672
    ds_read_b128 v[48:51], v3 offset:29696
    ds_read_b128 v[52:55], v3 offset:30720
    s_waitcnt vmcnt(2)
    s_waitcnt lgkmcnt(9)
    v_mfma_f32_16x16x32_bf16 v[16:19], v[56:59], a[68:71], v[16:19]
    s_waitcnt lgkmcnt(8)
    v_mfma_f32_16x16x32_bf16 v[20:23], v[60:63], a[68:71], v[20:23]
    s_waitcnt lgkmcnt(7)
    v_mfma_f32_16x16x32_bf16 v[24:27], v[64:67], a[68:71], v[24:27]
    s_waitcnt lgkmcnt(6)
    v_mfma_f32_16x16x32_bf16 v[28:31], v[68:71], a[68:71], v[28:31]
    s_waitcnt lgkmcnt(5)
    v_mfma_f32_16x16x32_bf16 v[32:35], v[72:75], a[68:71], v[32:35]
    ds_read_b128 v[56:59], v3 offset:31744
    ds_read_b128 v[60:63], v3 offset:32768
    ds_read_b128 v[64:67], v3 offset:33792
    ds_read_b128 v[68:71], v3 offset:34816
    ds_read_b128 v[72:75], v3 offset:35840
    s_waitcnt vmcnt(1)
    s_waitcnt lgkmcnt(9)
    v_mfma_f32_16x16x32_bf16 v[16:19], v[36:39], a[72:75], v[16:19]
    s_waitcnt lgkmcnt(8)
    v_mfma_f32_16x16x32_bf16 v[20:23], v[40:43], a[72:75], v[20:23]
    s_waitcnt lgkmcnt(7)
    v_mfma_f32_16x16x32_bf16 v[24:27], v[44:47], a[72:75], v[24:27]
    s_waitcnt lgkmcnt(6)
    v_mfma_f32_16x16x32_bf16 v[28:31], v[48:51], a[72:75], v[28:31]
    s_waitcnt lgkmcnt(5)
    v_mfma_f32_16x16x32_bf16 v[32:35], v[52:55], a[72:75], v[32:35]
    s_waitcnt vmcnt(0)
    s_waitcnt lgkmcnt(4)
    v_mfma_f32_16x16x32_bf16 v[16:19], v[56:59], a[76:79], v[16:19]
    s_waitcnt lgkmcnt(3)
    v_mfma_f32_16x16x32_bf16 v[20:23], v[60:63], a[76:79], v[20:23]
    s_waitcnt lgkmcnt(2)
    v_mfma_f32_16x16x32_bf16 v[24:27], v[64:67], a[76:79], v[24:27]
    s_waitcnt lgkmcnt(1)
    v_mfma_f32_16x16x32_bf16 v[28:31], v[68:71], a[76:79], v[28:31]
    s_waitcnt lgkmcnt(0)
    v_mfma_f32_16x16x32_bf16 v[32:35], v[72:75], a[76:79], v[32:35]
    s_nop 7
    s_mov_b32 s40, 0xbdd2d3e8
    v_mov_b32 v5, 0xc0135761
    v_mul_f32 v40, v16, v16
    v_mul_f32 v41, v17, v17
    v_mul_f32 v42, v18, v18
    v_mul_f32 v43, v19, v19
    v_mul_f32 v44, v20, v20
    v_mul_f32 v45, v21, v21
    v_mul_f32 v46, v22, v22
    v_mul_f32 v47, v23, v23
    v_mul_f32 v48, v24, v24
    v_mul_f32 v49, v25, v25
    v_mul_f32 v50, v26, v26
    v_mul_f32 v51, v27, v27
    v_mul_f32 v52, v28, v28
    v_mul_f32 v53, v29, v29
    v_mul_f32 v54, v30, v30
    v_mul_f32 v55, v31, v31
    v_mul_f32 v56, v32, v32
    v_mul_f32 v57, v33, v33
    v_mul_f32 v58, v34, v34
    v_mul_f32 v59, v35, v35
    v_fma_f32 v40, v40, s40, v5
    v_fma_f32 v41, v41, s40, v5
    v_fma_f32 v42, v42, s40, v5
    v_fma_f32 v43, v43, s40, v5
    v_fma_f32 v44, v44, s40, v5
    v_fma_f32 v45, v45, s40, v5
    v_fma_f32 v46, v46, s40, v5
    v_fma_f32 v47, v47, s40, v5
    v_fma_f32 v48, v48, s40, v5
    v_fma_f32 v49, v49, s40, v5
    v_fma_f32 v50, v50, s40, v5
    v_fma_f32 v51, v51, s40, v5
    v_fma_f32 v52, v52, s40, v5
    v_fma_f32 v53, v53, s40, v5
    v_fma_f32 v54, v54, s40, v5
    v_fma_f32 v55, v55, s40, v5
    v_fma_f32 v56, v56, s40, v5
    v_fma_f32 v57, v57, s40, v5
    v_fma_f32 v58, v58, s40, v5
    v_fma_f32 v59, v59, s40, v5
    v_mul_f32 v40, v40, v16
    v_mul_f32 v41, v41, v17
    v_mul_f32 v42, v42, v18
    v_mul_f32 v43, v43, v19
    v_mul_f32 v44, v44, v20
    v_mul_f32 v45, v45, v21
    v_mul_f32 v46, v46, v22
    v_mul_f32 v47, v47, v23
    v_mul_f32 v48, v48, v24
    v_mul_f32 v49, v49, v25
    v_mul_f32 v50, v50, v26
    v_mul_f32 v51, v51, v27
    v_mul_f32 v52, v52, v28
    v_mul_f32 v53, v53, v29
    v_mul_f32 v54, v54, v30
    v_mul_f32 v55, v55, v31
    v_mul_f32 v56, v56, v32
    v_mul_f32 v57, v57, v33
    v_mul_f32 v58, v58, v34
    v_mul_f32 v59, v59, v35
    v_exp_f32 v40, v40
    v_exp_f32 v41, v41
    v_exp_f32 v42, v42
    v_exp_f32 v43, v43
    v_exp_f32 v44, v44
    v_exp_f32 v45, v45
    v_exp_f32 v46, v46
    v_exp_f32 v47, v47
    v_exp_f32 v48, v48
    v_exp_f32 v49, v49
    v_exp_f32 v50, v50
    v_exp_f32 v51, v51
    v_exp_f32 v52, v52
    v_exp_f32 v53, v53
    v_exp_f32 v54, v54
    v_exp_f32 v55, v55
    v_exp_f32 v56, v56
    v_exp_f32 v57, v57
    v_exp_f32 v58, v58
    v_exp_f32 v59, v59
    v_add_f32 v40, 1.0, v40
    v_add_f32 v41, 1.0, v41
    v_add_f32 v42, 1.0, v42
    v_add_f32 v43, 1.0, v43
    v_add_f32 v44, 1.0, v44
    v_add_f32 v45, 1.0, v45
    v_add_f32 v46, 1.0, v46
    v_add_f32 v47, 1.0, v47
    v_add_f32 v48, 1.0, v48
    v_add_f32 v49, 1.0, v49
    v_add_f32 v50, 1.0, v50
    v_add_f32 v51, 1.0, v51
    v_add_f32 v52, 1.0, v52
    v_add_f32 v53, 1.0, v53
    v_add_f32 v54, 1.0, v54
    v_add_f32 v55, 1.0, v55
    v_add_f32 v56, 1.0, v56
    v_add_f32 v57, 1.0, v57
    v_add_f32 v58, 1.0, v58
    v_add_f32 v59, 1.0, v59
    v_rcp_f32 v40, v40
    v_rcp_f32 v41, v41
    v_rcp_f32 v42, v42
    v_rcp_f32 v43, v43
    v_rcp_f32 v44, v44
    v_rcp_f32 v45, v45
    v_rcp_f32 v46, v46
    v_rcp_f32 v47, v47
    v_rcp_f32 v48, v48
    v_rcp_f32 v49, v49
    v_rcp_f32 v50, v50
    v_rcp_f32 v51, v51
    v_rcp_f32 v52, v52
    v_rcp_f32 v53, v53
    v_rcp_f32 v54, v54
    v_rcp_f32 v55, v55
    v_rcp_f32 v56, v56
    v_rcp_f32 v57, v57
    v_rcp_f32 v58, v58
    v_rcp_f32 v59, v59
    v_mul_f32 v16, v16, v40
    v_mul_f32 v17, v17, v41
    v_mul_f32 v18, v18, v42
    v_mul_f32 v19, v19, v43
    v_mul_f32 v20, v20, v44
    v_mul_f32 v21, v21, v45
    v_mul_f32 v22, v22, v46
    v_mul_f32 v23, v23, v47
    v_mul_f32 v24, v24, v48
    v_mul_f32 v25, v25, v49
    v_mul_f32 v26, v26, v50
    v_mul_f32 v27, v27, v51
    v_mul_f32 v28, v28, v52
    v_mul_f32 v29, v29, v53
    v_mul_f32 v30, v30, v54
    v_mul_f32 v31, v31, v55
    v_mul_f32 v32, v32, v56
    v_mul_f32 v33, v33, v57
    v_mul_f32 v34, v34, v58
    v_mul_f32 v35, v35, v59
    s_lshr_b32 s36, s22, 1
    s_lshr_b32 s37, s36, 1
    s_add_u32 s37, s37, 1
    s_sub_u32 s38, 0, s37
    s_bitcmp1_b32 s36, 0
    s_cselect_b32 s37, s38, s37
    s_lshl_b32 s38, s24, 4
    s_add_u32 s38, s38, s37
    v_and_b32 v6, 15, v1
    v_add_u32 v6, s38, v6
    v_cmp_gt_u32 vcc, 0x800, v6
    v_and_b32 v6, 0x7ff, v6
    v_lshrrev_b32 v7, 4, v6
    v_mul_u32_u24 v7, 20480, v7
    v_and_b32 v6, 15, v6
    v_lshl_add_u32 v7, v6, 4, v7
    v_lshrrev_b32 v6, 4, v1
    v_lshl_add_u32 v7, v6, 8, v7
    v_cvt_pk_bf16_f32 v40, v16, v17
    v_cndmask_b32 v40, 0, v40, vcc
    v_cvt_pk_bf16_f32 v41, v18, v19
    v_cndmask_b32 v41, 0, v41, vcc
    v_cvt_pk_bf16_f32 v42, v20, v21
    v_cndmask_b32 v42, 0, v42, vcc
    v_cvt_pk_bf16_f32 v43, v22, v23
    v_cndmask_b32 v43, 0, v43, vcc
    v_cvt_pk_bf16_f32 v44, v24, v25
    v_cndmask_b32 v44, 0, v44, vcc
    v_cvt_pk_bf16_f32 v45, v26, v27
    v_cndmask_b32 v45, 0, v45, vcc
    v_cvt_pk_bf16_f32 v46, v28, v29
    v_cndmask_b32 v46, 0, v46, vcc
    v_cvt_pk_bf16_f32 v47, v30, v31
    v_cndmask_b32 v47, 0, v47, vcc
    v_cvt_pk_bf16_f32 v48, v32, v33
    v_cndmask_b32 v48, 0, v48, vcc
    v_cvt_pk_bf16_f32 v49, v34, v35
    v_cndmask_b32 v49, 0, v49, vcc
    s_mul_i32 s39, s22, 5
    s_lshr_b32 s39, s39, 1
    s_lshl_b32 s39, s39, 10
    s_add_u32 s39, s39, 5242880
    s_bitcmp1_b32 s22, 0
    s_cbranch_scc1 Par7_odd
    buffer_store_dwordx4 v[40:43], v7, s[4:7], s39 offen offset:0 sc1
    buffer_store_dwordx4 v[44:47], v7, s[4:7], s39 offen offset:1024 sc1
    buffer_store_dwordx2 v[48:49], v7, s[4:7], s39 offen offset:2048 sc1
    s_branch Par7_j
Par7_odd:
    buffer_store_dwordx2 v[40:41], v7, s[4:7], s39 offen offset:8 sc1
    buffer_store_dwordx4 v[42:45], v7, s[4:7], s39 offen offset:1024 sc1
    buffer_store_dwordx4 v[46:49], v7, s[4:7], s39 offen offset:2048 sc1
Par7_j:
    s_waitcnt vmcnt(0)
    s_barrier
    s_cmp_lg_u32 s30, 0
    s_cbranch_scc1 Lsig8
    s_lshl_b32 s20, s21, 7
    s_lshl_b32 s23, s22, 2
    s_add_u32 s20, s20, s23
    s_add_u32 s20, s20, 29888512
    v_mov_b32 v14, s31
    v_mov_b32 v15, 0
    s_mov_b64 exec, 1
    buffer_store_dword v14, v15, s[4:7], s20 offen sc1
    s_mov_b64 exec, -1
Lsig8:
    s_mov_b32 s46, 29885440
    s_mov_b32 s47, 0x40000
Lpoll9:
    buffer_load_dwordx4 v[12:15], v2, s[4:7], s46 offen sc1
    s_waitcnt vmcnt(0)
    v_xor_b32 v12, s31, v12
    v_xor_b32 v13, s31, v13
    v_xor_b32 v14, s31, v14
    v_xor_b32 v15, s31, v15
    v_or3_b32 v12, v12, v13, v14
    v_or_b32 v12, v12, v15
    v_cmp_ne_u32 vcc, 0, v12
    s_sub_u32 s47, s47, 1
    s_cmp_eq_u32 s47, 0
    s_cbranch_scc1 Lpoll9_x
    s_nop 2
    s_cbranch_vccnz Lpoll9
Lpoll9_x:
    s_lshl_b32 s24, s21, 2
    s_add_u32 s24, s24, s30
    s_mul_i32 s24, s24, 1
    s_mul_i32 s25, s24, 20480
    s_add_u32 s25, s25, 5242880
    s_add_u32 s26, s25, 20480
    s_mul_i32 s27, s22, 102400
    s_add_u32 s27, s27, 17825792
    s_mul_i32 s29, s30, 5120
    s_add_u32 s28, s27, s29
    s_mul_i32 s39, s22, 5
    s_lshr_b32 s39, s39, 1
    s_lshl_b32 s39, s39, 10
    s_mul_i32 s38, s24, 20480
    s_add_u32 s39, s39, s38
    s_add_u32 s38, s39, 0
    s_bitcmp1_b32 s22, 0
    s_cbranch_scc1 Par10_odd
    buffer_load_dwordx4 v[136:139], v2, s[4:7], s38 offen offset:0 sc1
    buffer_load_dwordx4 v[140:143], v2, s[4:7], s38 offen offset:1024 sc1
    buffer_load_dwordx2 v[144:145], v2, s[4:7], s38 offen offset:2048 sc1
    s_branch Par10_j
Par10_odd:
    buffer_load_dwordx2 v[136:137], v2, s[4:7], s38 offen offset:8 sc1
    buffer_load_dwordx4 v[138:141], v2, s[4:7], s38 offen offset:1024 sc1
    buffer_load_dwordx4 v[142:145], v2, s[4:7], s38 offen offset:2048 sc1
Par10_j:
    s_cmp_lg_u32 s30, 3
    s_cbranch_scc1 L_g1c
    s_mov_b32 m0, 0
    s_add_u32 s33, s27, 0
    buffer_load_dwordx4 v2, s[4:7], s33 offen offset:0 sc1 lds
    buffer_load_dwordx4 v2, s[4:7], s33 offen offset:1024 sc1 lds
    buffer_load_dwordx4 v2, s[4:7], s33 offen offset:2048 sc1 lds
    buffer_load_dwordx4 v2, s[4:7], s33 offen offset:3072 sc1 lds
    s_mov_b32 m0, 4096
    s_add_u32 s33, s27, 4096
    buffer_load_dwordx4 v2, s[4:7], s33 offen offset:0 sc1 lds
    buffer_load_dwordx4 v2, s[4:7], s33 offen offset:1024 sc1 lds
    buffer_load_dwordx4 v2, s[4:7], s33 offen offset:2048 sc1 lds
    buffer_load_dwordx4 v2, s[4:7], s33 offen offset:3072 sc1 lds
    s_mov_b32 m0, 8192
    s_add_u32 s33, s27, 8192
    buffer_load_dwordx4 v2, s[4:7], s33 offen offset:0 sc1 lds
    buffer_load_dwordx4 v2, s[4:7], s33 offen offset:1024 sc1 lds
    buffer_load_dwordx4 v2, s[4:7], s33 offen offset:2048 sc1 lds
    buffer_load_dwordx4 v2, s[4:7], s33 offen offset:3072 sc1 lds
    s_mov_b32 m0, 12288
    s_add_u32 s33, s27, 12288
    buffer_load_dwordx4 v2, s[4:7], s33 offen offset:0 sc1 lds
    buffer_load_dwordx4 v2, s[4:7], s33 offen offset:1024 sc1 lds
    buffer_load_dwordx4 v2, s[4:7], s33 offen offset:2048 sc1 lds
    buffer_load_dwordx4 v2, s[4:7], s33 offen offset:3072 sc1 lds
    s_mov_b32 m0, 16384
    s_add_u32 s33, s27, 16384
    buffer_load_dwordx4 v2, s[4:7], s33 offen offset:0 sc1 lds
    buffer_load_dwordx4 v2, s[4:7], s33 offen offset:1024 sc1 lds
    buffer_load_dwordx4 v2, s[4:7], s33 offen offset:2048 sc1 lds
    buffer_load_dwordx4 v2, s[4:7], s33 offen offset:3072 sc1 lds
    s_mov_b32 m0, 20480
    s_add_u32 s33, s27, 20480
    buffer_load_dwordx4 v2, s[4:7], s33 offen offset:0 sc1 lds
    buffer_load_dwordx4 v2, s[4:7], s33 offen offset:1024 sc1 lds
    buffer_load_dwordx4 v2, s[4:7], s33 offen offset:2048 sc1 lds
    buffer_load_dwordx4 v2, s[4:7], s33 offen offset:3072 sc1 lds
    s_mov_b32 m0, 24576
    s_add_u32 s33, s27, 24576
    buffer_load_dwordx4 v2, s[4:7], s33 offen offset:0 sc1 lds
    buffer_load_dwordx4 v2, s[4:7], s33 offen offset:1024 sc1 lds
    buffer_load_dwordx4 v2, s[4:7], s33 offen offset:2048 sc1 lds
    buffer_load_dwordx4 v2, s[4:7], s33 offen offset:3072 sc1 lds
    s_mov_b32 m0, 28672
    s_add_u32 s33, s27, 28672
    buffer_load_dwordx4 v2, s[4:7], s33 offen offset:0 sc1 lds
    buffer_load_dwordx4 v2, s[4:7], s33 offen offset:1024 sc1 lds
    buffer_load_dwordx4 v2, s[4:7], s33 offen offset:2048 sc1 lds
    buffer_load_dwordx4 v2, s[4:7], s33 offen offset:3072 sc1 lds
    s_mov_b32 m0, 32768
    s_add_u32 s33, s27, 32768
    buffer_load_dwordx4 v2, s[4:7], s33 offen offset:0 sc1 lds
    buffer_load_dwordx4 v2, s[4:7], s33 offen offset:1024 sc1 lds
    buffer_load_dwordx4 v2, s[4:7], s33 offen offset:2048 sc1 lds
    buffer_load_dwordx4 v2, s[4:7], s33 offen offset:3072 sc1 lds
    s_mov_b32 m0, 36864
    s_add_u32 s33, s27, 36864
    buffer_load_dwordx4 v2, s[4:7], s33 offen offset:0 sc1 lds
    buffer_load_dwordx4 v2, s[4:7], s33 offen offset:1024 sc1 lds
    buffer_load_dwordx4 v2, s[4:7], s33 offen offset:2048 sc1 lds
    buffer_load_dwordx4 v2, s[4:7], s33 offen offset:3072 sc1 lds
    s_mov_b32 m0, 40960
    s_add_u32 s33, s27, 40960
    buffer_load_dwordx4 v2, s[4:7], s33 offen offset:0 sc1 lds
    buffer_load_dwordx4 v2, s[4:7], s33 offen offset:1024 sc1 lds
    buffer_load_dwordx4 v2, s[4:7], s33 offen offset:2048 sc1 lds
    buffer_load_dwordx4 v2, s[4:7], s33 offen offset:3072 sc1 lds
    s_mov_b32 m0, 45056
    s_add_u32 s33, s27, 45056
    buffer_load_dwordx4 v2, s[4:7], s33 offen offset:0 sc1 lds
    buffer_load_dwordx4 v2, s[4:7], s33 offen offset:1024 sc1 lds
    buffer_load_dwordx4 v2, s[4:7], s33 offen offset:2048 sc1 lds
    buffer_load_dwordx4 v2, s[4:7], s33 offen offset:3072 sc1 lds
    s_mov_b32 m0, 49152
    s_add_u32 s33, s27, 49152
    buffer_load_dwordx4 v2, s[4:7], s33 offen offset:0 sc1 lds
    buffer_load_dwordx4 v2, s[4:7], s33 offen offset:1024 sc1 lds
    buffer_load_dwordx4 v2, s[4:7], s33 offen offset:2048 sc1 lds
    buffer_load_dwordx4 v2, s[4:7], s33 offen offset:3072 sc1 lds
    s_mov_b32 m0, 53248
    s_add_u32 s33, s27, 53248
    buffer_load_dwordx4 v2, s[4:7], s33 offen offset:0 sc1 lds
    buffer_load_dwordx4 v2, s[4:7], s33 offen offset:1024 sc1 lds
    buffer_load_dwordx4 v2, s[4:7], s33 offen offset:2048 sc1 lds
    buffer_load_dwordx4 v2, s[4:7], s33 offen offset:3072 sc1 lds
    s_mov_b32 m0, 57344
    s_add_u32 s33, s27, 57344
    s_waitcnt vmcnt(52)
    buffer_load_dwordx4 v2, s[4:7], s33 offen offset:0 sc1 lds
    buffer_load_dwordx4 v2, s[4:7], s33 offen offset:1024 sc1 lds
    buffer_load_dwordx4 v2, s[4:7], s33 offen offset:2048 sc1 lds
    buffer_load_dwordx4 v2, s[4:7], s33 offen offset:3072 sc1 lds
    s_mov_b32 m0, 61440
    s_add_u32 s33, s27, 61440
    s_waitcnt vmcnt(52)
    buffer_load_dwordx4 v2, s[4:7], s33 offen offset:0 sc1 lds
    buffer_load_dwordx4 v2, s[4:7], s33 offen offset:1024 sc1 lds
    buffer_load_dwordx4 v2, s[4:7], s33 offen offset:2048 sc1 lds
    buffer_load_dwordx4 v2, s[4:7], s33 offen offset:3072 sc1 lds
    s_mov_b32 m0, 65536
    s_add_u32 s33, s27, 65536
    s_waitcnt vmcnt(52)
    buffer_load_dwordx4 v2, s[4:7], s33 offen offset:0 sc1 lds
    buffer_load_dwordx4 v2, s[4:7], s33 offen offset:1024 sc1 lds
    buffer_load_dwordx4 v2, s[4:7], s33 offen offset:2048 sc1 lds
    buffer_load_dwordx4 v2, s[4:7], s33 offen offset:3072 sc1 lds
    s_mov_b32 m0, 69632
    s_add_u32 s33, s27, 69632
    s_waitcnt vmcnt(52)
    buffer_load_dwordx4 v2, s[4:7], s33 offen offset:0 sc1 lds
    buffer_load_dwordx4 v2, s[4:7], s33 offen offset:1024 sc1 lds
    buffer_load_dwordx4 v2, s[4:7], s33 offen offset:2048 sc1 lds
    buffer_load_dwordx4 v2, s[4:7], s33 offen offset:3072 sc1 lds
    s_mov_b32 m0, 73728
    s_add_u32 s33, s27, 73728
    s_waitcnt vmcnt(52)
    buffer_load_dwordx4 v2, s[4:7], s33 offen offset:0 sc1 lds
    buffer_load_dwordx4 v2, s[4:7], s33 offen offset:1024 sc1 lds
    buffer_load_dwordx4 v2, s[4:7], s33 offen offset:2048 sc1 lds
    buffer_load_dwordx4 v2, s[4:7], s33 offen offset:3072 sc1 lds
    s_mov_b32 m0, 77824
    s_add_u32 s33, s27, 77824
    s_waitcnt vmcnt(52)
    buffer_load_dwordx4 v2, s[4:7], s33 offen offset:0 sc1 lds
    buffer_load_dwordx4 v2, s[4:7], s33 offen offset:1024 sc1 lds
    buffer_load_dwordx4 v2, s[4:7], s33 offen offset:2048 sc1 lds
    buffer_load_dwordx4 v2, s[4:7], s33 offen offset:3072 sc1 lds
    s_mov_b32 m0, 81920
    s_add_u32 s33, s27, 81920
    s_waitcnt vmcnt(52)
    buffer_load_dwordx4 v2, s[4:7], s33 offen offset:0 sc1 lds
    buffer_load_dwordx4 v2, s[4:7], s33 offen offset:1024 sc1 lds
    buffer_load_dwordx4 v2, s[4:7], s33 offen offset:2048 sc1 lds
    buffer_load_dwordx4 v2, s[4:7], s33 offen offset:3072 sc1 lds
    s_mov_b32 m0, 86016
    s_add_u32 s33, s27, 86016
    s_waitcnt vmcnt(52)
    buffer_load_dwordx4 v2, s[4:7], s33 offen offset:0 sc1 lds
    buffer_load_dwordx4 v2, s[4:7], s33 offen offset:1024 sc1 lds
    buffer_load_dwordx4 v2, s[4:7], s33 offen offset:2048 sc1 lds
    buffer_load_dwordx4 v2, s[4:7], s33 offen offset:3072 sc1 lds
    s_mov_b32 m0, 90112
    s_add_u32 s33, s27, 90112
    s_waitcnt vmcnt(52)
    buffer_load_dwordx4 v2, s[4:7], s33 offen offset:0 sc1 lds
    buffer_load_dwordx4 v2, s[4:7], s33 offen offset:1024 sc1 lds
    buffer_load_dwordx4 v2, s[4:7], s33 offen offset:2048 sc1 lds
    buffer_load_dwordx4 v2, s[4:7], s33 offen offset:3072 sc1 lds
    s_mov_b32 m0, 94208
    s_add_u32 s33, s27, 94208
    s_waitcnt vmcnt(52)
    buffer_load_dwordx4 v2, s[4:7], s33 offen offset:0 sc1 lds
    buffer_load_dwordx4 v2, s[4:7], s33 offen offset:1024 sc1 lds
    buffer_load_dwordx4 v2, s[4:7], s33 offen offset:2048 sc1 lds
    buffer_load_dwordx4 v2, s[4:7], s33 offen offset:3072 sc1 lds
    s_mov_b32 m0, 98304
    s_add_u32 s33, s27, 98304
    s_waitcnt vmcnt(52)
    buffer_load_dwordx4 v2, s[4:7], s33 offen offset:0 sc1 lds
    buffer_load_dwordx4 v2, s[4:7], s33 offen offset:1024 sc1 lds
    buffer_load_dwordx4 v2, s[4:7], s33 offen offset:2048 sc1 lds
    buffer_load_dwordx4 v2, s[4:7], s33 offen offset:3072 sc1 lds
    v_bfe_u32 v5, v1, 3, 2
    v_lshrrev_b32 v6, 1, v5
    v_and_b32 v5, 1, v5
    v_sub_u32 v6, v6, v5
    v_add_u32 v6, s21, v6
    v_and_b32 v6, 31, v6
    v_and_b32 v5, 7, v1
    v_lshlrev_b32 v5, 2, v5
    v_lshl_add_u32 v5, v6, 7, v5
    s_mov_b32 s46, 29888512
    s_mov_b32 s47, 0x40000
Lpoll11:
    buffer_load_dword v12, v5, s[4:7], s46 offen sc1
    s_waitcnt vmcnt(0)
    v_cmp_ne_u32 vcc, s31, v12
    s_sub_u32 s47, s47, 1
    s_cmp_eq_u32 s47, 0
    s_cbranch_scc1 Lpoll11_x
    s_nop 2
    s_cbranch_vccnz Lpoll11
Lpoll11_x:
    s_branch L_g1j
L_g1c:
    s_cmp_ge_u32 s60, 640
    s_cbranch_scc1 L_g1j
    s_lshl_b32 s20, s60, 12
    s_add_u32 s20, s20, 23068672
    s_add_u32 m0, s61, 8320
    s_nop 0
    buffer_load_dwordx4 v2, s[4:7], s20 offen offset:0 sc1 lds
    buffer_load_dwordx4 v2, s[4:7], s20 offen offset:1024 sc1 lds
    buffer_load_dwordx4 v2, s[4:7], s20 offen offset:2048 sc1 lds
    buffer_load_dwordx4 v2, s[4:7], s20 offen offset:3072 sc1 lds
    s_waitcnt vmcnt(0)
    ds_read_b128 a[64:67], v236 offset:3584
    ds_read2_b32 a[0:1], v232 offset0:0 offset1:1
    ds_read2_b32 a[2:3], v232 offset0:2 offset1:3
    ds_read_b128 a[68:71], v236 offset:3072
    ds_read2_b32 a[4:5], v232 offset0:128 offset1:129
    ds_read2_b32 a[6:7], v232 offset0:130 offset1:131
    ds_read_b128 a[72:75], v236 offset:2560
    ds_read2_b32 a[8:9], v233 offset0:0 offset1:1
    ds_read2_b32 a[10:11], v233 offset0:2 offset1:3
    ds_read_b128 a[76:79], v236 offset:2048
    ds_read2_b32 a[12:13], v233 offset0:128 offset1:129
    ds_read2_b32 a[14:15], v233 offset0:130 offset1:131
    ds_read_b128 a[80:83], v236 offset:1536
    ds_read2_b32 a[16:17], v234 offset0:0 offset1:1
    ds_read2_b32 a[18:19], v234 offset0:2 offset1:3
    ds_read_b128 a[84:87], v236 offset:1024
    ds_read2_b32 a[20:21], v234 offset0:128 offset1:129
    ds_read2_b32 a[22:23], v234 offset0:130 offset1:131
    ds_read_b128 a[88:91], v236 offset:512
    ds_read2_b32 a[24:25], v235 offset0:0 offset1:1
    ds_read2_b32 a[26:27], v235 offset0:2 offset1:3
    ds_read_b128 a[92:95], v236 offset:0
    ds_read2_b32 a[28:29], v235 offset0:128 offset1:129
    ds_read2_b32 a[30:31], v235 offset0:130 offset1:131
    s_waitcnt lgkmcnt(0)
    v_mfma_f32_16x16x32_bf16 v[200:203], a[0:3], a[64:67], v[200:203]
    ds_read_b128 a[96:99], v236 offset:3648
    v_mfma_f32_16x16x32_bf16 v[204:207], a[0:3], a[68:71], v[204:207]
    ds_read2_b32 a[32:33], v232 offset0:16 offset1:17
    v_mfma_f32_16x16x32_bf16 v[208:211], a[0:3], a[72:75], v[208:211]
    ds_read2_b32 a[34:35], v232 offset0:18 offset1:19
    v_mfma_f32_16x16x32_bf16 v[212:215], a[0:3], a[76:79], v[212:215]
    ds_read_b128 a[100:103], v236 offset:3136
    v_mfma_f32_16x16x32_bf16 v[216:219], a[0:3], a[80:83], v[216:219]
    ds_read2_b32 a[36:37], v232 offset0:144 offset1:145
    v_mfma_f32_16x16x32_bf16 v[220:223], a[0:3], a[84:87], v[220:223]
    ds_read2_b32 a[38:39], v232 offset0:146 offset1:147
    v_mfma_f32_16x16x32_bf16 v[224:227], a[0:3], a[88:91], v[224:227]
    ds_read_b128 a[104:107], v236 offset:2624
    v_mfma_f32_16x16x32_bf16 v[228:231], a[0:3], a[92:95], v[228:231]
    ds_read2_b32 a[40:41], v233 offset0:16 offset1:17
    v_mfma_f32_16x16x32_bf16 v[204:207], a[4:7], a[64:67], v[204:207]
    ds_read2_b32 a[42:43], v233 offset0:18 offset1:19
    v_mfma_f32_16x16x32_bf16 v[208:211], a[4:7], a[68:71], v[208:211]
    ds_read_b128 a[108:111], v236 offset:2112
    v_mfma_f32_16x16x32_bf16 v[212:215], a[4:7], a[72:75], v[212:215]
    ds_read2_b32 a[44:45], v233 offset0:144 offset1:145
    v_mfma_f32_16x16x32_bf16 v[216:219], a[4:7], a[76:79], v[216:219]
    ds_read2_b32 a[46:47], v233 offset0:146 offset1:147
    v_mfma_f32_16x16x32_bf16 v[220:223], a[4:7], a[80:83], v[220:223]
    ds_read_b128 a[112:115], v236 offset:1600
    v_mfma_f32_16x16x32_bf16 v[224:227], a[4:7], a[84:87], v[224:227]
    ds_read2_b32 a[48:49], v234 offset0:16 offset1:17
    v_mfma_f32_16x16x32_bf16 v[228:231], a[4:7], a[88:91], v[228:231]
    ds_read2_b32 a[50:51], v234 offset0:18 offset1:19
    v_mfma_f32_16x16x32_bf16 v[208:211], a[8:11], a[64:67], v[208:211]
    ds_read_b128 a[116:119], v236 offset:1088
    v_mfma_f32_16x16x32_bf16 v[212:215], a[8:11], a[68:71], v[212:215]
    ds_read2_b32 a[52:53], v234 offset0:144 offset1:145
    v_mfma_f32_16x16x32_bf16 v[216:219], a[8:11], a[72:75], v[216:219]
    ds_read2_b32 a[54:55], v234 offset0:146 offset1:147
    v_mfma_f32_16x16x32_bf16 v[220:223], a[8:11], a[76:79], v[220:223]
    ds_read_b128 a[120:123], v236 offset:576
    v_mfma_f32_16x16x32_bf16 v[224:227], a[8:11], a[80:83], v[224:227]
    ds_read2_b32 a[56:57], v235 offset0:16 offset1:17
    v_mfma_f32_16x16x32_bf16 v[228:231], a[8:11], a[84:87], v[228:231]
    ds_read2_b32 a[58:59], v235 offset0:18 offset1:19
    v_mfma_f32_16x16x32_bf16 v[212:215], a[12:15], a[64:67], v[212:215]
    ds_read_b128 a[124:127], v236 offset:64
    v_mfma_f32_16x16x32_bf16 v[216:219], a[12:15], a[68:71], v[216:219]
    ds_read2_b32 a[60:61], v235 offset0:144 offset1:145
    v_mfma_f32_16x16x32_bf16 v[220:223], a[12:15], a[72:75], v[220:223]
    ds_read2_b32 a[62:63], v235 offset0:146 offset1:147
    v_mfma_f32_16x16x32_bf16 v[224:227], a[12:15], a[76:79], v[224:227]
    v_mfma_f32_16x16x32_bf16 v[228:231], a[12:15], a[80:83], v[228:231]
    v_mfma_f32_16x16x32_bf16 v[216:219], a[16:19], a[64:67], v[216:219]
    v_mfma_f32_16x16x32_bf16 v[220:223], a[16:19], a[68:71], v[220:223]
    v_mfma_f32_16x16x32_bf16 v[224:227], a[16:19], a[72:75], v[224:227]
    v_mfma_f32_16x16x32_bf16 v[228:231], a[16:19], a[76:79], v[228:231]
    v_mfma_f32_16x16x32_bf16 v[220:223], a[20:23], a[64:67], v[220:223]
    v_mfma_f32_16x16x32_bf16 v[224:227], a[20:23], a[68:71], v[224:227]
    v_mfma_f32_16x16x32_bf16 v[228:231], a[20:23], a[72:75], v[228:231]
    v_mfma_f32_16x16x32_bf16 v[224:227], a[24:27], a[64:67], v[224:227]
    v_mfma_f32_16x16x32_bf16 v[228:231], a[24:27], a[68:71], v[228:231]
    v_mfma_f32_16x16x32_bf16 v[228:231], a[28:31], a[64:67], v[228:231]
    s_waitcnt lgkmcnt(0)
    v_mfma_f32_16x16x32_bf16 v[200:203], a[32:35], a[96:99], v[200:203]
    ds_read_b128 a[64:67], v236 offset:3712
    v_mfma_f32_16x16x32_bf16 v[204:207], a[32:35], a[100:103], v[204:207]
    ds_read2_b32 a[0:1], v232 offset0:32 offset1:33
    v_mfma_f32_16x16x32_bf16 v[208:211], a[32:35], a[104:107], v[208:211]
    ds_read2_b32 a[2:3], v232 offset0:34 offset1:35
    v_mfma_f32_16x16x32_bf16 v[212:215], a[32:35], a[108:111], v[212:215]
    ds_read_b128 a[68:71], v236 offset:3200
    v_mfma_f32_16x16x32_bf16 v[216:219], a[32:35], a[112:115], v[216:219]
    ds_read2_b32 a[4:5], v232 offset0:160 offset1:161
    v_mfma_f32_16x16x32_bf16 v[220:223], a[32:35], a[116:119], v[220:223]
    ds_read2_b32 a[6:7], v232 offset0:162 offset1:163
    v_mfma_f32_16x16x32_bf16 v[224:227], a[32:35], a[120:123], v[224:227]
    ds_read_b128 a[72:75], v236 offset:2688
    v_mfma_f32_16x16x32_bf16 v[228:231], a[32:35], a[124:127], v[228:231]
    ds_read2_b32 a[8:9], v233 offset0:32 offset1:33
    v_mfma_f32_16x16x32_bf16 v[204:207], a[36:39], a[96:99], v[204:207]
    ds_read2_b32 a[10:11], v233 offset0:34 offset1:35
    v_mfma_f32_16x16x32_bf16 v[208:211], a[36:39], a[100:103], v[208:211]
    ds_read_b128 a[76:79], v236 offset:2176
    v_mfma_f32_16x16x32_bf16 v[212:215], a[36:39], a[104:107], v[212:215]
    ds_read2_b32 a[12:13], v233 offset0:160 offset1:161
    v_mfma_f32_16x16x32_bf16 v[216:219], a[36:39], a[108:111], v[216:219]
    ds_read2_b32 a[14:15], v233 offset0:162 offset1:163
    v_mfma_f32_16x16x32_bf16 v[220:223], a[36:39], a[112:115], v[220:223]
    ds_read_b128 a[80:83], v236 offset:1664
    v_mfma_f32_16x16x32_bf16 v[224:227], a[36:39], a[116:119], v[224:227]
    ds_read2_b32 a[16:17], v234 offset0:32 offset1:33
    v_mfma_f32_16x16x32_bf16 v[228:231], a[36:39], a[120:123], v[228:231]
    ds_read2_b32 a[18:19], v234 offset0:34 offset1:35
    v_mfma_f32_16x16x32_bf16 v[208:211], a[40:43], a[96:99], v[208:211]
    ds_read_b128 a[84:87], v236 offset:1152
    v_mfma_f32_16x16x32_bf16 v[212:215], a[40:43], a[100:103], v[212:215]
    ds_read2_b32 a[20:21], v234 offset0:160 offset1:161
    v_mfma_f32_16x16x32_bf16 v[216:219], a[40:43], a[104:107], v[216:219]
    ds_read2_b32 a[22:23], v234 offset0:162 offset1:163
    v_mfma_f32_16x16x32_bf16 v[220:223], a[40:43], a[108:111], v[220:223]
    ds_read_b128 a[88:91], v236 offset:640
    v_mfma_f32_16x16x32_bf16 v[224:227], a[40:43], a[112:115], v[224:227]
    ds_read2_b32 a[24:25], v235 offset0:32 offset1:33
    v_mfma_f32_16x16x32_bf16 v[228:231], a[40:43], a[116:119], v[228:231]
    ds_read2_b32 a[26:27], v235 offset0:34 offset1:35
    v_mfma_f32_16x16x32_bf16 v[212:215], a[44:47], a[96:99], v[212:215]
    ds_read_b128 a[92:95], v236 offset:128
    v_mfma_f32_16x16x32_bf16 v[216:219], a[44:47], a[100:103], v[216:219]
    ds_read2_b32 a[28:29], v235 offset0:160 offset1:161
    v_mfma_f32_16x16x32_bf16 v[220:223], a[44:47], a[104:107], v[220:223]
    ds_read2_b32 a[30:31], v235 offset0:162 offset1:163
    v_mfma_f32_16x16x32_bf16 v[224:227], a[44:47], a[108:111], v[224:227]
    v_mfma_f32_16x16x32_bf16 v[228:231], a[44:47], a[112:115], v[228:231]
    v_mfma_f32_16x16x32_bf16 v[216:219], a[48:51], a[96:99], v[216:219]
    v_mfma_f32_16x16x32_bf16 v[220:223], a[48:51], a[100:103], v[220:223]
    v_mfma_f32_16x16x32_bf16 v[224:227], a[48:51], a[104:107], v[224:227]
    v_mfma_f32_16x16x32_bf16 v[228:231], a[48:51], a[108:111], v[228:231]
    v_mfma_f32_16x16x32_bf16 v[220:223], a[52:55], a[96:99], v[220:223]
    v_mfma_f32_16x16x32_bf16 v[224:227], a[52:55], a[100:103], v[224:227]
    v_mfma_f32_16x16x32_bf16 v[228:231], a[52:55], a[104:107], v[228:231]
    v_mfma_f32_16x16x32_bf16 v[224:227], a[56:59], a[96:99], v[224:227]
    v_mfma_f32_16x16x32_bf16 v[228:231], a[56:59], a[100:103], v[228:231]
    v_mfma_f32_16x16x32_bf16 v[228:231], a[60:63], a[96:99], v[228:231]
    s_waitcnt lgkmcnt(0)
    v_mfma_f32_16x16x32_bf16 v[200:203], a[0:3], a[64:67], v[200:203]
    ds_read_b128 a[96:99], v236 offset:3776
    v_mfma_f32_16x16x32_bf16 v[204:207], a[0:3], a[68:71], v[204:207]
    ds_read2_b32 a[32:33], v232 offset0:48 offset1:49
    v_mfma_f32_16x16x32_bf16 v[208:211], a[0:3], a[72:75], v[208:211]
    ds_read2_b32 a[34:35], v232 offset0:50 offset1:51
    v_mfma_f32_16x16x32_bf16 v[212:215], a[0:3], a[76:79], v[212:215]
    ds_read_b128 a[100:103], v236 offset:3264
    v_mfma_f32_16x16x32_bf16 v[216:219], a[0:3], a[80:83], v[216:219]
    ds_read2_b32 a[36:37], v232 offset0:176 offset1:177
    v_mfma_f32_16x16x32_bf16 v[220:223], a[0:3], a[84:87], v[220:223]
    ds_read2_b32 a[38:39], v232 offset0:178 offset1:179
    v_mfma_f32_16x16x32_bf16 v[224:227], a[0:3], a[88:91], v[224:227]
    ds_read_b128 a[104:107], v236 offset:2752
    v_mfma_f32_16x16x32_bf16 v[228:231], a[0:3], a[92:95], v[228:231]
    ds_read2_b32 a[40:41], v233 offset0:48 offset1:49
    v_mfma_f32_16x16x32_bf16 v[204:207], a[4:7], a[64:67], v[204:207]
    ds_read2_b32 a[42:43], v233 offset0:50 offset1:51
    v_mfma_f32_16x16x32_bf16 v[208:211], a[4:7], a[68:71], v[208:211]
    ds_read_b128 a[108:111], v236 offset:2240
    v_mfma_f32_16x16x32_bf16 v[212:215], a[4:7], a[72:75], v[212:215]
    ds_read2_b32 a[44:45], v233 offset0:176 offset1:177
    v_mfma_f32_16x16x32_bf16 v[216:219], a[4:7], a[76:79], v[216:219]
    ds_read2_b32 a[46:47], v233 offset0:178 offset1:179
    v_mfma_f32_16x16x32_bf16 v[220:223], a[4:7], a[80:83], v[220:223]
    ds_read_b128 a[112:115], v236 offset:1728
    v_mfma_f32_16x16x32_bf16 v[224:227], a[4:7], a[84:87], v[224:227]
    ds_read2_b32 a[48:49], v234 offset0:48 offset1:49
    v_mfma_f32_16x16x32_bf16 v[228:231], a[4:7], a[88:91], v[228:231]
    ds_read2_b32 a[50:51], v234 offset0:50 offset1:51
    v_mfma_f32_16x16x32_bf16 v[208:211], a[8:11], a[64:67], v[208:211]
    ds_read_b128 a[116:119], v236 offset:1216
    v_mfma_f32_16x16x32_bf16 v[212:215], a[8:11], a[68:71], v[212:215]
    ds_read2_b32 a[52:53], v234 offset0:176 offset1:177
    v_mfma_f32_16x16x32_bf16 v[216:219], a[8:11], a[72:75], v[216:219]
    ds_read2_b32 a[54:55], v234 offset0:178 offset1:179
    v_mfma_f32_16x16x32_bf16 v[220:223], a[8:11], a[76:79], v[220:223]
    ds_read_b128 a[120:123], v236 offset:704
    v_mfma_f32_16x16x32_bf16 v[224:227], a[8:11], a[80:83], v[224:227]
    ds_read2_b32 a[56:57], v235 offset0:48 offset1:49
    v_mfma_f32_16x16x32_bf16 v[228:231], a[8:11], a[84:87], v[228:231]
    ds_read2_b32 a[58:59], v235 offset0:50 offset1:51
    v_mfma_f32_16x16x32_bf16 v[212:215], a[12:15], a[64:67], v[212:215]
    ds_read_b128 a[124:127], v236 offset:192
    v_mfma_f32_16x16x32_bf16 v[216:219], a[12:15], a[68:71], v[216:219]
    ds_read2_b32 a[60:61], v235 offset0:176 offset1:177
    v_mfma_f32_16x16x32_bf16 v[220:223], a[12:15], a[72:75], v[220:223]
    ds_read2_b32 a[62:63], v235 offset0:178 offset1:179
    v_mfma_f32_16x16x32_bf16 v[224:227], a[12:15], a[76:79], v[224:227]
    v_mfma_f32_16x16x32_bf16 v[228:231], a[12:15], a[80:83], v[228:231]
    v_mfma_f32_16x16x32_bf16 v[216:219], a[16:19], a[64:67], v[216:219]
    v_mfma_f32_16x16x32_bf16 v[220:223], a[16:19], a[68:71], v[220:223]
    v_mfma_f32_16x16x32_bf16 v[224:227], a[16:19], a[72:75], v[224:227]
    v_mfma_f32_16x16x32_bf16 v[228:231], a[16:19], a[76:79], v[228:231]
    v_mfma_f32_16x16x32_bf16 v[220:223], a[20:23], a[64:67], v[220:223]
    v_mfma_f32_16x16x32_bf16 v[224:227], a[20:23], a[68:71], v[224:227]
    v_mfma_f32_16x16x32_bf16 v[228:231], a[20:23], a[72:75], v[228:231]
    v_mfma_f32_16x16x32_bf16 v[224:227], a[24:27], a[64:67], v[224:227]
    v_mfma_f32_16x16x32_bf16 v[228:231], a[24:27], a[68:71], v[228:231]
    v_mfma_f32_16x16x32_bf16 v[228:231], a[28:31], a[64:67], v[228:231]
    s_waitcnt lgkmcnt(0)
    v_mfma_f32_16x16x32_bf16 v[200:203], a[32:35], a[96:99], v[200:203]
    v_mfma_f32_16x16x32_bf16 v[204:207], a[32:35], a[100:103], v[204:207]
    v_mfma_f32_16x16x32_bf16 v[208:211], a[32:35], a[104:107], v[208:211]
    v_mfma_f32_16x16x32_bf16 v[212:215], a[32:35], a[108:111], v[212:215]
    v_mfma_f32_16x16x32_bf16 v[216:219], a[32:35], a[112:115], v[216:219]
    v_mfma_f32_16x16x32_bf16 v[220:223], a[32:35], a[116:119], v[220:223]
    v_mfma_f32_16x16x32_bf16 v[224:227], a[32:35], a[120:123], v[224:227]
    v_mfma_f32_16x16x32_bf16 v[228:231], a[32:35], a[124:127], v[228:231]
    v_mfma_f32_16x16x32_bf16 v[204:207], a[36:39], a[96:99], v[204:207]
    v_mfma_f32_16x16x32_bf16 v[208:211], a[36:39], a[100:103], v[208:211]
    v_mfma_f32_16x16x32_bf16 v[212:215], a[36:39], a[104:107], v[212:215]
    v_mfma_f32_16x16x32_bf16 v[216:219], a[36:39], a[108:111], v[216:219]
    v_mfma_f32_16x16x32_bf16 v[220:223], a[36:39], a[112:115], v[220:223]
    v_mfma_f32_16x16x32_bf16 v[224:227], a[36:39], a[116:119], v[224:227]
    v_mfma_f32_16x16x32_bf16 v[228:231], a[36:39], a[120:123], v[228:231]
    v_mfma_f32_16x16x32_bf16 v[208:211], a[40:43], a[96:99], v[208:211]
    v_mfma_f32_16x16x32_bf16 v[212:215], a[40:43], a[100:103], v[212:215]
    v_mfma_f32_16x16x32_bf16 v[216:219], a[40:43], a[104:107], v[216:219]
    v_mfma_f32_16x16x32_bf16 v[220:223], a[40:43], a[108:111], v[220:223]
    v_mfma_f32_16x16x32_bf16 v[224:227], a[40:43], a[112:115], v[224:227]
    v_mfma_f32_16x16x32_bf16 v[228:231], a[40:43], a[116:119], v[228:231]
    v_mfma_f32_16x16x32_bf16 v[212:215], a[44:47], a[96:99], v[212:215]
    v_mfma_f32_16x16x32_bf16 v[216:219], a[44:47], a[100:103], v[216:219]
    v_mfma_f32_16x16x32_bf16 v[220:223], a[44:47], a[104:107], v[220:223]
    v_mfma_f32_16x16x32_bf16 v[224:227], a[44:47], a[108:111], v[224:227]
    v_mfma_f32_16x16x32_bf16 v[228:231], a[44:47], a[112:115], v[228:231]
    v_mfma_f32_16x16x32_bf16 v[216:219], a[48:51], a[96:99], v[216:219]
    v_mfma_f32_16x16x32_bf16 v[220:223], a[48:51], a[100:103], v[220:223]
    v_mfma_f32_16x16x32_bf16 v[224:227], a[48:51], a[104:107], v[224:227]
    v_mfma_f32_16x16x32_bf16 v[228:231], a[48:51], a[108:111], v[228:231]
    v_mfma_f32_16x16x32_bf16 v[220:223], a[52:55], a[96:99], v[220:223]
    v_mfma_f32_16x16x32_bf16 v[224:227], a[52:55], a[100:103], v[224:227]
    v_mfma_f32_16x16x32_bf16 v[228:231], a[52:55], a[104:107], v[228:231]
    v_mfma_f32_16x16x32_bf16 v[224:227], a[56:59], a[96:99], v[224:227]
    v_mfma_f32_16x16x32_bf16 v[228:231], a[56:59], a[100:103], v[228:231]
    v_mfma_f32_16x16x32_bf16 v[228:231], a[60:63], a[96:99], v[228:231]
L_g1j:
    s_waitcnt vmcnt(0)
    s_barrier
    s_lshl_b32 s24, s21, 2
    s_add_u32 s24, s24, s30
    s_mul_i32 s24, s24, 1
    s_mul_i32 s25, s24, 20480
    s_add_u32 s25, s25, 5242880
    s_add_u32 s26, s25, 20480
    s_mul_i32 s27, s22, 102400
    s_add_u32 s27, s27, 17825792
    s_mul_i32 s29, s30, 5120
    s_add_u32 s28, s27, s29
    s_add_u32 s35, s25, 0
    buffer_load_dwordx4 a[0:3], v2, s[4:7], s35 offen offset:0 sc1
    buffer_load_dwordx4 a[4:7], v2, s[4:7], s35 offen offset:1024 sc1
    buffer_load_dwordx4 a[8:11], v2, s[4:7], s35 offen offset:2048 sc1
    buffer_load_dwordx4 a[12:15], v2, s[4:7], s35 offen offset:3072 sc1
    s_add_u32 s35, s25, 4096
    buffer_load_dwordx4 a[16:19], v2, s[4:7], s35 offen offset:0 sc1
    buffer_load_dwordx4 a[20:23], v2, s[4:7], s35 offen offset:1024 sc1
    buffer_load_dwordx4 a[24:27], v2, s[4:7], s35 offen offset:2048 sc1
    buffer_load_dwordx4 a[28:31], v2, s[4:7], s35 offen offset:3072 sc1
    s_add_u32 s35, s25, 8192
    buffer_load_dwordx4 a[32:35], v2, s[4:7], s35 offen offset:0 sc1
    buffer_load_dwordx4 a[36:39], v2, s[4:7], s35 offen offset:1024 sc1
    v_mov_b32 v16, 0
    v_mov_b32 v17, 0
    v_mov_b32 v18, 0
    v_mov_b32 v19, 0
    v_mov_b32 v20, 0
    v_mov_b32 v21, 0
    v_mov_b32 v22, 0
    v_mov_b32 v23, 0
    v_mov_b32 v24, 0
    v_mov_b32 v25, 0
    v_mov_b32 v26, 0
    v_mov_b32 v27, 0
    v_mov_b32 v28, 0
    v_mov_b32 v29, 0
    v_mov_b32 v30, 0
    v_mov_b32 v31, 0
    v_mov_b32 v32, 0
    v_mov_b32 v33, 0
    v_mov_b32 v34, 0
    v_mov_b32 v35, 0
    v_add_u32 v3, 0x10000, v2
    v_add_u32 v4, 0x20000, v2
    ds_read_b128 v[36:39], v2 offset:0
    ds_read_b128 v[40:43], v2 offset:1024
    ds_read_b128 v[44:47], v2 offset:2048
    ds_read_b128 v[48:51], v2 offset:3072
    ds_read_b128 v[52:55], v2 offset:4096
    ds_read_b128 v[56:59], v2 offset:5120
    ds_read_b128 v[60:63], v2 offset:6144
    ds_read_b128 v[64:67], v2 offset:7168
    ds_read_b128 v[68:71], v2 offset:8192
    ds_read_b128 v[72:75], v2 offset:9216
    s_waitcnt vmcnt(9)
    s_waitcnt lgkmcnt(9)
    v_mfma_f32_16x16x32_bf16 v[16:19], v[36:39], a[0:3], v[16:19]
    buffer_load_dwordx4 a[40:43], v2, s[4:7], s35 offen offset:2048 sc1
    s_waitcnt lgkmcnt(8)
    v_mfma_f32_16x16x32_bf16 v[20:23], v[40:43], a[0:3], v[20:23]
    s_waitcnt lgkmcnt(7)
    v_mfma_f32_16x16x32_bf16 v[24:27], v[44:47], a[0:3], v[24:27]
    s_waitcnt lgkmcnt(6)
    v_mfma_f32_16x16x32_bf16 v[28:31], v[48:51], a[0:3], v[28:31]
    s_waitcnt lgkmcnt(5)
    v_mfma_f32_16x16x32_bf16 v[32:35], v[52:55], a[0:3], v[32:35]
    ds_read_b128 v[36:39], v2 offset:10240
    ds_read_b128 v[40:43], v2 offset:11264
    ds_read_b128 v[44:47], v2 offset:12288
    ds_read_b128 v[48:51], v2 offset:13312
    ds_read_b128 v[52:55], v2 offset:14336
    s_waitcnt vmcnt(9)
    s_waitcnt lgkmcnt(9)
    v_mfma_f32_16x16x32_bf16 v[16:19], v[56:59], a[4:7], v[16:19]
    buffer_load_dwordx4 a[44:47], v2, s[4:7], s35 offen offset:3072 sc1
    s_waitcnt lgkmcnt(8)
    v_mfma_f32_16x16x32_bf16 v[20:23], v[60:63], a[4:7], v[20:23]
    s_waitcnt lgkmcnt(7)
    v_mfma_f32_16x16x32_bf16 v[24:27], v[64:67], a[4:7], v[24:27]
    s_waitcnt lgkmcnt(6)
    v_mfma_f32_16x16x32_bf16 v[28:31], v[68:71], a[4:7], v[28:31]
    s_waitcnt lgkmcnt(5)
    v_mfma_f32_16x16x32_bf16 v[32:35], v[72:75], a[4:7], v[32:35]
    ds_read_b128 v[56:59], v2 offset:15360
    ds_read_b128 v[60:63], v2 offset:16384
    ds_read_b128 v[64:67], v2 offset:17408
    ds_read_b128 v[68:71], v2 offset:18432
    ds_read_b128 v[72:75], v2 offset:19456
    s_waitcnt vmcnt(9)
    s_waitcnt lgkmcnt(9)
    v_mfma_f32_16x16x32_bf16 v[16:19], v[36:39], a[8:11], v[16:19]
    s_add_u32 s35, s25, 12288
    buffer_load_dwordx4 a[48:51], v2, s[4:7], s35 offen offset:0 sc1
    s_waitcnt lgkmcnt(8)
    v_mfma_f32_16x16x32_bf16 v[20:23], v[40:43], a[8:11], v[20:23]
    s_waitcnt lgkmcnt(7)
    v_mfma_f32_16x16x32_bf16 v[24:27], v[44:47], a[8:11], v[24:27]
    s_waitcnt lgkmcnt(6)
    v_mfma_f32_16x16x32_bf16 v[28:31], v[48:51], a[8:11], v[28:31]
    s_waitcnt lgkmcnt(5)
    v_mfma_f32_16x16x32_bf16 v[32:35], v[52:55], a[8:11], v[32:35]
    ds_read_b128 v[36:39], v2 offset:20480
    ds_read_b128 v[40:43], v2 offset:21504
    ds_read_b128 v[44:47], v2 offset:22528
    ds_read_b128 v[48:51], v2 offset:23552
    ds_read_b128 v[52:55], v2 offset:24576
    s_waitcnt vmcnt(9)
    s_waitcnt lgkmcnt(9)
    v_mfma_f32_16x16x32_bf16 v[16:19], v[56:59], a[12:15], v[16:19]
    buffer_load_dwordx4 a[52:55], v2, s[4:7], s35 offen offset:1024 sc1
    s_waitcnt lgkmcnt(8)
    v_mfma_f32_16x16x32_bf16 v[20:23], v[60:63], a[12:15], v[20:23]
    s_waitcnt lgkmcnt(7)
    v_mfma_f32_16x16x32_bf16 v[24:27], v[64:67], a[12:15], v[24:27]
    s_waitcnt lgkmcnt(6)
    v_mfma_f32_16x16x32_bf16 v[28:31], v[68:71], a[12:15], v[28:31]
    s_waitcnt lgkmcnt(5)
    v_mfma_f32_16x16x32_bf16 v[32:35], v[72:75], a[12:15], v[32:35]
    ds_read_b128 v[56:59], v2 offset:25600
    ds_read_b128 v[60:63], v2 offset:26624
    ds_read_b128 v[64:67], v2 offset:27648
    ds_read_b128 v[68:71], v2 offset:28672
    ds_read_b128 v[72:75], v2 offset:29696
    s_waitcnt vmcnt(9)
    s_waitcnt lgkmcnt(9)
    v_mfma_f32_16x16x32_bf16 v[16:19], v[36:39], a[16:19], v[16:19]
    buffer_load_dwordx4 a[56:59], v2, s[4:7], s35 offen offset:2048 sc1
    s_waitcnt lgkmcnt(8)
    v_mfma_f32_16x16x32_bf16 v[20:23], v[40:43], a[16:19], v[20:23]
    s_waitcnt lgkmcnt(7)
    v_mfma_f32_16x16x32_bf16 v[24:27], v[44:47], a[16:19], v[24:27]
    s_waitcnt lgkmcnt(6)
    v_mfma_f32_16x16x32_bf16 v[28:31], v[48:51], a[16:19], v[28:31]
    s_waitcnt lgkmcnt(5)
    v_mfma_f32_16x16x32_bf16 v[32:35], v[52:55], a[16:19], v[32:35]
    ds_read_b128 v[36:39], v2 offset:30720
    ds_read_b128 v[40:43], v2 offset:31744
    ds_read_b128 v[44:47], v2 offset:32768
    ds_read_b128 v[48:51], v2 offset:33792
    ds_read_b128 v[52:55], v2 offset:34816
    s_waitcnt vmcnt(9)
    s_waitcnt lgkmcnt(9)
    v_mfma_f32_16x16x32_bf16 v[16:19], v[56:59], a[20:23], v[16:19]
    buffer_load_dwordx4 a[60:63], v2, s[4:7], s35 offen offset:3072 sc1
    s_waitcnt lgkmcnt(8)
    v_mfma_f32_16x16x32_bf16 v[20:23], v[60:63], a[20:23], v[20:23]
    s_waitcnt lgkmcnt(7)
    v_mfma_f32_16x16x32_bf16 v[24:27], v[64:67], a[20:23], v[24:27]
    s_waitcnt lgkmcnt(6)
    v_mfma_f32_16x16x32_bf16 v[28:31], v[68:71], a[20:23], v[28:31]
    s_waitcnt lgkmcnt(5)
    v_mfma_f32_16x16x32_bf16 v[32:35], v[72:75], a[20:23], v[32:35]
    ds_read_b128 v[56:59], v2 offset:35840
    ds_read_b128 v[60:63], v2 offset:36864
    ds_read_b128 v[64:67], v2 offset:37888
    ds_read_b128 v[68:71], v2 offset:38912
    ds_read_b128 v[72:75], v2 offset:39936
    s_waitcnt vmcnt(9)
    s_waitcnt lgkmcnt(9)
    v_mfma_f32_16x16x32_bf16 v[16:19], v[36:39], a[24:27], v[16:19]
    s_add_u32 s35, s25, 16384
    buffer_load_dwordx4 a[64:67], v2, s[4:7], s35 offen offset:0 sc1
    s_waitcnt lgkmcnt(8)
    v_mfma_f32_16x16x32_bf16 v[20:23], v[40:43], a[24:27], v[20:23]
    s_waitcnt lgkmcnt(7)
    v_mfma_f32_16x16x32_bf16 v[24:27], v[44:47], a[24:27], v[24:27]
    s_waitcnt lgkmcnt(6)
    v_mfma_f32_16x16x32_bf16 v[28:31], v[48:51], a[24:27], v[28:31]
    s_waitcnt lgkmcnt(5)
    v_mfma_f32_16x16x32_bf16 v[32:35], v[52:55], a[24:27], v[32:35]
    ds_read_b128 v[36:39], v2 offset:40960
    ds_read_b128 v[40:43], v2 offset:41984
    ds_read_b128 v[44:47], v2 offset:43008
    ds_read_b128 v[48:51], v2 offset:44032
    ds_read_b128 v[52:55], v2 offset:45056
    s_waitcnt vmcnt(9)
    s_waitcnt lgkmcnt(9)
    v_mfma_f32_16x16x32_bf16 v[16:19], v[56:59], a[28:31], v[16:19]
    buffer_load_dwordx4 a[68:71], v2, s[4:7], s35 offen offset:1024 sc1
    s_waitcnt lgkmcnt(8)
    v_mfma_f32_16x16x32_bf16 v[20:23], v[60:63], a[28:31], v[20:23]
    s_waitcnt lgkmcnt(7)
    v_mfma_f32_16x16x32_bf16 v[24:27], v[64:67], a[28:31], v[24:27]
    s_waitcnt lgkmcnt(6)
    v_mfma_f32_16x16x32_bf16 v[28:31], v[68:71], a[28:31], v[28:31]
    s_waitcnt lgkmcnt(5)
    v_mfma_f32_16x16x32_bf16 v[32:35], v[72:75], a[28:31], v[32:35]
    ds_read_b128 v[56:59], v2 offset:46080
    ds_read_b128 v[60:63], v2 offset:47104
    ds_read_b128 v[64:67], v2 offset:48128
    ds_read_b128 v[68:71], v2 offset:49152
    ds_read_b128 v[72:75], v2 offset:50176
    s_waitcnt vmcnt(9)
    s_waitcnt lgkmcnt(9)
    v_mfma_f32_16x16x32_bf16 v[16:19], v[36:39], a[32:35], v[16:19]
    buffer_load_dwordx4 a[72:75], v2, s[4:7], s35 offen offset:2048 sc1
    s_waitcnt lgkmcnt(8)
    v_mfma_f32_16x16x32_bf16 v[20:23], v[40:43], a[32:35], v[20:23]
    s_waitcnt lgkmcnt(7)
    v_mfma_f32_16x16x32_bf16 v[24:27], v[44:47], a[32:35], v[24:27]
    s_waitcnt lgkmcnt(6)
    v_mfma_f32_16x16x32_bf16 v[28:31], v[48:51], a[32:35], v[28:31]
    s_waitcnt lgkmcnt(5)
    v_mfma_f32_16x16x32_bf16 v[32:35], v[52:55], a[32:35], v[32:35]
    ds_read_b128 v[36:39], v2 offset:51200
    ds_read_b128 v[40:43], v2 offset:52224
    ds_read_b128 v[44:47], v2 offset:53248
    ds_read_b128 v[48:51], v2 offset:54272
    ds_read_b128 v[52:55], v2 offset:55296
    s_waitcnt vmcnt(9)
    s_waitcnt lgkmcnt(9)
    v_mfma_f32_16x16x32_bf16 v[16:19], v[56:59], a[36:39], v[16:19]
    buffer_load_dwordx4 a[76:79], v2, s[4:7], s35 offen offset:3072 sc1
    s_waitcnt lgkmcnt(8)
    v_mfma_f32_16x16x32_bf16 v[20:23], v[60:63], a[36:39], v[20:23]
    s_waitcnt lgkmcnt(7)
    v_mfma_f32_16x16x32_bf16 v[24:27], v[64:67], a[36:39], v[24:27]
    s_waitcnt lgkmcnt(6)
    v_mfma_f32_16x16x32_bf16 v[28:31], v[68:71], a[36:39], v[28:31]
    s_waitcnt lgkmcnt(5)
    v_mfma_f32_16x16x32_bf16 v[32:35], v[72:75], a[36:39], v[32:35]
    ds_read_b128 v[56:59], v2 offset:56320
    ds_read_b128 v[60:63], v2 offset:57344
    ds_read_b128 v[64:67], v2 offset:58368
    ds_read_b128 v[68:71], v2 offset:59392
    ds_read_b128 v[72:75], v2 offset:60416
    s_waitcnt vmcnt(9)
    s_waitcnt lgkmcnt(9)
    v_mfma_f32_16x16x32_bf16 v[16:19], v[36:39], a[40:43], v[16:19]
    s_waitcnt lgkmcnt(8)
    v_mfma_f32_16x16x32_bf16 v[20:23], v[40:43], a[40:43], v[20:23]
    s_waitcnt lgkmcnt(7)
    v_mfma_f32_16x16x32_bf16 v[24:27], v[44:47], a[40:43], v[24:27]
    s_waitcnt lgkmcnt(6)
    v_mfma_f32_16x16x32_bf16 v[28:31], v[48:51], a[40:43], v[28:31]
    s_waitcnt lgkmcnt(5)
    v_mfma_f32_16x16x32_bf16 v[32:35], v[52:55], a[40:43], v[32:35]
    ds_read_b128 v[36:39], v2 offset:61440
    ds_read_b128 v[40:43], v2 offset:62464
    ds_read_b128 v[44:47], v2 offset:63488
    ds_read_b128 v[48:51], v2 offset:64512
    ds_read_b128 v[52:55], v3 offset:0
    s_waitcnt vmcnt(8)
    s_waitcnt lgkmcnt(9)
    v_mfma_f32_16x16x32_bf16 v[16:19], v[56:59], a[44:47], v[16:19]
    s_waitcnt lgkmcnt(8)
    v_mfma_f32_16x16x32_bf16 v[20:23], v[60:63], a[44:47], v[20:23]
    s_waitcnt lgkmcnt(7)
    v_mfma_f32_16x16x32_bf16 v[24:27], v[64:67], a[44:47], v[24:27]
    s_waitcnt lgkmcnt(6)
    v_mfma_f32_16x16x32_bf16 v[28:31], v[68:71], a[44:47], v[28:31]
    s_waitcnt lgkmcnt(5)
    v_mfma_f32_16x16x32_bf16 v[32:35], v[72:75], a[44:47], v[32:35]
    ds_read_b128 v[56:59], v3 offset:1024
    ds_read_b128 v[60:63], v3 offset:2048
    ds_read_b128 v[64:67], v3 offset:3072
    ds_read_b128 v[68:71], v3 offset:4096
    ds_read_b128 v[72:75], v3 offset:5120
    s_waitcnt vmcnt(7)
    s_waitcnt lgkmcnt(9)
    v_mfma_f32_16x16x32_bf16 v[16:19], v[36:39], a[48:51], v[16:19]
    s_waitcnt lgkmcnt(8)
    v_mfma_f32_16x16x32_bf16 v[20:23], v[40:43], a[48:51], v[20:23]
    s_waitcnt lgkmcnt(7)
    v_mfma_f32_16x16x32_bf16 v[24:27], v[44:47], a[48:51], v[24:27]
    s_waitcnt lgkmcnt(6)
    v_mfma_f32_16x16x32_bf16 v[28:31], v[48:51], a[48:51], v[28:31]
    s_waitcnt lgkmcnt(5)
    v_mfma_f32_16x16x32_bf16 v[32:35], v[52:55], a[48:51], v[32:35]
    ds_read_b128 v[36:39], v3 offset:6144
    ds_read_b128 v[40:43], v3 offset:7168
    ds_read_b128 v[44:47], v3 offset:8192
    ds_read_b128 v[48:51], v3 offset:9216
    ds_read_b128 v[52:55], v3 offset:10240
    s_waitcnt vmcnt(6)
    s_waitcnt lgkmcnt(9)
    v_mfma_f32_16x16x32_bf16 v[16:19], v[56:59], a[52:55], v[16:19]
    s_waitcnt lgkmcnt(8)
    v_mfma_f32_16x16x32_bf16 v[20:23], v[60:63], a[52:55], v[20:23]
    s_waitcnt lgkmcnt(7)
    v_mfma_f32_16x16x32_bf16 v[24:27], v[64:67], a[52:55], v[24:27]
    s_waitcnt lgkmcnt(6)
    v_mfma_f32_16x16x32_bf16 v[28:31], v[68:71], a[52:55], v[28:31]
    s_waitcnt lgkmcnt(5)
    v_mfma_f32_16x16x32_bf16 v[32:35], v[72:75], a[52:55], v[32:35]
    ds_read_b128 v[56:59], v3 offset:11264
    ds_read_b128 v[60:63], v3 offset:12288
    ds_read_b128 v[64:67], v3 offset:13312
    ds_read_b128 v[68:71], v3 offset:14336
    ds_read_b128 v[72:75], v3 offset:15360
    s_waitcnt vmcnt(5)
    s_waitcnt lgkmcnt(9)
    v_mfma_f32_16x16x32_bf16 v[16:19], v[36:39], a[56:59], v[16:19]
    s_waitcnt lgkmcnt(8)
    v_mfma_f32_16x16x32_bf16 v[20:23], v[40:43], a[56:59], v[20:23]
    s_waitcnt lgkmcnt(7)
    v_mfma_f32_16x16x32_bf16 v[24:27], v[44:47], a[56:59], v[24:27]
    s_waitcnt lgkmcnt(6)
    v_mfma_f32_16x16x32_bf16 v[28:31], v[48:51], a[56:59], v[28:31]
    s_waitcnt lgkmcnt(5)
    v_mfma_f32_16x16x32_bf16 v[32:35], v[52:55], a[56:59], v[32:35]
    ds_read_b128 v[36:39], v3 offset:16384
    ds_read_b128 v[40:43], v3 offset:17408
    ds_read_b128 v[44:47], v3 offset:18432
    ds_read_b128 v[48:51], v3 offset:19456
    ds_read_b128 v[52:55], v3 offset:20480
    s_waitcnt vmcnt(4)
    s_waitcnt lgkmcnt(9)
    v_mfma_f32_16x16x32_bf16 v[16:19], v[56:59], a[60:63], v[16:19]
    s_waitcnt lgkmcnt(8)
    v_mfma_f32_16x16x32_bf16 v[20:23], v[60:63], a[60:63], v[20:23]
    s_waitcnt lgkmcnt(7)
    v_mfma_f32_16x16x32_bf16 v[24:27], v[64:67], a[60:63], v[24:27]
    s_waitcnt lgkmcnt(6)
    v_mfma_f32_16x16x32_bf16 v[28:31], v[68:71], a[60:63], v[28:31]
    s_waitcnt lgkmcnt(5)
    v_mfma_f32_16x16x32_bf16 v[32:35], v[72:75], a[60:63], v[32:35]
    ds_read_b128 v[56:59], v3 offset:21504
    ds_read_b128 v[60:63], v3 offset:22528
    ds_read_b128 v[64:67], v3 offset:23552
    ds_read_b128 v[68:71], v3 offset:24576
    ds_read_b128 v[72:75], v3 offset:25600
    s_waitcnt vmcnt(3)
    s_waitcnt lgkmcnt(9)
    v_mfma_f32_16x16x32_bf16 v[16:19], v[36:39], a[64:67], v[16:19]
    s_waitcnt lgkmcnt(8)
    v_mfma_f32_16x16x32_bf16 v[20:23], v[40:43], a[64:67], v[20:23]
    s_waitcnt lgkmcnt(7)
    v_mfma_f32_16x16x32_bf16 v[24:27], v[44:47], a[64:67], v[24:27]
    s_waitcnt lgkmcnt(6)
    v_mfma_f32_16x16x32_bf16 v[28:31], v[48:51], a[64:67], v[28:31]
    s_waitcnt lgkmcnt(5)
    v_mfma_f32_16x16x32_bf16 v[32:35], v[52:55], a[64:67], v[32:35]
    ds_read_b128 v[36:39], v3 offset:26624
    ds_read_b128 v[40:43], v3 offset:27648
    ds_read_b128 v[44:47], v3 offset:28672
    ds_read_b128 v[48:51], v3 offset:29696
    ds_read_b128 v[52:55], v3 offset:30720
    s_waitcnt vmcnt(2)
    s_waitcnt lgkmcnt(9)
    v_mfma_f32_16x16x32_bf16 v[16:19], v[56:59], a[68:71], v[16:19]
    s_waitcnt lgkmcnt(8)
    v_mfma_f32_16x16x32_bf16 v[20:23], v[60:63], a[68:71], v[20:23]
    s_waitcnt lgkmcnt(7)
    v_mfma_f32_16x16x32_bf16 v[24:27], v[64:67], a[68:71], v[24:27]
    s_waitcnt lgkmcnt(6)
    v_mfma_f32_16x16x32_bf16 v[28:31], v[68:71], a[68:71], v[28:31]
    s_waitcnt lgkmcnt(5)
    v_mfma_f32_16x16x32_bf16 v[32:35], v[72:75], a[68:71], v[32:35]
    ds_read_b128 v[56:59], v3 offset:31744
    ds_read_b128 v[60:63], v3 offset:32768
    ds_read_b128 v[64:67], v3 offset:33792
    ds_read_b128 v[68:71], v3 offset:34816
    ds_read_b128 v[72:75], v3 offset:35840
    s_waitcnt vmcnt(1)
    s_waitcnt lgkmcnt(9)
    v_mfma_f32_16x16x32_bf16 v[16:19], v[36:39], a[72:75], v[16:19]
    s_waitcnt lgkmcnt(8)
    v_mfma_f32_16x16x32_bf16 v[20:23], v[40:43], a[72:75], v[20:23]
    s_waitcnt lgkmcnt(7)
    v_mfma_f32_16x16x32_bf16 v[24:27], v[44:47], a[72:75], v[24:27]
    s_waitcnt lgkmcnt(6)
    v_mfma_f32_16x16x32_bf16 v[28:31], v[48:51], a[72:75], v[28:31]
    s_waitcnt lgkmcnt(5)
    v_mfma_f32_16x16x32_bf16 v[32:35], v[52:55], a[72:75], v[32:35]
    s_waitcnt vmcnt(0)
    s_waitcnt lgkmcnt(4)
    v_mfma_f32_16x16x32_bf16 v[16:19], v[56:59], a[76:79], v[16:19]
    s_waitcnt lgkmcnt(3)
    v_mfma_f32_16x16x32_bf16 v[20:23], v[60:63], a[76:79], v[20:23]
    s_waitcnt lgkmcnt(2)
    v_mfma_f32_16x16x32_bf16 v[24:27], v[64:67], a[76:79], v[24:27]
    s_waitcnt lgkmcnt(1)
    v_mfma_f32_16x16x32_bf16 v[28:31], v[68:71], a[76:79], v[28:31]
    s_waitcnt lgkmcnt(0)
    v_mfma_f32_16x16x32_bf16 v[32:35], v[72:75], a[76:79], v[32:35]
    s_nop 7
    s_mul_i32 s39, s22, 5
    s_lshr_b32 s39, s39, 1
    s_lshl_b32 s39, s39, 10
    s_mul_i32 s38, s24, 20480
    s_add_u32 s39, s39, s38
    s_add_u32 s39, s39, 7864320
    v_lshlrev_b32 v40, 16, v136
    v_and_b32 v41, 0xffff0000, v136
    v_lshlrev_b32 v42, 16, v137
    v_and_b32 v43, 0xffff0000, v137
    v_lshlrev_b32 v44, 16, v138
    v_and_b32 v45, 0xffff0000, v138
    v_lshlrev_b32 v46, 16, v139
    v_and_b32 v47, 0xffff0000, v139
    v_lshlrev_b32 v48, 16, v140
    v_and_b32 v49, 0xffff0000, v140
    v_lshlrev_b32 v50, 16, v141
    v_and_b32 v51, 0xffff0000, v141
    v_lshlrev_b32 v52, 16, v142
    v_and_b32 v53, 0xffff0000, v142
    v_lshlrev_b32 v54, 16, v143
    v_and_b32 v55, 0xffff0000, v143
    v_lshlrev_b32 v56, 16, v144
    v_and_b32 v57, 0xffff0000, v144
    v_lshlrev_b32 v58, 16, v145
    v_and_b32 v59, 0xffff0000, v145
    v_add_f32 v16, v16, v40
    v_add_f32 v17, v17, v41
    v_add_f32 v18, v18, v42
    v_add_f32 v19, v19, v43
    v_add_f32 v20, v20, v44
    v_add_f32 v21, v21, v45
    v_add_f32 v22, v22, v46
    v_add_f32 v23, v23, v47
    v_add_f32 v24, v24, v48
    v_add_f32 v25, v25, v49
    v_add_f32 v26, v26, v50
    v_add_f32 v27, v27, v51
    v_add_f32 v28, v28, v52
    v_add_f32 v29, v29, v53
    v_add_f32 v30, v30, v54
    v_add_f32 v31, v31, v55
    v_add_f32 v32, v32, v56
    v_add_f32 v33, v33, v57
    v_add_f32 v34, v34, v58
    v_add_f32 v35, v35, v59
    v_cvt_pk_bf16_f32 v146, v16, v17
    v_cvt_pk_bf16_f32 v147, v18, v19
    v_cvt_pk_bf16_f32 v148, v20, v21
    v_cvt_pk_bf16_f32 v149, v22, v23
    v_cvt_pk_bf16_f32 v150, v24, v25
    v_cvt_pk_bf16_f32 v151, v26, v27
    v_cvt_pk_bf16_f32 v152, v28, v29
    v_cvt_pk_bf16_f32 v153, v30, v31
    v_cvt_pk_bf16_f32 v154, v32, v33
    v_cvt_pk_bf16_f32 v155, v34, v35
    s_bitcmp1_b32 s22, 0
    s_cbranch_scc1 Par12_odd
    buffer_store_dwordx4 v[146:149], v2, s[4:7], s39 offen offset:0 sc1
    buffer_store_dwordx4 v[150:153], v2, s[4:7], s39 offen offset:1024 sc1
    buffer_store_dwordx2 v[154:155], v2, s[4:7], s39 offen offset:2048 sc1
    s_branch Par12_j
Par12_odd:
    buffer_store_dwordx2 v[146:147], v2, s[4:7], s39 offen offset:8 sc1
    buffer_store_dwordx4 v[148:151], v2, s[4:7], s39 offen offset:1024 sc1
    buffer_store_dwordx4 v[152:155], v2, s[4:7], s39 offen offset:2048 sc1
Par12_j:
    v_lshlrev_b32 v16, 16, v146
    v_and_b32 v17, 0xffff0000, v146
    v_lshlrev_b32 v18, 16, v147
    v_and_b32 v19, 0xffff0000, v147
    v_lshlrev_b32 v20, 16, v148
    v_and_b32 v21, 0xffff0000, v148
    v_lshlrev_b32 v22, 16, v149
    v_and_b32 v23, 0xffff0000, v149
    v_lshlrev_b32 v24, 16, v150
    v_and_b32 v25, 0xffff0000, v150
    v_lshlrev_b32 v26, 16, v151
    v_and_b32 v27, 0xffff0000, v151
    v_lshlrev_b32 v28, 16, v152
    v_and_b32 v29, 0xffff0000, v152
    v_lshlrev_b32 v30, 16, v153
    v_and_b32 v31, 0xffff0000, v153
    v_lshlrev_b32 v32, 16, v154
    v_and_b32 v33, 0xffff0000, v154
    v_lshlrev_b32 v34, 16, v155
    v_and_b32 v35, 0xffff0000, v155
    v_add_f32 v40, v16, v17
    v_mul_f32 v41, v16, v16
    v_fmac_f32 v41, v17, v17
    v_add_f32 v40, v40, v18
    v_fmac_f32 v41, v18, v18
    v_add_f32 v40, v40, v19
    v_fmac_f32 v41, v19, v19
    v_add_f32 v40, v40, v20
    v_fmac_f32 v41, v20, v20
    v_add_f32 v40, v40, v21
    v_fmac_f32 v41, v21, v21
    v_add_f32 v40, v40, v22
    v_fmac_f32 v41, v22, v22
    v_add_f32 v40, v40, v23
    v_fmac_f32 v41, v23, v23
    v_add_f32 v40, v40, v24
    v_fmac_f32 v41, v24, v24
    v_add_f32 v40, v40, v25
    v_fmac_f32 v41, v25, v25
    v_add_f32 v40, v40, v26
    v_fmac_f32 v41, v26, v26
    v_add_f32 v40, v40, v27
    v_fmac_f32 v41, v27, v27
    v_add_f32 v40, v40, v28
    v_fmac_f32 v41, v28, v28
    v_add_f32 v40, v40, v29
    v_fmac_f32 v41, v29, v29
    v_add_f32 v40, v40, v30
    v_fmac_f32 v41, v30, v30
    v_add_f32 v40, v40, v31
    v_fmac_f32 v41, v31, v31
    v_add_f32 v40, v40, v32
    v_fmac_f32 v41, v32, v32
    v_add_f32 v40, v40, v33
    v_fmac_f32 v41, v33, v33
    v_add_f32 v40, v40, v34
    v_fmac_f32 v41, v34, v34
    v_add_f32 v40, v40, v35
    v_fmac_f32 v41, v35, v35
    v_xor_b32 v44, 32, v1
    v_lshlrev_b32 v44, 2, v44
    ds_swizzle_b32 v42, v40 offset:0x401F
    ds_swizzle_b32 v43, v41 offset:0x401F
    s_waitcnt lgkmcnt(0)
    v_add_f32 v40, v40, v42
    v_add_f32 v41, v41, v43
    ds_bpermute_b32 v42, v44, v40
    ds_bpermute_b32 v43, v44, v41
    s_waitcnt lgkmcnt(0)
    v_add_f32 v40, v40, v42
    v_add_f32 v41, v41, v43
    v_lshlrev_b32 v44, 3, v1
    s_lshl_b32 s36, s24, 10
    s_lshl_b32 s37, s22, 7
    s_add_u32 s36, s36, s37
    s_add_u32 s36, s36, 29360128
    s_mov_b64 exec, 0xffff
    buffer_store_dwordx2 v[40:41], v44, s[4:7], s36 offen sc1
    s_mov_b64 exec, -1
    s_waitcnt vmcnt(0)
    s_barrier
    s_cmp_lg_u32 s30, 0
    s_cbranch_scc1 Lsig13
    s_lshl_b32 s20, s21, 7
    s_lshl_b32 s23, s22, 2
    s_add_u32 s20, s20, s23
    s_add_u32 s20, s20, 29892608
    v_mov_b32 v14, s31
    v_mov_b32 v15, 0
    s_mov_b64 exec, 1
    buffer_store_dword v14, v15, s[4:7], s20 offen sc1
    s_mov_b64 exec, -1
Lsig13:
    s_cmp_lg_u32 s30, 3
    s_cbranch_scc1 L_g2c
    s_lshl_b32 s24, s44, 2
    s_add_u32 s24, s24, s30
    s_mul_i32 s24, s24, 2
    s_mul_i32 s25, s24, 20480
    s_add_u32 s25, s25, 7864320
    s_add_u32 s26, s25, 20480
    s_mul_i32 s27, s45, 122880
    s_add_u32 s27, s27, 18874368
    s_mul_i32 s29, s30, 6144
    s_add_u32 s28, s27, s29
    v_mov_b32 v16, 0
    v_mov_b32 v17, 0
    v_mov_b32 v18, 0
    v_mov_b32 v19, 0
    v_mov_b32 v20, 0
    v_mov_b32 v21, 0
    v_mov_b32 v22, 0
    v_mov_b32 v23, 0
    v_mov_b32 v24, 0
    v_mov_b32 v25, 0
    v_mov_b32 v26, 0
    v_mov_b32 v27, 0
    v_mov_b32 v28, 0
    v_mov_b32 v29, 0
    v_mov_b32 v30, 0
    v_mov_b32 v31, 0
    v_mov_b32 v32, 0
    v_mov_b32 v33, 0
    v_mov_b32 v34, 0
    v_mov_b32 v35, 0
    v_mov_b32 v36, 0
    v_mov_b32 v37, 0
    v_mov_b32 v38, 0
    v_mov_b32 v39, 0
    v_mov_b32 v8, 0x3f803f80
    v_mov_b32 v9, 0x3f803f80
    v_mov_b32 v10, 0x3f803f80
    v_mov_b32 v11, 0x3f803f80
    v_add_u32 v3, 0x10000, v2
    s_mov_b32 m0, 0
    s_add_u32 s33, s27, 0
    buffer_load_dwordx4 v2, s[4:7], s33 offen offset:0 sc1 lds
    buffer_load_dwordx4 v2, s[4:7], s33 offen offset:1024 sc1 lds
    buffer_load_dwordx4 v2, s[4:7], s33 offen offset:2048 sc1 lds
    buffer_load_dwordx4 v2, s[4:7], s33 offen offset:3072 sc1 lds
    s_mov_b32 m0, 4096
    s_add_u32 s33, s27, 4096
    buffer_load_dwordx4 v2, s[4:7], s33 offen offset:0 sc1 lds
    buffer_load_dwordx4 v2, s[4:7], s33 offen offset:1024 sc1 lds
    buffer_load_dwordx4 v2, s[4:7], s33 offen offset:2048 sc1 lds
    buffer_load_dwordx4 v2, s[4:7], s33 offen offset:3072 sc1 lds
    s_mov_b32 m0, 8192
    s_add_u32 s33, s27, 8192
    buffer_load_dwordx4 v2, s[4:7], s33 offen offset:0 sc1 lds
    buffer_load_dwordx4 v2, s[4:7], s33 offen offset:1024 sc1 lds
    buffer_load_dwordx4 v2, s[4:7], s33 offen offset:2048 sc1 lds
    buffer_load_dwordx4 v2, s[4:7], s33 offen offset:3072 sc1 lds
    s_mov_b32 m0, 12288
    s_add_u32 s33, s27, 12288
    buffer_load_dwordx4 v2, s[4:7], s33 offen offset:0 sc1 lds
    buffer_load_dwordx4 v2, s[4:7], s33 offen offset:1024 sc1 lds
    buffer_load_dwordx4 v2, s[4:7], s33 offen offset:2048 sc1 lds
    buffer_load_dwordx4 v2, s[4:7], s33 offen offset:3072 sc1 lds
    s_mov_b32 m0, 16384
    s_add_u32 s33, s27, 16384
    buffer_load_dwordx4 v2, s[4:7], s33 offen offset:0 sc1 lds
    buffer_load_dwordx4 v2, s[4:7], s33 offen offset:1024 sc1 lds
    buffer_load_dwordx4 v2, s[4:7], s33 offen offset:2048 sc1 lds
    buffer_load_dwordx4 v2, s[4:7], s33 offen offset:3072 sc1 lds
    s_mov_b32 m0, 20480
    s_add_u32 s33, s27, 20480
    buffer_load_dwordx4 v2, s[4:7], s33 offen offset:0 sc1 lds
    buffer_load_dwordx4 v2, s[4:7], s33 offen offset:1024 sc1 lds
    buffer_load_dwordx4 v2, s[4:7], s33 offen offset:2048 sc1 lds
    buffer_load_dwordx4 v2, s[4:7], s33 offen offset:3072 sc1 lds
    s_mov_b32 m0, 24576
    s_add_u32 s33, s27, 24576
    buffer_load_dwordx4 v2, s[4:7], s33 offen offset:0 sc1 lds
    buffer_load_dwordx4 v2, s[4:7], s33 offen offset:1024 sc1 lds
    buffer_load_dwordx4 v2, s[4:7], s33 offen offset:2048 sc1 lds
    buffer_load_dwordx4 v2, s[4:7], s33 offen offset:3072 sc1 lds
    s_mov_b32 m0, 28672
    s_add_u32 s33, s27, 28672
    buffer_load_dwordx4 v2, s[4:7], s33 offen offset:0 sc1 lds
    buffer_load_dwordx4 v2, s[4:7], s33 offen offset:1024 sc1 lds
    buffer_load_dwordx4 v2, s[4:7], s33 offen offset:2048 sc1 lds
    buffer_load_dwordx4 v2, s[4:7], s33 offen offset:3072 sc1 lds
    s_mov_b32 m0, 32768
    s_add_u32 s33, s27, 32768
    buffer_load_dwordx4 v2, s[4:7], s33 offen offset:0 sc1 lds
    buffer_load_dwordx4 v2, s[4:7], s33 offen offset:1024 sc1 lds
    buffer_load_dwordx4 v2, s[4:7], s33 offen offset:2048 sc1 lds
    buffer_load_dwordx4 v2, s[4:7], s33 offen offset:3072 sc1 lds
    s_mov_b32 m0, 36864
    s_add_u32 s33, s27, 36864
    buffer_load_dwordx4 v2, s[4:7], s33 offen offset:0 sc1 lds
    buffer_load_dwordx4 v2, s[4:7], s33 offen offset:1024 sc1 lds
    buffer_load_dwordx4 v2, s[4:7], s33 offen offset:2048 sc1 lds
    buffer_load_dwordx4 v2, s[4:7], s33 offen offset:3072 sc1 lds
    s_mov_b32 m0, 40960
    s_add_u32 s33, s27, 40960
    buffer_load_dwordx4 v2, s[4:7], s33 offen offset:0 sc1 lds
    buffer_load_dwordx4 v2, s[4:7], s33 offen offset:1024 sc1 lds
    buffer_load_dwordx4 v2, s[4:7], s33 offen offset:2048 sc1 lds
    buffer_load_dwordx4 v2, s[4:7], s33 offen offset:3072 sc1 lds
    s_mov_b32 m0, 45056
    s_add_u32 s33, s27, 45056
    buffer_load_dwordx4 v2, s[4:7], s33 offen offset:0 sc1 lds
    buffer_load_dwordx4 v2, s[4:7], s33 offen offset:1024 sc1 lds
    buffer_load_dwordx4 v2, s[4:7], s33 offen offset:2048 sc1 lds
    buffer_load_dwordx4 v2, s[4:7], s33 offen offset:3072 sc1 lds
    s_waitcnt vmcnt(42)
    ds_read_b128 v[64:67], v2 offset:0
    ds_read_b128 v[68:71], v2 offset:1024
    ds_read_b128 v[72:75], v2 offset:2048
    ds_read_b128 v[76:79], v2 offset:3072
    ds_read_b128 v[80:83], v2 offset:4096
    ds_read_b128 v[84:87], v2 offset:5120
    s_mov_b32 m0, 49152
    s_add_u32 s33, s27, 49152
    buffer_load_dwordx4 v2, s[4:7], s33 offen offset:0 sc1 lds
    buffer_load_dwordx4 v2, s[4:7], s33 offen offset:1024 sc1 lds
    buffer_load_dwordx4 v2, s[4:7], s33 offen offset:2048 sc1 lds
    buffer_load_dwordx4 v2, s[4:7], s33 offen offset:3072 sc1 lds
    s_mov_b32 m0, 53248
    s_add_u32 s33, s27, 53248
    buffer_load_dwordx4 v2, s[4:7], s33 offen offset:0 sc1 lds
    buffer_load_dwordx4 v2, s[4:7], s33 offen offset:1024 sc1 lds
    s_waitcnt lgkmcnt(5)
    v_mfma_f32_16x16x32_bf16 v[16:19], v[64:67], v[8:11], v[16:19]
    s_waitcnt lgkmcnt(4)
    v_mfma_f32_16x16x32_bf16 v[20:23], v[68:71], v[8:11], v[20:23]
    s_waitcnt lgkmcnt(3)
    v_mfma_f32_16x16x32_bf16 v[24:27], v[72:75], v[8:11], v[24:27]
    s_waitcnt lgkmcnt(2)
    v_mfma_f32_16x16x32_bf16 v[28:31], v[76:79], v[8:11], v[28:31]
    s_waitcnt lgkmcnt(1)
    v_mfma_f32_16x16x32_bf16 v[32:35], v[80:83], v[8:11], v[32:35]
    s_waitcnt lgkmcnt(0)
    v_mfma_f32_16x16x32_bf16 v[36:39], v[84:87], v[8:11], v[36:39]
    s_waitcnt vmcnt(42)
    ds_read_b128 v[64:67], v2 offset:6144
    ds_read_b128 v[68:71], v2 offset:7168
    ds_read_b128 v[72:75], v2 offset:8192
    ds_read_b128 v[76:79], v2 offset:9216
    ds_read_b128 v[80:83], v2 offset:10240
    ds_read_b128 v[84:87], v2 offset:11264
    buffer_load_dwordx4 v2, s[4:7], s33 offen offset:2048 sc1 lds
    buffer_load_dwordx4 v2, s[4:7], s33 offen offset:3072 sc1 lds
    s_mov_b32 m0, 57344
    s_add_u32 s33, s27, 57344
    buffer_load_dwordx4 v2, s[4:7], s33 offen offset:0 sc1 lds
    buffer_load_dwordx4 v2, s[4:7], s33 offen offset:1024 sc1 lds
    buffer_load_dwordx4 v2, s[4:7], s33 offen offset:2048 sc1 lds
    buffer_load_dwordx4 v2, s[4:7], s33 offen offset:3072 sc1 lds
    s_waitcnt lgkmcnt(5)
    v_mfma_f32_16x16x32_bf16 v[16:19], v[64:67], v[8:11], v[16:19]
    s_waitcnt lgkmcnt(4)
    v_mfma_f32_16x16x32_bf16 v[20:23], v[68:71], v[8:11], v[20:23]
    s_waitcnt lgkmcnt(3)
    v_mfma_f32_16x16x32_bf16 v[24:27], v[72:75], v[8:11], v[24:27]
    s_waitcnt lgkmcnt(2)
    v_mfma_f32_16x16x32_bf16 v[28:31], v[76:79], v[8:11], v[28:31]
    s_waitcnt lgkmcnt(1)
    v_mfma_f32_16x16x32_bf16 v[32:35], v[80:83], v[8:11], v[32:35]
    s_waitcnt lgkmcnt(0)
    v_mfma_f32_16x16x32_bf16 v[36:39], v[84:87], v[8:11], v[36:39]
    s_waitcnt vmcnt(42)
    ds_read_b128 v[64:67], v2 offset:12288
    ds_read_b128 v[68:71], v2 offset:13312
    ds_read_b128 v[72:75], v2 offset:14336
    ds_read_b128 v[76:79], v2 offset:15360
    ds_read_b128 v[80:83], v2 offset:16384
    ds_read_b128 v[84:87], v2 offset:17408
    s_mov_b32 m0, 61440
    s_add_u32 s33, s27, 61440
    buffer_load_dwordx4 v2, s[4:7], s33 offen offset:0 sc1 lds
    buffer_load_dwordx4 v2, s[4:7], s33 offen offset:1024 sc1 lds
    buffer_load_dwordx4 v2, s[4:7], s33 offen offset:2048 sc1 lds
    buffer_load_dwordx4 v2, s[4:7], s33 offen offset:3072 sc1 lds
    s_mov_b32 m0, 65536
    s_add_u32 s33, s27, 65536
    buffer_load_dwordx4 v2, s[4:7], s33 offen offset:0 sc1 lds
    buffer_load_dwordx4 v2, s[4:7], s33 offen offset:1024 sc1 lds
    s_waitcnt lgkmcnt(5)
    v_mfma_f32_16x16x32_bf16 v[16:19], v[64:67], v[8:11], v[16:19]
    s_waitcnt lgkmcnt(4)
    v_mfma_f32_16x16x32_bf16 v[20:23], v[68:71], v[8:11], v[20:23]
    s_waitcnt lgkmcnt(3)
    v_mfma_f32_16x16x32_bf16 v[24:27], v[72:75], v[8:11], v[24:27]
    s_waitcnt lgkmcnt(2)
    v_mfma_f32_16x16x32_bf16 v[28:31], v[76:79], v[8:11], v[28:31]
    s_waitcnt lgkmcnt(1)
    v_mfma_f32_16x16x32_bf16 v[32:35], v[80:83], v[8:11], v[32:35]
    s_waitcnt lgkmcnt(0)
    v_mfma_f32_16x16x32_bf16 v[36:39], v[84:87], v[8:11], v[36:39]
    s_waitcnt vmcnt(42)
    ds_read_b128 v[64:67], v2 offset:18432
    ds_read_b128 v[68:71], v2 offset:19456
    ds_read_b128 v[72:75], v2 offset:20480
    ds_read_b128 v[76:79], v2 offset:21504
    ds_read_b128 v[80:83], v2 offset:22528
    ds_read_b128 v[84:87], v2 offset:23552
    buffer_load_dwordx4 v2, s[4:7], s33 offen offset:2048 sc1 lds
    buffer_load_dwordx4 v2, s[4:7], s33 offen offset:3072 sc1 lds
    s_mov_b32 m0, 69632
    s_add_u32 s33, s27, 69632
    buffer_load_dwordx4 v2, s[4:7], s33 offen offset:0 sc1 lds
    buffer_load_dwordx4 v2, s[4:7], s33 offen offset:1024 sc1 lds
    buffer_load_dwordx4 v2, s[4:7], s33 offen offset:2048 sc1 lds
    buffer_load_dwordx4 v2, s[4:7], s33 offen offset:3072 sc1 lds
    s_waitcnt lgkmcnt(5)
    v_mfma_f32_16x16x32_bf16 v[16:19], v[64:67], v[8:11], v[16:19]
    s_waitcnt lgkmcnt(4)
    v_mfma_f32_16x16x32_bf16 v[20:23], v[68:71], v[8:11], v[20:23]
    s_waitcnt lgkmcnt(3)
    v_mfma_f32_16x16x32_bf16 v[24:27], v[72:75], v[8:11], v[24:27]
    s_waitcnt lgkmcnt(2)
    v_mfma_f32_16x16x32_bf16 v[28:31], v[76:79], v[8:11], v[28:31]
    s_waitcnt lgkmcnt(1)
    v_mfma_f32_16x16x32_bf16 v[32:35], v[80:83], v[8:11], v[32:35]
    s_waitcnt lgkmcnt(0)
    v_mfma_f32_16x16x32_bf16 v[36:39], v[84:87], v[8:11], v[36:39]
    s_waitcnt vmcnt(42)
    ds_read_b128 v[64:67], v2 offset:24576
    ds_read_b128 v[68:71], v2 offset:25600
    ds_read_b128 v[72:75], v2 offset:26624
    ds_read_b128 v[76:79], v2 offset:27648
    ds_read_b128 v[80:83], v2 offset:28672
    ds_read_b128 v[84:87], v2 offset:29696
    s_mov_b32 m0, 73728
    s_add_u32 s33, s27, 73728
    buffer_load_dwordx4 v2, s[4:7], s33 offen offset:0 sc1 lds
    buffer_load_dwordx4 v2, s[4:7], s33 offen offset:1024 sc1 lds
    buffer_load_dwordx4 v2, s[4:7], s33 offen offset:2048 sc1 lds
    buffer_load_dwordx4 v2, s[4:7], s33 offen offset:3072 sc1 lds
    s_mov_b32 m0, 77824
    s_add_u32 s33, s27, 77824
    buffer_load_dwordx4 v2, s[4:7], s33 offen offset:0 sc1 lds
    buffer_load_dwordx4 v2, s[4:7], s33 offen offset:1024 sc1 lds
    s_waitcnt lgkmcnt(5)
    v_mfma_f32_16x16x32_bf16 v[16:19], v[64:67], v[8:11], v[16:19]
    s_waitcnt lgkmcnt(4)
    v_mfma_f32_16x16x32_bf16 v[20:23], v[68:71], v[8:11], v[20:23]
    s_waitcnt lgkmcnt(3)
    v_mfma_f32_16x16x32_bf16 v[24:27], v[72:75], v[8:11], v[24:27]
    s_waitcnt lgkmcnt(2)
    v_mfma_f32_16x16x32_bf16 v[28:31], v[76:79], v[8:11], v[28:31]
    s_waitcnt lgkmcnt(1)
    v_mfma_f32_16x16x32_bf16 v[32:35], v[80:83], v[8:11], v[32:35]
    s_waitcnt lgkmcnt(0)
    v_mfma_f32_16x16x32_bf16 v[36:39], v[84:87], v[8:11], v[36:39]
    s_waitcnt vmcnt(42)
    ds_read_b128 v[64:67], v2 offset:30720
    ds_read_b128 v[68:71], v2 offset:31744
    ds_read_b128 v[72:75], v2 offset:32768
    ds_read_b128 v[76:79], v2 offset:33792
    ds_read_b128 v[80:83], v2 offset:34816
    ds_read_b128 v[84:87], v2 offset:35840
    buffer_load_dwordx4 v2, s[4:7], s33 offen offset:2048 sc1 lds
    buffer_load_dwordx4 v2, s[4:7], s33 offen offset:3072 sc1 lds
    s_mov_b32 m0, 81920
    s_add_u32 s33, s27, 81920
    buffer_load_dwordx4 v2, s[4:7], s33 offen offset:0 sc1 lds
    buffer_load_dwordx4 v2, s[4:7], s33 offen offset:1024 sc1 lds
    buffer_load_dwordx4 v2, s[4:7], s33 offen offset:2048 sc1 lds
    buffer_load_dwordx4 v2, s[4:7], s33 offen offset:3072 sc1 lds
    s_waitcnt lgkmcnt(5)
    v_mfma_f32_16x16x32_bf16 v[16:19], v[64:67], v[8:11], v[16:19]
    s_waitcnt lgkmcnt(4)
    v_mfma_f32_16x16x32_bf16 v[20:23], v[68:71], v[8:11], v[20:23]
    s_waitcnt lgkmcnt(3)
    v_mfma_f32_16x16x32_bf16 v[24:27], v[72:75], v[8:11], v[24:27]
    s_waitcnt lgkmcnt(2)
    v_mfma_f32_16x16x32_bf16 v[28:31], v[76:79], v[8:11], v[28:31]
    s_waitcnt lgkmcnt(1)
    v_mfma_f32_16x16x32_bf16 v[32:35], v[80:83], v[8:11], v[32:35]
    s_waitcnt lgkmcnt(0)
    v_mfma_f32_16x16x32_bf16 v[36:39], v[84:87], v[8:11], v[36:39]
    s_waitcnt vmcnt(42)
    ds_read_b128 v[64:67], v2 offset:36864
    ds_read_b128 v[68:71], v2 offset:37888
    ds_read_b128 v[72:75], v2 offset:38912
    ds_read_b128 v[76:79], v2 offset:39936
    ds_read_b128 v[80:83], v2 offset:40960
    ds_read_b128 v[84:87], v2 offset:41984
    s_mov_b32 m0, 86016
    s_add_u32 s33, s27, 86016
    buffer_load_dwordx4 v2, s[4:7], s33 offen offset:0 sc1 lds
    buffer_load_dwordx4 v2, s[4:7], s33 offen offset:1024 sc1 lds
    buffer_load_dwordx4 v2, s[4:7], s33 offen offset:2048 sc1 lds
    buffer_load_dwordx4 v2, s[4:7], s33 offen offset:3072 sc1 lds
    s_mov_b32 m0, 90112
    s_add_u32 s33, s27, 90112
    buffer_load_dwordx4 v2, s[4:7], s33 offen offset:0 sc1 lds
    buffer_load_dwordx4 v2, s[4:7], s33 offen offset:1024 sc1 lds
    s_waitcnt lgkmcnt(5)
    v_mfma_f32_16x16x32_bf16 v[16:19], v[64:67], v[8:11], v[16:19]
    s_waitcnt lgkmcnt(4)
    v_mfma_f32_16x16x32_bf16 v[20:23], v[68:71], v[8:11], v[20:23]
    s_waitcnt lgkmcnt(3)
    v_mfma_f32_16x16x32_bf16 v[24:27], v[72:75], v[8:11], v[24:27]
    s_waitcnt lgkmcnt(2)
    v_mfma_f32_16x16x32_bf16 v[28:31], v[76:79], v[8:11], v[28:31]
    s_waitcnt lgkmcnt(1)
    v_mfma_f32_16x16x32_bf16 v[32:35], v[80:83], v[8:11], v[32:35]
    s_waitcnt lgkmcnt(0)
    v_mfma_f32_16x16x32_bf16 v[36:39], v[84:87], v[8:11], v[36:39]
    s_waitcnt vmcnt(42)
    ds_read_b128 v[64:67], v2 offset:43008
    ds_read_b128 v[68:71], v2 offset:44032
    ds_read_b128 v[72:75], v2 offset:45056
    ds_read_b128 v[76:79], v2 offset:46080
    ds_read_b128 v[80:83], v2 offset:47104
    ds_read_b128 v[84:87], v2 offset:48128
    buffer_load_dwordx4 v2, s[4:7], s33 offen offset:2048 sc1 lds
    buffer_load_dwordx4 v2, s[4:7], s33 offen offset:3072 sc1 lds
    s_mov_b32 m0, 94208
    s_add_u32 s33, s27, 94208
    buffer_load_dwordx4 v2, s[4:7], s33 offen offset:0 sc1 lds
    buffer_load_dwordx4 v2, s[4:7], s33 offen offset:1024 sc1 lds
    buffer_load_dwordx4 v2, s[4:7], s33 offen offset:2048 sc1 lds
    buffer_load_dwordx4 v2, s[4:7], s33 offen offset:3072 sc1 lds
    s_waitcnt lgkmcnt(5)
    v_mfma_f32_16x16x32_bf16 v[16:19], v[64:67], v[8:11], v[16:19]
    s_waitcnt lgkmcnt(4)
    v_mfma_f32_16x16x32_bf16 v[20:23], v[68:71], v[8:11], v[20:23]
    s_waitcnt lgkmcnt(3)
    v_mfma_f32_16x16x32_bf16 v[24:27], v[72:75], v[8:11], v[24:27]
    s_waitcnt lgkmcnt(2)
    v_mfma_f32_16x16x32_bf16 v[28:31], v[76:79], v[8:11], v[28:31]
    s_waitcnt lgkmcnt(1)
    v_mfma_f32_16x16x32_bf16 v[32:35], v[80:83], v[8:11], v[32:35]
    s_waitcnt lgkmcnt(0)
    v_mfma_f32_16x16x32_bf16 v[36:39], v[84:87], v[8:11], v[36:39]
    s_waitcnt vmcnt(42)
    ds_read_b128 v[64:67], v2 offset:49152
    ds_read_b128 v[68:71], v2 offset:50176
    ds_read_b128 v[72:75], v2 offset:51200
    ds_read_b128 v[76:79], v2 offset:52224
    ds_read_b128 v[80:83], v2 offset:53248
    ds_read_b128 v[84:87], v2 offset:54272
    s_mov_b32 m0, 98304
    s_add_u32 s33, s27, 98304
    buffer_load_dwordx4 v2, s[4:7], s33 offen offset:0 sc1 lds
    buffer_load_dwordx4 v2, s[4:7], s33 offen offset:1024 sc1 lds
    buffer_load_dwordx4 v2, s[4:7], s33 offen offset:2048 sc1 lds
    buffer_load_dwordx4 v2, s[4:7], s33 offen offset:3072 sc1 lds
    s_mov_b32 m0, 102400
    s_add_u32 s33, s27, 102400
    buffer_load_dwordx4 v2, s[4:7], s33 offen offset:0 sc1 lds
    buffer_load_dwordx4 v2, s[4:7], s33 offen offset:1024 sc1 lds
    s_waitcnt lgkmcnt(5)
    v_mfma_f32_16x16x32_bf16 v[16:19], v[64:67], v[8:11], v[16:19]
    s_waitcnt lgkmcnt(4)
    v_mfma_f32_16x16x32_bf16 v[20:23], v[68:71], v[8:11], v[20:23]
    s_waitcnt lgkmcnt(3)
    v_mfma_f32_16x16x32_bf16 v[24:27], v[72:75], v[8:11], v[24:27]
    s_waitcnt lgkmcnt(2)
    v_mfma_f32_16x16x32_bf16 v[28:31], v[76:79], v[8:11], v[28:31]
    s_waitcnt lgkmcnt(1)
    v_mfma_f32_16x16x32_bf16 v[32:35], v[80:83], v[8:11], v[32:35]
    s_waitcnt lgkmcnt(0)
    v_mfma_f32_16x16x32_bf16 v[36:39], v[84:87], v[8:11], v[36:39]
    s_waitcnt vmcnt(42)
    ds_read_b128 v[64:67], v2 offset:55296
    ds_read_b128 v[68:71], v2 offset:56320
    ds_read_b128 v[72:75], v2 offset:57344
    ds_read_b128 v[76:79], v2 offset:58368
    ds_read_b128 v[80:83], v2 offset:59392
    ds_read_b128 v[84:87], v2 offset:60416
    buffer_load_dwordx4 v2, s[4:7], s33 offen offset:2048 sc1 lds
    buffer_load_dwordx4 v2, s[4:7], s33 offen offset:3072 sc1 lds
    s_mov_b32 m0, 106496
    s_add_u32 s33, s27, 106496
    buffer_load_dwordx4 v2, s[4:7], s33 offen offset:0 sc1 lds
    buffer_load_dwordx4 v2, s[4:7], s33 offen offset:1024 sc1 lds
    buffer_load_dwordx4 v2, s[4:7], s33 offen offset:2048 sc1 lds
    buffer_load_dwordx4 v2, s[4:7], s33 offen offset:3072 sc1 lds
    s_waitcnt lgkmcnt(5)
    v_mfma_f32_16x16x32_bf16 v[16:19], v[64:67], v[8:11], v[16:19]
    s_waitcnt lgkmcnt(4)
    v_mfma_f32_16x16x32_bf16 v[20:23], v[68:71], v[8:11], v[20:23]
    s_waitcnt lgkmcnt(3)
    v_mfma_f32_16x16x32_bf16 v[24:27], v[72:75], v[8:11], v[24:27]
    s_waitcnt lgkmcnt(2)
    v_mfma_f32_16x16x32_bf16 v[28:31], v[76:79], v[8:11], v[28:31]
    s_waitcnt lgkmcnt(1)
    v_mfma_f32_16x16x32_bf16 v[32:35], v[80:83], v[8:11], v[32:35]
    s_waitcnt lgkmcnt(0)
    v_mfma_f32_16x16x32_bf16 v[36:39], v[84:87], v[8:11], v[36:39]
    s_waitcnt vmcnt(42)
    ds_read_b128 v[64:67], v2 offset:61440
    ds_read_b128 v[68:71], v2 offset:62464
    ds_read_b128 v[72:75], v2 offset:63488
    ds_read_b128 v[76:79], v2 offset:64512
    ds_read_b128 v[80:83], v3 offset:0
    ds_read_b128 v[84:87], v3 offset:1024
    s_mov_b32 m0, 110592
    s_add_u32 s33, s27, 110592
    buffer_load_dwordx4 v2, s[4:7], s33 offen offset:0 sc1 lds
    buffer_load_dwordx4 v2, s[4:7], s33 offen offset:1024 sc1 lds
    buffer_load_dwordx4 v2, s[4:7], s33 offen offset:2048 sc1 lds
    buffer_load_dwordx4 v2, s[4:7], s33 offen offset:3072 sc1 lds
    s_mov_b32 m0, 114688
    s_add_u32 s33, s27, 114688
    buffer_load_dwordx4 v2, s[4:7], s33 offen offset:0 sc1 lds
    buffer_load_dwordx4 v2, s[4:7], s33 offen offset:1024 sc1 lds
    s_waitcnt lgkmcnt(5)
    v_mfma_f32_16x16x32_bf16 v[16:19], v[64:67], v[8:11], v[16:19]
    s_waitcnt lgkmcnt(4)
    v_mfma_f32_16x16x32_bf16 v[20:23], v[68:71], v[8:11], v[20:23]
    s_waitcnt lgkmcnt(3)
    v_mfma_f32_16x16x32_bf16 v[24:27], v[72:75], v[8:11], v[24:27]
    s_waitcnt lgkmcnt(2)
    v_mfma_f32_16x16x32_bf16 v[28:31], v[76:79], v[8:11], v[28:31]
    s_waitcnt lgkmcnt(1)
    v_mfma_f32_16x16x32_bf16 v[32:35], v[80:83], v[8:11], v[32:35]
    s_waitcnt lgkmcnt(0)
    v_mfma_f32_16x16x32_bf16 v[36:39], v[84:87], v[8:11], v[36:39]
    s_waitcnt vmcnt(42)
    ds_read_b128 v[64:67], v3 offset:2048
    ds_read_b128 v[68:71], v3 offset:3072
    ds_read_b128 v[72:75], v3 offset:4096
    ds_read_b128 v[76:79], v3 offset:5120
    ds_read_b128 v[80:83], v3 offset:6144
    ds_read_b128 v[84:87], v3 offset:7168
    buffer_load_dwordx4 v2, s[4:7], s33 offen offset:2048 sc1 lds
    buffer_load_dwordx4 v2, s[4:7], s33 offen offset:3072 sc1 lds
    s_mov_b32 m0, 118784
    s_add_u32 s33, s27, 118784
    buffer_load_dwordx4 v2, s[4:7], s33 offen offset:0 sc1 lds
    buffer_load_dwordx4 v2, s[4:7], s33 offen offset:1024 sc1 lds
    buffer_load_dwordx4 v2, s[4:7], s33 offen offset:2048 sc1 lds
    buffer_load_dwordx4 v2, s[4:7], s33 offen offset:3072 sc1 lds
    s_waitcnt lgkmcnt(5)
    v_mfma_f32_16x16x32_bf16 v[16:19], v[64:67], v[8:11], v[16:19]
    s_waitcnt lgkmcnt(4)
    v_mfma_f32_16x16x32_bf16 v[20:23], v[68:71], v[8:11], v[20:23]
    s_waitcnt lgkmcnt(3)
    v_mfma_f32_16x16x32_bf16 v[24:27], v[72:75], v[8:11], v[24:27]
    s_waitcnt lgkmcnt(2)
    v_mfma_f32_16x16x32_bf16 v[28:31], v[76:79], v[8:11], v[28:31]
    s_waitcnt lgkmcnt(1)
    v_mfma_f32_16x16x32_bf16 v[32:35], v[80:83], v[8:11], v[32:35]
    s_waitcnt lgkmcnt(0)
    v_mfma_f32_16x16x32_bf16 v[36:39], v[84:87], v[8:11], v[36:39]
    s_waitcnt vmcnt(42)
    ds_read_b128 v[64:67], v3 offset:8192
    ds_read_b128 v[68:71], v3 offset:9216
    ds_read_b128 v[72:75], v3 offset:10240
    ds_read_b128 v[76:79], v3 offset:11264
    ds_read_b128 v[80:83], v3 offset:12288
    ds_read_b128 v[84:87], v3 offset:13312
    s_waitcnt lgkmcnt(5)
    v_mfma_f32_16x16x32_bf16 v[16:19], v[64:67], v[8:11], v[16:19]
    s_waitcnt lgkmcnt(4)
    v_mfma_f32_16x16x32_bf16 v[20:23], v[68:71], v[8:11], v[20:23]
    s_waitcnt lgkmcnt(3)
    v_mfma_f32_16x16x32_bf16 v[24:27], v[72:75], v[8:11], v[24:27]
    s_waitcnt lgkmcnt(2)
    v_mfma_f32_16x16x32_bf16 v[28:31], v[76:79], v[8:11], v[28:31]
    s_waitcnt lgkmcnt(1)
    v_mfma_f32_16x16x32_bf16 v[32:35], v[80:83], v[8:11], v[32:35]
    s_waitcnt lgkmcnt(0)
    v_mfma_f32_16x16x32_bf16 v[36:39], v[84:87], v[8:11], v[36:39]
    s_waitcnt vmcnt(36)
    ds_read_b128 v[64:67], v3 offset:14336
    ds_read_b128 v[68:71], v3 offset:15360
    ds_read_b128 v[72:75], v3 offset:16384
    ds_read_b128 v[76:79], v3 offset:17408
    ds_read_b128 v[80:83], v3 offset:18432
    ds_read_b128 v[84:87], v3 offset:19456
    s_waitcnt lgkmcnt(5)
    v_mfma_f32_16x16x32_bf16 v[16:19], v[64:67], v[8:11], v[16:19]
    s_waitcnt lgkmcnt(4)
    v_mfma_f32_16x16x32_bf16 v[20:23], v[68:71], v[8:11], v[20:23]
    s_waitcnt lgkmcnt(3)
    v_mfma_f32_16x16x32_bf16 v[24:27], v[72:75], v[8:11], v[24:27]
    s_waitcnt lgkmcnt(2)
    v_mfma_f32_16x16x32_bf16 v[28:31], v[76:79], v[8:11], v[28:31]
    s_waitcnt lgkmcnt(1)
    v_mfma_f32_16x16x32_bf16 v[32:35], v[80:83], v[8:11], v[32:35]
    s_waitcnt lgkmcnt(0)
    v_mfma_f32_16x16x32_bf16 v[36:39], v[84:87], v[8:11], v[36:39]
    s_waitcnt vmcnt(30)
    ds_read_b128 v[64:67], v3 offset:20480
    ds_read_b128 v[68:71], v3 offset:21504
    ds_read_b128 v[72:75], v3 offset:22528
    ds_read_b128 v[76:79], v3 offset:23552
    ds_read_b128 v[80:83], v3 offset:24576
    ds_read_b128 v[84:87], v3 offset:25600
    s_waitcnt lgkmcnt(5)
    v_mfma_f32_16x16x32_bf16 v[16:19], v[64:67], v[8:11], v[16:19]
    s_waitcnt lgkmcnt(4)
    v_mfma_f32_16x16x32_bf16 v[20:23], v[68:71], v[8:11], v[20:23]
    s_waitcnt lgkmcnt(3)
    v_mfma_f32_16x16x32_bf16 v[24:27], v[72:75], v[8:11], v[24:27]
    s_waitcnt lgkmcnt(2)
    v_mfma_f32_16x16x32_bf16 v[28:31], v[76:79], v[8:11], v[28:31]
    s_waitcnt lgkmcnt(1)
    v_mfma_f32_16x16x32_bf16 v[32:35], v[80:83], v[8:11], v[32:35]
    s_waitcnt lgkmcnt(0)
    v_mfma_f32_16x16x32_bf16 v[36:39], v[84:87], v[8:11], v[36:39]
    s_waitcnt vmcnt(24)
    ds_read_b128 v[64:67], v3 offset:26624
    ds_read_b128 v[68:71], v3 offset:27648
    ds_read_b128 v[72:75], v3 offset:28672
    ds_read_b128 v[76:79], v3 offset:29696
    ds_read_b128 v[80:83], v3 offset:30720
    ds_read_b128 v[84:87], v3 offset:31744
    s_waitcnt lgkmcnt(5)
    v_mfma_f32_16x16x32_bf16 v[16:19], v[64:67], v[8:11], v[16:19]
    s_waitcnt lgkmcnt(4)
    v_mfma_f32_16x16x32_bf16 v[20:23], v[68:71], v[8:11], v[20:23]
    s_waitcnt lgkmcnt(3)
    v_mfma_f32_16x16x32_bf16 v[24:27], v[72:75], v[8:11], v[24:27]
    s_waitcnt lgkmcnt(2)
    v_mfma_f32_16x16x32_bf16 v[28:31], v[76:79], v[8:11], v[28:31]
    s_waitcnt lgkmcnt(1)
    v_mfma_f32_16x16x32_bf16 v[32:35], v[80:83], v[8:11], v[32:35]
    s_waitcnt lgkmcnt(0)
    v_mfma_f32_16x16x32_bf16 v[36:39], v[84:87], v[8:11], v[36:39]
    s_waitcnt vmcnt(18)
    ds_read_b128 v[64:67], v3 offset:32768
    ds_read_b128 v[68:71], v3 offset:33792
    ds_read_b128 v[72:75], v3 offset:34816
    ds_read_b128 v[76:79], v3 offset:35840
    ds_read_b128 v[80:83], v3 offset:36864
    ds_read_b128 v[84:87], v3 offset:37888
    s_waitcnt lgkmcnt(5)
    v_mfma_f32_16x16x32_bf16 v[16:19], v[64:67], v[8:11], v[16:19]
    s_waitcnt lgkmcnt(4)
    v_mfma_f32_16x16x32_bf16 v[20:23], v[68:71], v[8:11], v[20:23]
    s_waitcnt lgkmcnt(3)
    v_mfma_f32_16x16x32_bf16 v[24:27], v[72:75], v[8:11], v[24:27]
    s_waitcnt lgkmcnt(2)
    v_mfma_f32_16x16x32_bf16 v[28:31], v[76:79], v[8:11], v[28:31]
    s_waitcnt lgkmcnt(1)
    v_mfma_f32_16x16x32_bf16 v[32:35], v[80:83], v[8:11], v[32:35]
    s_waitcnt lgkmcnt(0)
    v_mfma_f32_16x16x32_bf16 v[36:39], v[84:87], v[8:11], v[36:39]
    s_waitcnt vmcnt(12)
    ds_read_b128 v[64:67], v3 offset:38912
    ds_read_b128 v[68:71], v3 offset:39936
    ds_read_b128 v[72:75], v3 offset:40960
    ds_read_b128 v[76:79], v3 offset:41984
    ds_read_b128 v[80:83], v3 offset:43008
    ds_read_b128 v[84:87], v3 offset:44032
    s_waitcnt lgkmcnt(5)
    v_mfma_f32_16x16x32_bf16 v[16:19], v[64:67], v[8:11], v[16:19]
    s_waitcnt lgkmcnt(4)
    v_mfma_f32_16x16x32_bf16 v[20:23], v[68:71], v[8:11], v[20:23]
    s_waitcnt lgkmcnt(3)
    v_mfma_f32_16x16x32_bf16 v[24:27], v[72:75], v[8:11], v[24:27]
    s_waitcnt lgkmcnt(2)
    v_mfma_f32_16x16x32_bf16 v[28:31], v[76:79], v[8:11], v[28:31]
    s_waitcnt lgkmcnt(1)
    v_mfma_f32_16x16x32_bf16 v[32:35], v[80:83], v[8:11], v[32:35]
    s_waitcnt lgkmcnt(0)
    v_mfma_f32_16x16x32_bf16 v[36:39], v[84:87], v[8:11], v[36:39]
    s_waitcnt vmcnt(6)
    ds_read_b128 v[64:67], v3 offset:45056
    ds_read_b128 v[68:71], v3 offset:46080
    ds_read_b128 v[72:75], v3 offset:47104
    ds_read_b128 v[76:79], v3 offset:48128
    ds_read_b128 v[80:83], v3 offset:49152
    ds_read_b128 v[84:87], v3 offset:50176
    s_waitcnt lgkmcnt(5)
    v_mfma_f32_16x16x32_bf16 v[16:19], v[64:67], v[8:11], v[16:19]
    s_waitcnt lgkmcnt(4)
    v_mfma_f32_16x16x32_bf16 v[20:23], v[68:71], v[8:11], v[20:23]
    s_waitcnt lgkmcnt(3)
    v_mfma_f32_16x16x32_bf16 v[24:27], v[72:75], v[8:11], v[24:27]
    s_waitcnt lgkmcnt(2)
    v_mfma_f32_16x16x32_bf16 v[28:31], v[76:79], v[8:11], v[28:31]
    s_waitcnt lgkmcnt(1)
    v_mfma_f32_16x16x32_bf16 v[32:35], v[80:83], v[8:11], v[32:35]
    s_waitcnt lgkmcnt(0)
    v_mfma_f32_16x16x32_bf16 v[36:39], v[84:87], v[8:11], v[36:39]
    s_waitcnt vmcnt(0)
    ds_read_b128 v[64:67], v3 offset:51200
    ds_read_b128 v[68:71], v3 offset:52224
    ds_read_b128 v[72:75], v3 offset:53248
    ds_read_b128 v[76:79], v3 offset:54272
    ds_read_b128 v[80:83], v3 offset:55296
    ds_read_b128 v[84:87], v3 offset:56320
    s_waitcnt lgkmcnt(5)
    v_mfma_f32_16x16x32_bf16 v[16:19], v[64:67], v[8:11], v[16:19]
    s_waitcnt lgkmcnt(4)
    v_mfma_f32_16x16x32_bf16 v[20:23], v[68:71], v[8:11], v[20:23]
    s_waitcnt lgkmcnt(3)
    v_mfma_f32_16x16x32_bf16 v[24:27], v[72:75], v[8:11], v[24:27]
    s_waitcnt lgkmcnt(2)
    v_mfma_f32_16x16x32_bf16 v[28:31], v[76:79], v[8:11], v[28:31]
    s_waitcnt lgkmcnt(1)
    v_mfma_f32_16x16x32_bf16 v[32:35], v[80:83], v[8:11], v[32:35]
    s_waitcnt lgkmcnt(0)
    v_mfma_f32_16x16x32_bf16 v[36:39], v[84:87], v[8:11], v[36:39]
    v_and_b32 v5, 48, v1
    v_add_u32 v5, 162048, v5
    s_nop 6
    s_mov_b32 exec_lo, 0x10001
    s_mov_b32 exec_hi, 0x10001
    ds_write_b128 v5, v[16:19] offset:0
    ds_write_b128 v5, v[20:23] offset:64
    ds_write_b128 v5, v[24:27] offset:128
    ds_write_b128 v5, v[28:31] offset:192
    ds_write_b128 v5, v[32:35] offset:256
    ds_write_b128 v5, v[36:39] offset:320
    s_mov_b64 exec, -1
    s_waitcnt lgkmcnt(0)
    v_bfe_u32 v6, v1, 3, 1
    s_lshl_b32 s20, s44, 1
    v_add_u32 v6, s20, v6
    v_and_b32 v5, 7, v1
    v_lshlrev_b32 v5, 2, v5
    v_lshl_add_u32 v5, v6, 7, v5
    s_mov_b32 s46, 29892608
    s_mov_b32 s47, 0x40000
Lpoll14:
    buffer_load_dword v12, v5, s[4:7], s46 offen sc1
    s_waitcnt vmcnt(0)
    v_cmp_ne_u32 vcc, s31, v12
    s_sub_u32 s47, s47, 1
    s_cmp_eq_u32 s47, 0
    s_cbranch_scc1 Lpoll14_x
    s_nop 2
    s_cbranch_vccnz Lpoll14
Lpoll14_x:
    s_branch L_g2j
L_g2c:
    s_cmp_ge_u32 s60, 640
    s_cbranch_scc1 L_g2j
    ds_read_b128 a[64:67], v236 offset:3840
    ds_read2_b32 a[0:1], v232 offset0:64 offset1:65
    ds_read2_b32 a[2:3], v232 offset0:66 offset1:67
    ds_read_b128 a[68:71], v236 offset:3328
    ds_read2_b32 a[4:5], v232 offset0:192 offset1:193
    ds_read2_b32 a[6:7], v232 offset0:194 offset1:195
    ds_read_b128 a[72:75], v236 offset:2816
    ds_read2_b32 a[8:9], v233 offset0:64 offset1:65
    ds_read2_b32 a[10:11], v233 offset0:66 offset1:67
    ds_read_b128 a[76:79], v236 offset:2304
    ds_read2_b32 a[12:13], v233 offset0:192 offset1:193
    ds_read2_b32 a[14:15], v233 offset0:194 offset1:195
    ds_read_b128 a[80:83], v236 offset:1792
    ds_read2_b32 a[16:17], v234 offset0:64 offset1:65
    ds_read2_b32 a[18:19], v234 offset0:66 offset1:67
    ds_read_b128 a[84:87], v236 offset:1280
    ds_read2_b32 a[20:21], v234 offset0:192 offset1:193
    ds_read2_b32 a[22:23], v234 offset0:194 offset1:195
    ds_read_b128 a[88:91], v236 offset:768
    ds_read2_b32 a[24:25], v235 offset0:64 offset1:65
    ds_read2_b32 a[26:27], v235 offset0:66 offset1:67
    ds_read_b128 a[92:95], v236 offset:256
    ds_read2_b32 a[28:29], v235 offset0:192 offset1:193
    ds_read2_b32 a[30:31], v235 offset0:194 offset1:195
    s_waitcnt lgkmcnt(0)
    v_mfma_f32_16x16x32_bf16 v[200:203], a[0:3], a[64:67], v[200:203]
    ds_read_b128 a[96:99], v236 offset:3904
    v_mfma_f32_16x16x32_bf16 v[204:207], a[0:3], a[68:71], v[204:207]
    ds_read2_b32 a[32:33], v232 offset0:80 offset1:81
    v_mfma_f32_16x16x32_bf16 v[208:211], a[0:3], a[72:75], v[208:211]
    ds_read2_b32 a[34:35], v232 offset0:82 offset1:83
    v_mfma_f32_16x16x32_bf16 v[212:215], a[0:3], a[76:79], v[212:215]
    ds_read_b128 a[100:103], v236 offset:3392
    v_mfma_f32_16x16x32_bf16 v[216:219], a[0:3], a[80:83], v[216:219]
    ds_read2_b32 a[36:37], v232 offset0:208 offset1:209
    v_mfma_f32_16x16x32_bf16 v[220:223], a[0:3], a[84:87], v[220:223]
    ds_read2_b32 a[38:39], v232 offset0:210 offset1:211
    v_mfma_f32_16x16x32_bf16 v[224:227], a[0:3], a[88:91], v[224:227]
    ds_read_b128 a[104:107], v236 offset:2880
    v_mfma_f32_16x16x32_bf16 v[228:231], a[0:3], a[92:95], v[228:231]
    ds_read2_b32 a[40:41], v233 offset0:80 offset1:81
    v_mfma_f32_16x16x32_bf16 v[204:207], a[4:7], a[64:67], v[204:207]
    ds_read2_b32 a[42:43], v233 offset0:82 offset1:83
    v_mfma_f32_16x16x32_bf16 v[208:211], a[4:7], a[68:71], v[208:211]
    ds_read_b128 a[108:111], v236 offset:2368
    v_mfma_f32_16x16x32_bf16 v[212:215], a[4:7], a[72:75], v[212:215]
    ds_read2_b32 a[44:45], v233 offset0:208 offset1:209
    v_mfma_f32_16x16x32_bf16 v[216:219], a[4:7], a[76:79], v[216:219]
    ds_read2_b32 a[46:47], v233 offset0:210 offset1:211
    v_mfma_f32_16x16x32_bf16 v[220:223], a[4:7], a[80:83], v[220:223]
    ds_read_b128 a[112:115], v236 offset:1856
    v_mfma_f32_16x16x32_bf16 v[224:227], a[4:7], a[84:87], v[224:227]
    ds_read2_b32 a[48:49], v234 offset0:80 offset1:81
    v_mfma_f32_16x16x32_bf16 v[228:231], a[4:7], a[88:91], v[228:231]
    ds_read2_b32 a[50:51], v234 offset0:82 offset1:83
    v_mfma_f32_16x16x32_bf16 v[208:211], a[8:11], a[64:67], v[208:211]
    ds_read_b128 a[116:119], v236 offset:1344
    v_mfma_f32_16x16x32_bf16 v[212:215], a[8:11], a[68:71], v[212:215]
    ds_read2_b32 a[52:53], v234 offset0:208 offset1:209
    v_mfma_f32_16x16x32_bf16 v[216:219], a[8:11], a[72:75], v[216:219]
    ds_read2_b32 a[54:55], v234 offset0:210 offset1:211
    v_mfma_f32_16x16x32_bf16 v[220:223], a[8:11], a[76:79], v[220:223]
    ds_read_b128 a[120:123], v236 offset:832
    v_mfma_f32_16x16x32_bf16 v[224:227], a[8:11], a[80:83], v[224:227]
    ds_read2_b32 a[56:57], v235 offset0:80 offset1:81
    v_mfma_f32_16x16x32_bf16 v[228:231], a[8:11], a[84:87], v[228:231]
    ds_read2_b32 a[58:59], v235 offset0:82 offset1:83
    v_mfma_f32_16x16x32_bf16 v[212:215], a[12:15], a[64:67], v[212:215]
    ds_read_b128 a[124:127], v236 offset:320
    v_mfma_f32_16x16x32_bf16 v[216:219], a[12:15], a[68:71], v[216:219]
    ds_read2_b32 a[60:61], v235 offset0:208 offset1:209
    v_mfma_f32_16x16x32_bf16 v[220:223], a[12:15], a[72:75], v[220:223]
    ds_read2_b32 a[62:63], v235 offset0:210 offset1:211
    v_mfma_f32_16x16x32_bf16 v[224:227], a[12:15], a[76:79], v[224:227]
    v_mfma_f32_16x16x32_bf16 v[228:231], a[12:15], a[80:83], v[228:231]
    v_mfma_f32_16x16x32_bf16 v[216:219], a[16:19], a[64:67], v[216:219]
    v_mfma_f32_16x16x32_bf16 v[220:223], a[16:19], a[68:71], v[220:223]
    v_mfma_f32_16x16x32_bf16 v[224:227], a[16:19], a[72:75], v[224:227]
    v_mfma_f32_16x16x32_bf16 v[228:231], a[16:19], a[76:79], v[228:231]
    v_mfma_f32_16x16x32_bf16 v[220:223], a[20:23], a[64:67], v[220:223]
    v_mfma_f32_16x16x32_bf16 v[224:227], a[20:23], a[68:71], v[224:227]
    v_mfma_f32_16x16x32_bf16 v[228:231], a[20:23], a[72:75], v[228:231]
    v_mfma_f32_16x16x32_bf16 v[224:227], a[24:27], a[64:67], v[224:227]
    v_mfma_f32_16x16x32_bf16 v[228:231], a[24:27], a[68:71], v[228:231]
    v_mfma_f32_16x16x32_bf16 v[228:231], a[28:31], a[64:67], v[228:231]
    s_waitcnt lgkmcnt(0)
    v_mfma_f32_16x16x32_bf16 v[200:203], a[32:35], a[96:99], v[200:203]
    ds_read_b128 a[64:67], v236 offset:3968
    v_mfma_f32_16x16x32_bf16 v[204:207], a[32:35], a[100:103], v[204:207]
    ds_read2_b32 a[0:1], v232 offset0:96 offset1:97
    v_mfma_f32_16x16x32_bf16 v[208:211], a[32:35], a[104:107], v[208:211]
    ds_read2_b32 a[2:3], v232 offset0:98 offset1:99
    v_mfma_f32_16x16x32_bf16 v[212:215], a[32:35], a[108:111], v[212:215]
    ds_read_b128 a[68:71], v236 offset:3456
    v_mfma_f32_16x16x32_bf16 v[216:219], a[32:35], a[112:115], v[216:219]
    ds_read2_b32 a[4:5], v232 offset0:224 offset1:225
    v_mfma_f32_16x16x32_bf16 v[220:223], a[32:35], a[116:119], v[220:223]
    ds_read2_b32 a[6:7], v232 offset0:226 offset1:227
    v_mfma_f32_16x16x32_bf16 v[224:227], a[32:35], a[120:123], v[224:227]
    ds_read_b128 a[72:75], v236 offset:2944
    v_mfma_f32_16x16x32_bf16 v[228:231], a[32:35], a[124:127], v[228:231]
    ds_read2_b32 a[8:9], v233 offset0:96 offset1:97
    v_mfma_f32_16x16x32_bf16 v[204:207], a[36:39], a[96:99], v[204:207]
    ds_read2_b32 a[10:11], v233 offset0:98 offset1:99
    v_mfma_f32_16x16x32_bf16 v[208:211], a[36:39], a[100:103], v[208:211]
    ds_read_b128 a[76:79], v236 offset:2432
    v_mfma_f32_16x16x32_bf16 v[212:215], a[36:39], a[104:107], v[212:215]
    ds_read2_b32 a[12:13], v233 offset0:224 offset1:225
    v_mfma_f32_16x16x32_bf16 v[216:219], a[36:39], a[108:111], v[216:219]
    ds_read2_b32 a[14:15], v233 offset0:226 offset1:227
    v_mfma_f32_16x16x32_bf16 v[220:223], a[36:39], a[112:115], v[220:223]
    ds_read_b128 a[80:83], v236 offset:1920
    v_mfma_f32_16x16x32_bf16 v[224:227], a[36:39], a[116:119], v[224:227]
    ds_read2_b32 a[16:17], v234 offset0:96 offset1:97
    v_mfma_f32_16x16x32_bf16 v[228:231], a[36:39], a[120:123], v[228:231]
    ds_read2_b32 a[18:19], v234 offset0:98 offset1:99
    v_mfma_f32_16x16x32_bf16 v[208:211], a[40:43], a[96:99], v[208:211]
    ds_read_b128 a[84:87], v236 offset:1408
    v_mfma_f32_16x16x32_bf16 v[212:215], a[40:43], a[100:103], v[212:215]
    ds_read2_b32 a[20:21], v234 offset0:224 offset1:225
    v_mfma_f32_16x16x32_bf16 v[216:219], a[40:43], a[104:107], v[216:219]
    ds_read2_b32 a[22:23], v234 offset0:226 offset1:227
    v_mfma_f32_16x16x32_bf16 v[220:223], a[40:43], a[108:111], v[220:223]
    ds_read_b128 a[88:91], v236 offset:896
    v_mfma_f32_16x16x32_bf16 v[224:227], a[40:43], a[112:115], v[224:227]
    ds_read2_b32 a[24:25], v235 offset0:96 offset1:97
    v_mfma_f32_16x16x32_bf16 v[228:231], a[40:43], a[116:119], v[228:231]
    ds_read2_b32 a[26:27], v235 offset0:98 offset1:99
    v_mfma_f32_16x16x32_bf16 v[212:215], a[44:47], a[96:99], v[212:215]
    ds_read_b128 a[92:95], v236 offset:384
    v_mfma_f32_16x16x32_bf16 v[216:219], a[44:47], a[100:103], v[216:219]
    ds_read2_b32 a[28:29], v235 offset0:224 offset1:225
    v_mfma_f32_16x16x32_bf16 v[220:223], a[44:47], a[104:107], v[220:223]
    ds_read2_b32 a[30:31], v235 offset0:226 offset1:227
    v_mfma_f32_16x16x32_bf16 v[224:227], a[44:47], a[108:111], v[224:227]
    v_mfma_f32_16x16x32_bf16 v[228:231], a[44:47], a[112:115], v[228:231]
    v_mfma_f32_16x16x32_bf16 v[216:219], a[48:51], a[96:99], v[216:219]
    v_mfma_f32_16x16x32_bf16 v[220:223], a[48:51], a[100:103], v[220:223]
    v_mfma_f32_16x16x32_bf16 v[224:227], a[48:51], a[104:107], v[224:227]
    v_mfma_f32_16x16x32_bf16 v[228:231], a[48:51], a[108:111], v[228:231]
    v_mfma_f32_16x16x32_bf16 v[220:223], a[52:55], a[96:99], v[220:223]
    v_mfma_f32_16x16x32_bf16 v[224:227], a[52:55], a[100:103], v[224:227]
    v_mfma_f32_16x16x32_bf16 v[228:231], a[52:55], a[104:107], v[228:231]
    v_mfma_f32_16x16x32_bf16 v[224:227], a[56:59], a[96:99], v[224:227]
    v_mfma_f32_16x16x32_bf16 v[228:231], a[56:59], a[100:103], v[228:231]
    v_mfma_f32_16x16x32_bf16 v[228:231], a[60:63], a[96:99], v[228:231]
    s_waitcnt lgkmcnt(0)
    v_mfma_f32_16x16x32_bf16 v[200:203], a[0:3], a[64:67], v[200:203]
    ds_read_b128 a[96:99], v236 offset:4032
    v_mfma_f32_16x16x32_bf16 v[204:207], a[0:3], a[68:71], v[204:207]
    ds_read2_b32 a[32:33], v232 offset0:112 offset1:113
    v_mfma_f32_16x16x32_bf16 v[208:211], a[0:3], a[72:75], v[208:211]
    ds_read2_b32 a[34:35], v232 offset0:114 offset1:115
    v_mfma_f32_16x16x32_bf16 v[212:215], a[0:3], a[76:79], v[212:215]
    ds_read_b128 a[100:103], v236 offset:3520
    v_mfma_f32_16x16x32_bf16 v[216:219], a[0:3], a[80:83], v[216:219]
    ds_read2_b32 a[36:37], v232 offset0:240 offset1:241
    v_mfma_f32_16x16x32_bf16 v[220:223], a[0:3], a[84:87], v[220:223]
    ds_read2_b32 a[38:39], v232 offset0:242 offset1:243
    v_mfma_f32_16x16x32_bf16 v[224:227], a[0:3], a[88:91], v[224:227]
    ds_read_b128 a[104:107], v236 offset:3008
    v_mfma_f32_16x16x32_bf16 v[228:231], a[0:3], a[92:95], v[228:231]
    ds_read2_b32 a[40:41], v233 offset0:112 offset1:113
    v_mfma_f32_16x16x32_bf16 v[204:207], a[4:7], a[64:67], v[204:207]
    ds_read2_b32 a[42:43], v233 offset0:114 offset1:115
    v_mfma_f32_16x16x32_bf16 v[208:211], a[4:7], a[68:71], v[208:211]
    ds_read_b128 a[108:111], v236 offset:2496
    v_mfma_f32_16x16x32_bf16 v[212:215], a[4:7], a[72:75], v[212:215]
    ds_read2_b32 a[44:45], v233 offset0:240 offset1:241
    v_mfma_f32_16x16x32_bf16 v[216:219], a[4:7], a[76:79], v[216:219]
    ds_read2_b32 a[46:47], v233 offset0:242 offset1:243
    v_mfma_f32_16x16x32_bf16 v[220:223], a[4:7], a[80:83], v[220:223]
    ds_read_b128 a[112:115], v236 offset:1984
    v_mfma_f32_16x16x32_bf16 v[224:227], a[4:7], a[84:87], v[224:227]
    ds_read2_b32 a[48:49], v234 offset0:112 offset1:113
    v_mfma_f32_16x16x32_bf16 v[228:231], a[4:7], a[88:91], v[228:231]
    ds_read2_b32 a[50:51], v234 offset0:114 offset1:115
    v_mfma_f32_16x16x32_bf16 v[208:211], a[8:11], a[64:67], v[208:211]
    ds_read_b128 a[116:119], v236 offset:1472
    v_mfma_f32_16x16x32_bf16 v[212:215], a[8:11], a[68:71], v[212:215]
    ds_read2_b32 a[52:53], v234 offset0:240 offset1:241
    v_mfma_f32_16x16x32_bf16 v[216:219], a[8:11], a[72:75], v[216:219]
    ds_read2_b32 a[54:55], v234 offset0:242 offset1:243
    v_mfma_f32_16x16x32_bf16 v[220:223], a[8:11], a[76:79], v[220:223]
    ds_read_b128 a[120:123], v236 offset:960
    v_mfma_f32_16x16x32_bf16 v[224:227], a[8:11], a[80:83], v[224:227]
    ds_read2_b32 a[56:57], v235 offset0:112 offset1:113
    v_mfma_f32_16x16x32_bf16 v[228:231], a[8:11], a[84:87], v[228:231]
    ds_read2_b32 a[58:59], v235 offset0:114 offset1:115
    v_mfma_f32_16x16x32_bf16 v[212:215], a[12:15], a[64:67], v[212:215]
    ds_read_b128 a[124:127], v236 offset:448
    v_mfma_f32_16x16x32_bf16 v[216:219], a[12:15], a[68:71], v[216:219]
    ds_read2_b32 a[60:61], v235 offset0:240 offset1:241
    v_mfma_f32_16x16x32_bf16 v[220:223], a[12:15], a[72:75], v[220:223]
    ds_read2_b32 a[62:63], v235 offset0:242 offset1:243
    v_mfma_f32_16x16x32_bf16 v[224:227], a[12:15], a[76:79], v[224:227]
    v_mfma_f32_16x16x32_bf16 v[228:231], a[12:15], a[80:83], v[228:231]
    v_mfma_f32_16x16x32_bf16 v[216:219], a[16:19], a[64:67], v[216:219]
    v_mfma_f32_16x16x32_bf16 v[220:223], a[16:19], a[68:71], v[220:223]
    v_mfma_f32_16x16x32_bf16 v[224:227], a[16:19], a[72:75], v[224:227]
    v_mfma_f32_16x16x32_bf16 v[228:231], a[16:19], a[76:79], v[228:231]
    v_mfma_f32_16x16x32_bf16 v[220:223], a[20:23], a[64:67], v[220:223]
    v_mfma_f32_16x16x32_bf16 v[224:227], a[20:23], a[68:71], v[224:227]
    v_mfma_f32_16x16x32_bf16 v[228:231], a[20:23], a[72:75], v[228:231]
    v_mfma_f32_16x16x32_bf16 v[224:227], a[24:27], a[64:67], v[224:227]
    v_mfma_f32_16x16x32_bf16 v[228:231], a[24:27], a[68:71], v[228:231]
    v_mfma_f32_16x16x32_bf16 v[228:231], a[28:31], a[64:67], v[228:231]
    s_waitcnt lgkmcnt(0)
    v_mfma_f32_16x16x32_bf16 v[200:203], a[32:35], a[96:99], v[200:203]
    ds_read_b64 v[176:177], v237 offset:3584
    v_mfma_f32_16x16x32_bf16 v[204:207], a[32:35], a[100:103], v[204:207]
    ds_read_b64 v[178:179], v237 offset:3072
    v_mfma_f32_16x16x32_bf16 v[208:211], a[32:35], a[104:107], v[208:211]
    ds_read_b64 v[180:181], v237 offset:2560
    v_mfma_f32_16x16x32_bf16 v[212:215], a[32:35], a[108:111], v[212:215]
    ds_read_b64 v[182:183], v237 offset:2048
    v_mfma_f32_16x16x32_bf16 v[216:219], a[32:35], a[112:115], v[216:219]
    ds_read_b64 v[184:185], v237 offset:1536
    v_mfma_f32_16x16x32_bf16 v[220:223], a[32:35], a[116:119], v[220:223]
    ds_read_b64 v[186:187], v237 offset:1024
    v_mfma_f32_16x16x32_bf16 v[224:227], a[32:35], a[120:123], v[224:227]
    ds_read_b64 v[188:189], v237 offset:512
    v_mfma_f32_16x16x32_bf16 v[228:231], a[32:35], a[124:127], v[228:231]
    ds_read_b64 v[190:191], v237 offset:0
    v_mfma_f32_16x16x32_bf16 v[204:207], a[36:39], a[96:99], v[204:207]
    v_mfma_f32_16x16x32_bf16 v[208:211], a[36:39], a[100:103], v[208:211]
    v_mfma_f32_16x16x32_bf16 v[212:215], a[36:39], a[104:107], v[212:215]
    v_mfma_f32_16x16x32_bf16 v[216:219], a[36:39], a[108:111], v[216:219]
    v_mfma_f32_16x16x32_bf16 v[220:223], a[36:39], a[112:115], v[220:223]
    v_mfma_f32_16x16x32_bf16 v[224:227], a[36:39], a[116:119], v[224:227]
    v_mfma_f32_16x16x32_bf16 v[228:231], a[36:39], a[120:123], v[228:231]
    v_mfma_f32_16x16x32_bf16 v[208:211], a[40:43], a[96:99], v[208:211]
    v_mfma_f32_16x16x32_bf16 v[212:215], a[40:43], a[100:103], v[212:215]
    v_mfma_f32_16x16x32_bf16 v[216:219], a[40:43], a[104:107], v[216:219]
    v_mfma_f32_16x16x32_bf16 v[220:223], a[40:43], a[108:111], v[220:223]
    v_mfma_f32_16x16x32_bf16 v[224:227], a[40:43], a[112:115], v[224:227]
    v_mfma_f32_16x16x32_bf16 v[228:231], a[40:43], a[116:119], v[228:231]
    v_mfma_f32_16x16x32_bf16 v[212:215], a[44:47], a[96:99], v[212:215]
    v_mfma_f32_16x16x32_bf16 v[216:219], a[44:47], a[100:103], v[216:219]
    v_mfma_f32_16x16x32_bf16 v[220:223], a[44:47], a[104:107], v[220:223]
    v_mfma_f32_16x16x32_bf16 v[224:227], a[44:47], a[108:111], v[224:227]
    v_mfma_f32_16x16x32_bf16 v[228:231], a[44:47], a[112:115], v[228:231]
    v_mfma_f32_16x16x32_bf16 v[216:219], a[48:51], a[96:99], v[216:219]
    v_mfma_f32_16x16x32_bf16 v[220:223], a[48:51], a[100:103], v[220:223]
    v_mfma_f32_16x16x32_bf16 v[224:227], a[48:51], a[104:107], v[224:227]
    v_mfma_f32_16x16x32_bf16 v[228:231], a[48:51], a[108:111], v[228:231]
    v_mfma_f32_16x16x32_bf16 v[220:223], a[52:55], a[96:99], v[220:223]
    v_mfma_f32_16x16x32_bf16 v[224:227], a[52:55], a[100:103], v[224:227]
    v_mfma_f32_16x16x32_bf16 v[228:231], a[52:55], a[104:107], v[228:231]
    v_mfma_f32_16x16x32_bf16 v[224:227], a[56:59], a[96:99], v[224:227]
    v_mfma_f32_16x16x32_bf16 v[228:231], a[56:59], a[100:103], v[228:231]
    v_mfma_f32_16x16x32_bf16 v[228:231], a[60:63], a[96:99], v[228:231]
    s_lshl_b32 s20, s60, 12
    s_add_u32 s20, s20, 26214400
    v_add_u32 v5, s61, v238
    v_add_u32 v6, s61, v2
    s_waitcnt lgkmcnt(0)
    s_nop 4
    v_and_b32 v8, 0xffff0000, v177
    v_lshlrev_b32 v9, 16, v177
    v_and_b32 v10, 0xffff0000, v176
    v_lshlrev_b32 v11, 16, v176
    v_fmac_f32 v200, v8, v239
    v_fmac_f32 v201, v9, v239
    v_fmac_f32 v202, v10, v239
    v_fmac_f32 v203, v11, v239
    v_cvt_pk_bf16_f32 v176, v200, v201
    v_cvt_pk_bf16_f32 v177, v202, v203
    ds_write_b64 v5, v[176:177] offset:0
    v_and_b32 v8, 0xffff0000, v179
    v_lshlrev_b32 v9, 16, v179
    v_and_b32 v10, 0xffff0000, v178
    v_lshlrev_b32 v11, 16, v178
    v_fmac_f32 v204, v8, v239
    v_fmac_f32 v205, v9, v239
    v_fmac_f32 v206, v10, v239
    v_fmac_f32 v207, v11, v239
    v_cvt_pk_bf16_f32 v178, v204, v205
    v_cvt_pk_bf16_f32 v179, v206, v207
    ds_write_b64 v5, v[178:179] offset:512
    v_and_b32 v8, 0xffff0000, v181
    v_lshlrev_b32 v9, 16, v181
    v_and_b32 v10, 0xffff0000, v180
    v_lshlrev_b32 v11, 16, v180
    v_fmac_f32 v208, v8, v239
    v_fmac_f32 v209, v9, v239
    v_fmac_f32 v210, v10, v239
    v_fmac_f32 v211, v11, v239
    v_cvt_pk_bf16_f32 v180, v208, v209
    v_cvt_pk_bf16_f32 v181, v210, v211
    ds_write_b64 v5, v[180:181] offset:1024
    v_and_b32 v8, 0xffff0000, v183
    v_lshlrev_b32 v9, 16, v183
    v_and_b32 v10, 0xffff0000, v182
    v_lshlrev_b32 v11, 16, v182
    v_fmac_f32 v212, v8, v239
    v_fmac_f32 v213, v9, v239
    v_fmac_f32 v214, v10, v239
    v_fmac_f32 v215, v11, v239
    v_cvt_pk_bf16_f32 v182, v212, v213
    v_cvt_pk_bf16_f32 v183, v214, v215
    ds_write_b64 v5, v[182:183] offset:1536
    v_and_b32 v8, 0xffff0000, v185
    v_lshlrev_b32 v9, 16, v185
    v_and_b32 v10, 0xffff0000, v184
    v_lshlrev_b32 v11, 16, v184
    v_fmac_f32 v216, v8, v239
    v_fmac_f32 v217, v9, v239
    v_fmac_f32 v218, v10, v239
    v_fmac_f32 v219, v11, v239
    v_cvt_pk_bf16_f32 v184, v216, v217
    v_cvt_pk_bf16_f32 v185, v218, v219
    ds_write_b64 v5, v[184:185] offset:2048
    v_and_b32 v8, 0xffff0000, v187
    v_lshlrev_b32 v9, 16, v187
    v_and_b32 v10, 0xffff0000, v186
    v_lshlrev_b32 v11, 16, v186
    v_fmac_f32 v220, v8, v239
    v_fmac_f32 v221, v9, v239
    v_fmac_f32 v222, v10, v239
    v_fmac_f32 v223, v11, v239
    v_cvt_pk_bf16_f32 v186, v220, v221
    v_cvt_pk_bf16_f32 v187, v222, v223
    ds_write_b64 v5, v[186:187] offset:2560
    v_and_b32 v8, 0xffff0000, v189
    v_lshlrev_b32 v9, 16, v189
    v_and_b32 v10, 0xffff0000, v188
    v_lshlrev_b32 v11, 16, v188
    v_fmac_f32 v224, v8, v239
    v_fmac_f32 v225, v9, v239
    v_fmac_f32 v226, v10, v239
    v_fmac_f32 v227, v11, v239
    v_cvt_pk_bf16_f32 v188, v224, v225
    v_cvt_pk_bf16_f32 v189, v226, v227
    ds_write_b64 v5, v[188:189] offset:3072
    v_and_b32 v8, 0xffff0000, v191
    v_lshlrev_b32 v9, 16, v191
    v_and_b32 v10, 0xffff0000, v190
    v_lshlrev_b32 v11, 16, v190
    v_fmac_f32 v228, v8, v239
    v_fmac_f32 v229, v9, v239
    v_fmac_f32 v230, v10, v239
    v_fmac_f32 v231, v11, v239
    v_cvt_pk_bf16_f32 v190, v228, v229
    v_cvt_pk_bf16_f32 v191, v230, v231
    ds_write_b64 v5, v[190:191] offset:3584
    s_waitcnt lgkmcnt(0)
    ds_read_b128 v[240:243], v6 offset:0
    ds_read_b128 v[244:247], v6 offset:1024
    ds_read_b128 v[248:251], v6 offset:2048
    ds_read_b128 v[252:255], v6 offset:3072
    s_waitcnt lgkmcnt(3)
    buffer_store_dwordx4 v[240:243], v2, s[4:7], s20 offen offset:0 sc1
    s_waitcnt lgkmcnt(2)
    buffer_store_dwordx4 v[244:247], v2, s[4:7], s20 offen offset:1024 sc1
    s_waitcnt lgkmcnt(1)
    buffer_store_dwordx4 v[248:251], v2, s[4:7], s20 offen offset:2048 sc1
    s_waitcnt lgkmcnt(0)
    buffer_store_dwordx4 v[252:255], v2, s[4:7], s20 offen offset:3072 sc1
L_g2j:
    s_waitcnt vmcnt(0)
    s_barrier
    s_cmp_lg_u32 s30, 0
    s_cbranch_scc1 Lsig15
    s_lshl_b32 s20, s2, 2
    s_add_u32 s20, s20, 29886464
    v_mov_b32 v14, s31
    v_mov_b32 v15, 0
    s_mov_b64 exec, 1
    buffer_store_dword v14, v15, s[4:7], s20 offen sc1
    s_mov_b64 exec, -1
Lsig15:
    s_lshl_b32 s24, s44, 2
    s_add_u32 s24, s24, s30
    s_mul_i32 s24, s24, 2
    s_mul_i32 s25, s24, 20480
    s_add_u32 s25, s25, 7864320
    s_add_u32 s26, s25, 20480
    s_mul_i32 s27, s45, 122880
    s_add_u32 s27, s27, 18874368
    s_mul_i32 s29, s30, 6144
    s_add_u32 s28, s27, s29
    v_and_b32 v5, 15, v1
    v_lshrrev_b32 v6, 4, v1
    v_lshlrev_b32 v6, 8, v6
    v_lshl_add_u32 v5, v5, 3, v6
    s_lshl_b32 s37, s24, 10
    s_add_u32 s37, s37, 29360128
    s_add_u32 s35, s25, 0
    buffer_load_dwordx4 a[0:3], v2, s[4:7], s35 offen offset:0 sc1
    s_add_u32 s36, s26, 0
    buffer_load_dwordx4 a[4:7], v2, s[4:7], s36 offen offset:0 sc1
    buffer_load_dwordx4 a[8:11], v2, s[4:7], s35 offen offset:1024 sc1
    buffer_load_dwordx4 a[12:15], v2, s[4:7], s36 offen offset:1024 sc1
    buffer_load_dwordx4 a[16:19], v2, s[4:7], s35 offen offset:2048 sc1
    buffer_load_dwordx4 a[20:23], v2, s[4:7], s36 offen offset:2048 sc1
    buffer_load_dwordx4 a[24:27], v2, s[4:7], s35 offen offset:3072 sc1
    buffer_load_dwordx4 a[28:31], v2, s[4:7], s36 offen offset:3072 sc1
    s_add_u32 s35, s25, 4096
    buffer_load_dwordx4 a[32:35], v2, s[4:7], s35 offen offset:0 sc1
    s_add_u32 s36, s26, 4096
    buffer_load_dwordx4 a[36:39], v2, s[4:7], s36 offen offset:0 sc1
    buffer_load_dwordx4 a[40:43], v2, s[4:7], s35 offen offset:1024 sc1
    buffer_load_dwordx4 a[44:47], v2, s[4:7], s36 offen offset:1024 sc1
    v_mov_b32 v16, 0
    v_mov_b32 v17, 0
    v_mov_b32 v18, 0
    v_mov_b32 v19, 0
    v_mov_b32 v20, 0
    v_mov_b32 v21, 0
    v_mov_b32 v22, 0
    v_mov_b32 v23, 0
    v_mov_b32 v24, 0
    v_mov_b32 v25, 0
    v_mov_b32 v26, 0
    v_mov_b32 v27, 0
    v_mov_b32 v28, 0
    v_mov_b32 v29, 0
    v_mov_b32 v30, 0
    v_mov_b32 v31, 0
    v_mov_b32 v32, 0
    v_mov_b32 v33, 0
    v_mov_b32 v34, 0
    v_mov_b32 v35, 0
    v_mov_b32 v36, 0
    v_mov_b32 v37, 0
    v_mov_b32 v38, 0
    v_mov_b32 v39, 0
    v_mov_b32 v40, 0
    v_mov_b32 v41, 0
    v_mov_b32 v42, 0
    v_mov_b32 v43, 0
    v_mov_b32 v44, 0
    v_mov_b32 v45, 0
    v_mov_b32 v46, 0
    v_mov_b32 v47, 0
    v_mov_b32 v48, 0
    v_mov_b32 v49, 0
    v_mov_b32 v50, 0
    v_mov_b32 v51, 0
    v_mov_b32 v52, 0
    v_mov_b32 v53, 0
    v_mov_b32 v54, 0
    v_mov_b32 v55, 0
    v_mov_b32 v56, 0
    v_mov_b32 v57, 0
    v_mov_b32 v58, 0
    v_mov_b32 v59, 0
    v_mov_b32 v60, 0
    v_mov_b32 v61, 0
    v_mov_b32 v62, 0
    v_mov_b32 v63, 0
    v_add_u32 v3, 0x10000, v2
    v_add_u32 v4, 0x20000, v2
    ds_read_b128 v[64:67], v2 offset:0
    ds_read_b128 v[68:71], v2 offset:1024
    ds_read_b128 v[72:75], v2 offset:2048
    ds_read_b128 v[76:79], v2 offset:3072
    ds_read_b128 v[80:83], v2 offset:4096
    ds_read_b128 v[84:87], v2 offset:5120
    ds_read_b128 v[88:91], v2 offset:6144
    ds_read_b128 v[92:95], v2 offset:7168
    ds_read_b128 v[96:99], v2 offset:8192
    ds_read_b128 v[100:103], v2 offset:9216
    ds_read_b128 v[104:107], v2 offset:10240
    ds_read_b128 v[108:111], v2 offset:11264
    s_waitcnt vmcnt(10)
    s_waitcnt lgkmcnt(11)
    v_mfma_f32_16x16x32_bf16 v[16:19], v[64:67], a[0:3], v[16:19]
    buffer_load_dwordx4 a[48:51], v2, s[4:7], s35 offen offset:2048 sc1
    v_mfma_f32_16x16x32_bf16 v[40:43], v[64:67], a[4:7], v[40:43]
    s_waitcnt lgkmcnt(10)
    v_mfma_f32_16x16x32_bf16 v[20:23], v[68:71], a[0:3], v[20:23]
    v_mfma_f32_16x16x32_bf16 v[44:47], v[68:71], a[4:7], v[44:47]
    s_waitcnt lgkmcnt(9)
    v_mfma_f32_16x16x32_bf16 v[24:27], v[72:75], a[0:3], v[24:27]
    v_mfma_f32_16x16x32_bf16 v[48:51], v[72:75], a[4:7], v[48:51]
    s_waitcnt lgkmcnt(8)
    v_mfma_f32_16x16x32_bf16 v[28:31], v[76:79], a[0:3], v[28:31]
    buffer_load_dwordx4 a[52:55], v2, s[4:7], s36 offen offset:2048 sc1
    v_mfma_f32_16x16x32_bf16 v[52:55], v[76:79], a[4:7], v[52:55]
    s_waitcnt lgkmcnt(7)
    v_mfma_f32_16x16x32_bf16 v[32:35], v[80:83], a[0:3], v[32:35]
    v_mfma_f32_16x16x32_bf16 v[56:59], v[80:83], a[4:7], v[56:59]
    s_waitcnt lgkmcnt(6)
    v_mfma_f32_16x16x32_bf16 v[36:39], v[84:87], a[0:3], v[36:39]
    v_mfma_f32_16x16x32_bf16 v[60:63], v[84:87], a[4:7], v[60:63]
    ds_read_b128 v[64:67], v2 offset:12288
    ds_read_b128 v[68:71], v2 offset:13312
    ds_read_b128 v[72:75], v2 offset:14336
    ds_read_b128 v[76:79], v2 offset:15360
    ds_read_b128 v[80:83], v2 offset:16384
    ds_read_b128 v[84:87], v2 offset:17408
    s_waitcnt vmcnt(10)
    s_waitcnt lgkmcnt(11)
    v_mfma_f32_16x16x32_bf16 v[16:19], v[88:91], a[8:11], v[16:19]
    buffer_load_dwordx4 a[56:59], v2, s[4:7], s35 offen offset:3072 sc1
    v_mfma_f32_16x16x32_bf16 v[40:43], v[88:91], a[12:15], v[40:43]
    s_waitcnt lgkmcnt(10)
    v_mfma_f32_16x16x32_bf16 v[20:23], v[92:95], a[8:11], v[20:23]
    v_mfma_f32_16x16x32_bf16 v[44:47], v[92:95], a[12:15], v[44:47]
    s_waitcnt lgkmcnt(9)
    v_mfma_f32_16x16x32_bf16 v[24:27], v[96:99], a[8:11], v[24:27]
    v_mfma_f32_16x16x32_bf16 v[48:51], v[96:99], a[12:15], v[48:51]
    s_waitcnt lgkmcnt(8)
    v_mfma_f32_16x16x32_bf16 v[28:31], v[100:103], a[8:11], v[28:31]
    buffer_load_dwordx4 a[60:63], v2, s[4:7], s36 offen offset:3072 sc1
    v_mfma_f32_16x16x32_bf16 v[52:55], v[100:103], a[12:15], v[52:55]
    s_waitcnt lgkmcnt(7)
    v_mfma_f32_16x16x32_bf16 v[32:35], v[104:107], a[8:11], v[32:35]
    v_mfma_f32_16x16x32_bf16 v[56:59], v[104:107], a[12:15], v[56:59]
    s_waitcnt lgkmcnt(6)
    v_mfma_f32_16x16x32_bf16 v[36:39], v[108:111], a[8:11], v[36:39]
    v_mfma_f32_16x16x32_bf16 v[60:63], v[108:111], a[12:15], v[60:63]
    ds_read_b128 v[88:91], v2 offset:18432
    ds_read_b128 v[92:95], v2 offset:19456
    ds_read_b128 v[96:99], v2 offset:20480
    ds_read_b128 v[100:103], v2 offset:21504
    ds_read_b128 v[104:107], v2 offset:22528
    ds_read_b128 v[108:111], v2 offset:23552
    s_waitcnt vmcnt(10)
    s_waitcnt lgkmcnt(11)
    v_mfma_f32_16x16x32_bf16 v[16:19], v[64:67], a[16:19], v[16:19]
    buffer_load_dwordx2 v[8:9], v5, s[4:7], s37 offen offset:0 sc1
    v_mfma_f32_16x16x32_bf16 v[40:43], v[64:67], a[20:23], v[40:43]
    s_waitcnt lgkmcnt(10)
    v_mfma_f32_16x16x32_bf16 v[20:23], v[68:71], a[16:19], v[20:23]
    v_mfma_f32_16x16x32_bf16 v[44:47], v[68:71], a[20:23], v[44:47]
    s_waitcnt lgkmcnt(9)
    v_mfma_f32_16x16x32_bf16 v[24:27], v[72:75], a[16:19], v[24:27]
    v_mfma_f32_16x16x32_bf16 v[48:51], v[72:75], a[20:23], v[48:51]
    s_waitcnt lgkmcnt(8)
    v_mfma_f32_16x16x32_bf16 v[28:31], v[76:79], a[16:19], v[28:31]
    buffer_load_dwordx2 v[10:11], v5, s[4:7], s37 offen offset:128 sc1
    v_mfma_f32_16x16x32_bf16 v[52:55], v[76:79], a[20:23], v[52:55]
    s_waitcnt lgkmcnt(7)
    v_mfma_f32_16x16x32_bf16 v[32:35], v[80:83], a[16:19], v[32:35]
    v_mfma_f32_16x16x32_bf16 v[56:59], v[80:83], a[20:23], v[56:59]
    s_waitcnt lgkmcnt(6)
    v_mfma_f32_16x16x32_bf16 v[36:39], v[84:87], a[16:19], v[36:39]
    v_mfma_f32_16x16x32_bf16 v[60:63], v[84:87], a[20:23], v[60:63]
    ds_read_b128 v[64:67], v2 offset:24576
    ds_read_b128 v[68:71], v2 offset:25600
    ds_read_b128 v[72:75], v2 offset:26624
    ds_read_b128 v[76:79], v2 offset:27648
    ds_read_b128 v[80:83], v2 offset:28672
    ds_read_b128 v[84:87], v2 offset:29696
    s_waitcnt vmcnt(10)
    s_waitcnt lgkmcnt(11)
    v_mfma_f32_16x16x32_bf16 v[16:19], v[88:91], a[24:27], v[16:19]
    buffer_load_dwordx2 v[12:13], v5, s[4:7], s37 offen offset:1024 sc1
    v_mfma_f32_16x16x32_bf16 v[40:43], v[88:91], a[28:31], v[40:43]
    s_waitcnt lgkmcnt(10)
    v_mfma_f32_16x16x32_bf16 v[20:23], v[92:95], a[24:27], v[20:23]
    v_mfma_f32_16x16x32_bf16 v[44:47], v[92:95], a[28:31], v[44:47]
    s_waitcnt lgkmcnt(9)
    v_mfma_f32_16x16x32_bf16 v[24:27], v[96:99], a[24:27], v[24:27]
    v_mfma_f32_16x16x32_bf16 v[48:51], v[96:99], a[28:31], v[48:51]
    s_waitcnt lgkmcnt(8)
    v_mfma_f32_16x16x32_bf16 v[28:31], v[100:103], a[24:27], v[28:31]
    buffer_load_dwordx2 v[14:15], v5, s[4:7], s37 offen offset:1152 sc1
    v_mfma_f32_16x16x32_bf16 v[52:55], v[100:103], a[28:31], v[52:55]
    s_waitcnt lgkmcnt(7)
    v_mfma_f32_16x16x32_bf16 v[32:35], v[104:107], a[24:27], v[32:35]
    v_mfma_f32_16x16x32_bf16 v[56:59], v[104:107], a[28:31], v[56:59]
    s_waitcnt lgkmcnt(6)
    v_mfma_f32_16x16x32_bf16 v[36:39], v[108:111], a[24:27], v[36:39]
    v_mfma_f32_16x16x32_bf16 v[60:63], v[108:111], a[28:31], v[60:63]
    ds_read_b128 v[88:91], v2 offset:30720
    ds_read_b128 v[92:95], v2 offset:31744
    ds_read_b128 v[96:99], v2 offset:32768
    ds_read_b128 v[100:103], v2 offset:33792
    ds_read_b128 v[104:107], v2 offset:34816
    ds_read_b128 v[108:111], v2 offset:35840
    s_waitcnt vmcnt(10)
    s_waitcnt lgkmcnt(11)
    v_mfma_f32_16x16x32_bf16 v[16:19], v[64:67], a[32:35], v[16:19]
    s_add_u32 s35, s25, 8192
    buffer_load_dwordx4 a[64:67], v2, s[4:7], s35 offen offset:0 sc1
    v_mfma_f32_16x16x32_bf16 v[40:43], v[64:67], a[36:39], v[40:43]
    s_waitcnt lgkmcnt(10)
    v_mfma_f32_16x16x32_bf16 v[20:23], v[68:71], a[32:35], v[20:23]
    v_mfma_f32_16x16x32_bf16 v[44:47], v[68:71], a[36:39], v[44:47]
    s_waitcnt lgkmcnt(9)
    v_mfma_f32_16x16x32_bf16 v[24:27], v[72:75], a[32:35], v[24:27]
    v_mfma_f32_16x16x32_bf16 v[48:51], v[72:75], a[36:39], v[48:51]
    s_waitcnt lgkmcnt(8)
    v_mfma_f32_16x16x32_bf16 v[28:31], v[76:79], a[32:35], v[28:31]
    s_add_u32 s36, s26, 8192
    buffer_load_dwordx4 a[68:71], v2, s[4:7], s36 offen offset:0 sc1
    v_mfma_f32_16x16x32_bf16 v[52:55], v[76:79], a[36:39], v[52:55]
    s_waitcnt lgkmcnt(7)
    v_mfma_f32_16x16x32_bf16 v[32:35], v[80:83], a[32:35], v[32:35]
    v_mfma_f32_16x16x32_bf16 v[56:59], v[80:83], a[36:39], v[56:59]
    s_waitcnt lgkmcnt(6)
    v_mfma_f32_16x16x32_bf16 v[36:39], v[84:87], a[32:35], v[36:39]
    v_mfma_f32_16x16x32_bf16 v[60:63], v[84:87], a[36:39], v[60:63]
    ds_read_b128 v[64:67], v2 offset:36864
    ds_read_b128 v[68:71], v2 offset:37888
    ds_read_b128 v[72:75], v2 offset:38912
    ds_read_b128 v[76:79], v2 offset:39936
    ds_read_b128 v[80:83], v2 offset:40960
    ds_read_b128 v[84:87], v2 offset:41984
    s_waitcnt vmcnt(10)
    s_waitcnt lgkmcnt(11)
    v_mfma_f32_16x16x32_bf16 v[16:19], v[88:91], a[40:43], v[16:19]
    buffer_load_dwordx4 a[72:75], v2, s[4:7], s35 offen offset:1024 sc1
    v_mfma_f32_16x16x32_bf16 v[40:43], v[88:91], a[44:47], v[40:43]
    s_waitcnt lgkmcnt(10)
    v_mfma_f32_16x16x32_bf16 v[20:23], v[92:95], a[40:43], v[20:23]
    v_mfma_f32_16x16x32_bf16 v[44:47], v[92:95], a[44:47], v[44:47]
    s_waitcnt lgkmcnt(9)
    v_mfma_f32_16x16x32_bf16 v[24:27], v[96:99], a[40:43], v[24:27]
    v_mfma_f32_16x16x32_bf16 v[48:51], v[96:99], a[44:47], v[48:51]
    s_waitcnt lgkmcnt(8)
    v_mfma_f32_16x16x32_bf16 v[28:31], v[100:103], a[40:43], v[28:31]
    buffer_load_dwordx4 a[76:79], v2, s[4:7], s36 offen offset:1024 sc1
    v_mfma_f32_16x16x32_bf16 v[52:55], v[100:103], a[44:47], v[52:55]
    s_waitcnt lgkmcnt(7)
    v_mfma_f32_16x16x32_bf16 v[32:35], v[104:107], a[40:43], v[32:35]
    v_mfma_f32_16x16x32_bf16 v[56:59], v[104:107], a[44:47], v[56:59]
    s_waitcnt lgkmcnt(6)
    v_mfma_f32_16x16x32_bf16 v[36:39], v[108:111], a[40:43], v[36:39]
    v_mfma_f32_16x16x32_bf16 v[60:63], v[108:111], a[44:47], v[60:63]
    ds_read_b128 v[88:91], v2 offset:43008
    ds_read_b128 v[92:95], v2 offset:44032
    ds_read_b128 v[96:99], v2 offset:45056
    ds_read_b128 v[100:103], v2 offset:46080
    ds_read_b128 v[104:107], v2 offset:47104
    ds_read_b128 v[108:111], v2 offset:48128
    s_waitcnt vmcnt(10)
    s_waitcnt lgkmcnt(11)
    v_mfma_f32_16x16x32_bf16 v[16:19], v[64:67], a[48:51], v[16:19]
    buffer_load_dwordx4 a[80:83], v2, s[4:7], s35 offen offset:2048 sc1
    v_mfma_f32_16x16x32_bf16 v[40:43], v[64:67], a[52:55], v[40:43]
    s_waitcnt lgkmcnt(10)
    v_mfma_f32_16x16x32_bf16 v[20:23], v[68:71], a[48:51], v[20:23]
    v_mfma_f32_16x16x32_bf16 v[44:47], v[68:71], a[52:55], v[44:47]
    s_waitcnt lgkmcnt(9)
    v_mfma_f32_16x16x32_bf16 v[24:27], v[72:75], a[48:51], v[24:27]
    v_mfma_f32_16x16x32_bf16 v[48:51], v[72:75], a[52:55], v[48:51]
    s_waitcnt lgkmcnt(8)
    v_mfma_f32_16x16x32_bf16 v[28:31], v[76:79], a[48:51], v[28:31]
    buffer_load_dwordx4 a[84:87], v2, s[4:7], s36 offen offset:2048 sc1
    v_mfma_f32_16x16x32_bf16 v[52:55], v[76:79], a[52:55], v[52:55]
    s_waitcnt lgkmcnt(7)
    v_mfma_f32_16x16x32_bf16 v[32:35], v[80:83], a[48:51], v[32:35]
    v_mfma_f32_16x16x32_bf16 v[56:59], v[80:83], a[52:55], v[56:59]
    s_waitcnt lgkmcnt(6)
    v_mfma_f32_16x16x32_bf16 v[36:39], v[84:87], a[48:51], v[36:39]
    v_mfma_f32_16x16x32_bf16 v[60:63], v[84:87], a[52:55], v[60:63]
    ds_read_b128 v[64:67], v2 offset:49152
    ds_read_b128 v[68:71], v2 offset:50176
    ds_read_b128 v[72:75], v2 offset:51200
    ds_read_b128 v[76:79], v2 offset:52224
    ds_read_b128 v[80:83], v2 offset:53248
    ds_read_b128 v[84:87], v2 offset:54272
    s_waitcnt vmcnt(10)
    s_waitcnt lgkmcnt(11)
    v_mfma_f32_16x16x32_bf16 v[16:19], v[88:91], a[56:59], v[16:19]
    buffer_load_dwordx4 a[88:91], v2, s[4:7], s35 offen offset:3072 sc1
    v_mfma_f32_16x16x32_bf16 v[40:43], v[88:91], a[60:63], v[40:43]
    s_waitcnt lgkmcnt(10)
    v_mfma_f32_16x16x32_bf16 v[20:23], v[92:95], a[56:59], v[20:23]
    v_mfma_f32_16x16x32_bf16 v[44:47], v[92:95], a[60:63], v[44:47]
    s_waitcnt lgkmcnt(9)
    v_mfma_f32_16x16x32_bf16 v[24:27], v[96:99], a[56:59], v[24:27]
    v_mfma_f32_16x16x32_bf16 v[48:51], v[96:99], a[60:63], v[48:51]
    s_waitcnt lgkmcnt(8)
    v_mfma_f32_16x16x32_bf16 v[28:31], v[100:103], a[56:59], v[28:31]
    buffer_load_dwordx4 a[92:95], v2, s[4:7], s36 offen offset:3072 sc1
    v_mfma_f32_16x16x32_bf16 v[52:55], v[100:103], a[60:63], v[52:55]
    s_waitcnt lgkmcnt(7)
    v_mfma_f32_16x16x32_bf16 v[32:35], v[104:107], a[56:59], v[32:35]
    v_mfma_f32_16x16x32_bf16 v[56:59], v[104:107], a[60:63], v[56:59]
    s_waitcnt lgkmcnt(6)
    v_mfma_f32_16x16x32_bf16 v[36:39], v[108:111], a[56:59], v[36:39]
    v_mfma_f32_16x16x32_bf16 v[60:63], v[108:111], a[60:63], v[60:63]
    ds_read_b128 v[88:91], v2 offset:55296
    ds_read_b128 v[92:95], v2 offset:56320
    ds_read_b128 v[96:99], v2 offset:57344
    ds_read_b128 v[100:103], v2 offset:58368
    ds_read_b128 v[104:107], v2 offset:59392
    ds_read_b128 v[108:111], v2 offset:60416
    s_waitcnt vmcnt(6)
    s_waitcnt lgkmcnt(11)
    v_mfma_f32_16x16x32_bf16 v[16:19], v[64:67], a[64:67], v[16:19]
    s_add_u32 s35, s25, 12288
    buffer_load_dwordx4 a[96:99], v2, s[4:7], s35 offen offset:0 sc1
    v_mfma_f32_16x16x32_bf16 v[40:43], v[64:67], a[68:71], v[40:43]
    s_waitcnt lgkmcnt(10)
    v_mfma_f32_16x16x32_bf16 v[20:23], v[68:71], a[64:67], v[20:23]
    v_mfma_f32_16x16x32_bf16 v[44:47], v[68:71], a[68:71], v[44:47]
    s_waitcnt lgkmcnt(9)
    v_mfma_f32_16x16x32_bf16 v[24:27], v[72:75], a[64:67], v[24:27]
    v_mfma_f32_16x16x32_bf16 v[48:51], v[72:75], a[68:71], v[48:51]
    s_waitcnt lgkmcnt(8)
    v_mfma_f32_16x16x32_bf16 v[28:31], v[76:79], a[64:67], v[28:31]
    s_add_u32 s36, s26, 12288
    buffer_load_dwordx4 a[100:103], v2, s[4:7], s36 offen offset:0 sc1
    v_mfma_f32_16x16x32_bf16 v[52:55], v[76:79], a[68:71], v[52:55]
    s_waitcnt lgkmcnt(7)
    v_mfma_f32_16x16x32_bf16 v[32:35], v[80:83], a[64:67], v[32:35]
    v_mfma_f32_16x16x32_bf16 v[56:59], v[80:83], a[68:71], v[56:59]
    s_waitcnt lgkmcnt(6)
    v_mfma_f32_16x16x32_bf16 v[36:39], v[84:87], a[64:67], v[36:39]
    v_mfma_f32_16x16x32_bf16 v[60:63], v[84:87], a[68:71], v[60:63]
    ds_read_b128 v[64:67], v2 offset:61440
    ds_read_b128 v[68:71], v2 offset:62464
    ds_read_b128 v[72:75], v2 offset:63488
    ds_read_b128 v[76:79], v2 offset:64512
    ds_read_b128 v[80:83], v3 offset:0
    ds_read_b128 v[84:87], v3 offset:1024
    s_waitcnt vmcnt(6)
    s_waitcnt lgkmcnt(11)
    v_mfma_f32_16x16x32_bf16 v[16:19], v[88:91], a[72:75], v[16:19]
    buffer_load_dwordx4 a[104:107], v2, s[4:7], s35 offen offset:1024 sc1
    v_mfma_f32_16x16x32_bf16 v[40:43], v[88:91], a[76:79], v[40:43]
    s_waitcnt lgkmcnt(10)
    v_mfma_f32_16x16x32_bf16 v[20:23], v[92:95], a[72:75], v[20:23]
    v_mfma_f32_16x16x32_bf16 v[44:47], v[92:95], a[76:79], v[44:47]
    s_waitcnt lgkmcnt(9)
    v_mfma_f32_16x16x32_bf16 v[24:27], v[96:99], a[72:75], v[24:27]
    v_mfma_f32_16x16x32_bf16 v[48:51], v[96:99], a[76:79], v[48:51]
    s_waitcnt lgkmcnt(8)
    v_mfma_f32_16x16x32_bf16 v[28:31], v[100:103], a[72:75], v[28:31]
    buffer_load_dwordx4 a[108:111], v2, s[4:7], s36 offen offset:1024 sc1
    v_mfma_f32_16x16x32_bf16 v[52:55], v[100:103], a[76:79], v[52:55]
    s_waitcnt lgkmcnt(7)
    v_mfma_f32_16x16x32_bf16 v[32:35], v[104:107], a[72:75], v[32:35]
    v_mfma_f32_16x16x32_bf16 v[56:59], v[104:107], a[76:79], v[56:59]
    s_waitcnt lgkmcnt(6)
    v_mfma_f32_16x16x32_bf16 v[36:39], v[108:111], a[72:75], v[36:39]
    v_mfma_f32_16x16x32_bf16 v[60:63], v[108:111], a[76:79], v[60:63]
    ds_read_b128 v[88:91], v3 offset:2048
    ds_read_b128 v[92:95], v3 offset:3072
    ds_read_b128 v[96:99], v3 offset:4096
    ds_read_b128 v[100:103], v3 offset:5120
    ds_read_b128 v[104:107], v3 offset:6144
    ds_read_b128 v[108:111], v3 offset:7168
    s_waitcnt vmcnt(6)
    s_waitcnt lgkmcnt(11)
    v_mfma_f32_16x16x32_bf16 v[16:19], v[64:67], a[80:83], v[16:19]
    buffer_load_dwordx4 a[112:115], v2, s[4:7], s35 offen offset:2048 sc1
    v_mfma_f32_16x16x32_bf16 v[40:43], v[64:67], a[84:87], v[40:43]
    s_waitcnt lgkmcnt(10)
    v_mfma_f32_16x16x32_bf16 v[20:23], v[68:71], a[80:83], v[20:23]
    v_mfma_f32_16x16x32_bf16 v[44:47], v[68:71], a[84:87], v[44:47]
    s_waitcnt lgkmcnt(9)
    v_mfma_f32_16x16x32_bf16 v[24:27], v[72:75], a[80:83], v[24:27]
    v_mfma_f32_16x16x32_bf16 v[48:51], v[72:75], a[84:87], v[48:51]
    s_waitcnt lgkmcnt(8)
    v_mfma_f32_16x16x32_bf16 v[28:31], v[76:79], a[80:83], v[28:31]
    buffer_load_dwordx4 a[116:119], v2, s[4:7], s36 offen offset:2048 sc1
    v_mfma_f32_16x16x32_bf16 v[52:55], v[76:79], a[84:87], v[52:55]
    s_waitcnt lgkmcnt(7)
    v_mfma_f32_16x16x32_bf16 v[32:35], v[80:83], a[80:83], v[32:35]
    v_mfma_f32_16x16x32_bf16 v[56:59], v[80:83], a[84:87], v[56:59]
    s_waitcnt lgkmcnt(6)
    v_mfma_f32_16x16x32_bf16 v[36:39], v[84:87], a[80:83], v[36:39]
    v_mfma_f32_16x16x32_bf16 v[60:63], v[84:87], a[84:87], v[60:63]
    ds_read_b128 v[64:67], v3 offset:8192
    ds_read_b128 v[68:71], v3 offset:9216
    ds_read_b128 v[72:75], v3 offset:10240
    ds_read_b128 v[76:79], v3 offset:11264
    ds_read_b128 v[80:83], v3 offset:12288
    ds_read_b128 v[84:87], v3 offset:13312
    s_waitcnt vmcnt(6)
    s_waitcnt lgkmcnt(11)
    v_mfma_f32_16x16x32_bf16 v[16:19], v[88:91], a[88:91], v[16:19]
    buffer_load_dwordx4 a[120:123], v2, s[4:7], s35 offen offset:3072 sc1
    v_mfma_f32_16x16x32_bf16 v[40:43], v[88:91], a[92:95], v[40:43]
    s_waitcnt lgkmcnt(10)
    v_mfma_f32_16x16x32_bf16 v[20:23], v[92:95], a[88:91], v[20:23]
    v_mfma_f32_16x16x32_bf16 v[44:47], v[92:95], a[92:95], v[44:47]
    s_waitcnt lgkmcnt(9)
    v_mfma_f32_16x16x32_bf16 v[24:27], v[96:99], a[88:91], v[24:27]
    v_mfma_f32_16x16x32_bf16 v[48:51], v[96:99], a[92:95], v[48:51]
    s_waitcnt lgkmcnt(8)
    v_mfma_f32_16x16x32_bf16 v[28:31], v[100:103], a[88:91], v[28:31]
    buffer_load_dwordx4 a[124:127], v2, s[4:7], s36 offen offset:3072 sc1
    v_mfma_f32_16x16x32_bf16 v[52:55], v[100:103], a[92:95], v[52:55]
    s_waitcnt lgkmcnt(7)
    v_mfma_f32_16x16x32_bf16 v[32:35], v[104:107], a[88:91], v[32:35]
    v_mfma_f32_16x16x32_bf16 v[56:59], v[104:107], a[92:95], v[56:59]
    s_waitcnt lgkmcnt(6)
    v_mfma_f32_16x16x32_bf16 v[36:39], v[108:111], a[88:91], v[36:39]
    v_mfma_f32_16x16x32_bf16 v[60:63], v[108:111], a[92:95], v[60:63]
    ds_read_b128 v[88:91], v3 offset:14336
    ds_read_b128 v[92:95], v3 offset:15360
    ds_read_b128 v[96:99], v3 offset:16384
    ds_read_b128 v[100:103], v3 offset:17408
    ds_read_b128 v[104:107], v3 offset:18432
    ds_read_b128 v[108:111], v3 offset:19456
    s_waitcnt vmcnt(6)
    s_waitcnt lgkmcnt(11)
    v_mfma_f32_16x16x32_bf16 v[16:19], v[64:67], a[96:99], v[16:19]
    s_add_u32 s35, s25, 16384
    buffer_load_dwordx4 a[128:131], v2, s[4:7], s35 offen offset:0 sc1
    v_mfma_f32_16x16x32_bf16 v[40:43], v[64:67], a[100:103], v[40:43]
    s_waitcnt lgkmcnt(10)
    v_mfma_f32_16x16x32_bf16 v[20:23], v[68:71], a[96:99], v[20:23]
    v_mfma_f32_16x16x32_bf16 v[44:47], v[68:71], a[100:103], v[44:47]
    s_waitcnt lgkmcnt(9)
    v_mfma_f32_16x16x32_bf16 v[24:27], v[72:75], a[96:99], v[24:27]
    v_mfma_f32_16x16x32_bf16 v[48:51], v[72:75], a[100:103], v[48:51]
    s_waitcnt lgkmcnt(8)
    v_mfma_f32_16x16x32_bf16 v[28:31], v[76:79], a[96:99], v[28:31]
    s_add_u32 s36, s26, 16384
    buffer_load_dwordx4 a[132:135], v2, s[4:7], s36 offen offset:0 sc1
    v_mfma_f32_16x16x32_bf16 v[52:55], v[76:79], a[100:103], v[52:55]
    s_waitcnt lgkmcnt(7)
    v_mfma_f32_16x16x32_bf16 v[32:35], v[80:83], a[96:99], v[32:35]
    v_mfma_f32_16x16x32_bf16 v[56:59], v[80:83], a[100:103], v[56:59]
    s_waitcnt lgkmcnt(6)
    v_mfma_f32_16x16x32_bf16 v[36:39], v[84:87], a[96:99], v[36:39]
    v_mfma_f32_16x16x32_bf16 v[60:63], v[84:87], a[100:103], v[60:63]
    ds_read_b128 v[64:67], v3 offset:20480
    ds_read_b128 v[68:71], v3 offset:21504
    ds_read_b128 v[72:75], v3 offset:22528
    ds_read_b128 v[76:79], v3 offset:23552
    ds_read_b128 v[80:83], v3 offset:24576
    ds_read_b128 v[84:87], v3 offset:25600
    s_waitcnt vmcnt(6)
    s_waitcnt lgkmcnt(11)
    v_mfma_f32_16x16x32_bf16 v[16:19], v[88:91], a[104:107], v[16:19]
    buffer_load_dwordx4 a[136:139], v2, s[4:7], s35 offen offset:1024 sc1
    v_mfma_f32_16x16x32_bf16 v[40:43], v[88:91], a[108:111], v[40:43]
    s_waitcnt lgkmcnt(10)
    v_mfma_f32_16x16x32_bf16 v[20:23], v[92:95], a[104:107], v[20:23]
    v_mfma_f32_16x16x32_bf16 v[44:47], v[92:95], a[108:111], v[44:47]
    s_waitcnt lgkmcnt(9)
    v_mfma_f32_16x16x32_bf16 v[24:27], v[96:99], a[104:107], v[24:27]
    v_mfma_f32_16x16x32_bf16 v[48:51], v[96:99], a[108:111], v[48:51]
    s_waitcnt lgkmcnt(8)
    v_mfma_f32_16x16x32_bf16 v[28:31], v[100:103], a[104:107], v[28:31]
    buffer_load_dwordx4 a[140:143], v2, s[4:7], s36 offen offset:1024 sc1
    v_mfma_f32_16x16x32_bf16 v[52:55], v[100:103], a[108:111], v[52:55]
    s_waitcnt lgkmcnt(7)
    v_mfma_f32_16x16x32_bf16 v[32:35], v[104:107], a[104:107], v[32:35]
    v_mfma_f32_16x16x32_bf16 v[56:59], v[104:107], a[108:111], v[56:59]
    s_waitcnt lgkmcnt(6)
    v_mfma_f32_16x16x32_bf16 v[36:39], v[108:111], a[104:107], v[36:39]
    v_mfma_f32_16x16x32_bf16 v[60:63], v[108:111], a[108:111], v[60:63]
    ds_read_b128 v[88:91], v3 offset:26624
    ds_read_b128 v[92:95], v3 offset:27648
    ds_read_b128 v[96:99], v3 offset:28672
    ds_read_b128 v[100:103], v3 offset:29696
    ds_read_b128 v[104:107], v3 offset:30720
    ds_read_b128 v[108:111], v3 offset:31744
    s_waitcnt vmcnt(6)
    s_waitcnt lgkmcnt(11)
    v_mfma_f32_16x16x32_bf16 v[16:19], v[64:67], a[112:115], v[16:19]
    buffer_load_dwordx4 a[144:147], v2, s[4:7], s35 offen offset:2048 sc1
    v_mfma_f32_16x16x32_bf16 v[40:43], v[64:67], a[116:119], v[40:43]
    s_waitcnt lgkmcnt(10)
    v_mfma_f32_16x16x32_bf16 v[20:23], v[68:71], a[112:115], v[20:23]
    v_mfma_f32_16x16x32_bf16 v[44:47], v[68:71], a[116:119], v[44:47]
    s_waitcnt lgkmcnt(9)
    v_mfma_f32_16x16x32_bf16 v[24:27], v[72:75], a[112:115], v[24:27]
    v_mfma_f32_16x16x32_bf16 v[48:51], v[72:75], a[116:119], v[48:51]
    s_waitcnt lgkmcnt(8)
    v_mfma_f32_16x16x32_bf16 v[28:31], v[76:79], a[112:115], v[28:31]
    buffer_load_dwordx4 a[148:151], v2, s[4:7], s36 offen offset:2048 sc1
    v_mfma_f32_16x16x32_bf16 v[52:55], v[76:79], a[116:119], v[52:55]
    s_waitcnt lgkmcnt(7)
    v_mfma_f32_16x16x32_bf16 v[32:35], v[80:83], a[112:115], v[32:35]
    v_mfma_f32_16x16x32_bf16 v[56:59], v[80:83], a[116:119], v[56:59]
    s_waitcnt lgkmcnt(6)
    v_mfma_f32_16x16x32_bf16 v[36:39], v[84:87], a[112:115], v[36:39]
    v_mfma_f32_16x16x32_bf16 v[60:63], v[84:87], a[116:119], v[60:63]
    ds_read_b128 v[64:67], v3 offset:32768
    ds_read_b128 v[68:71], v3 offset:33792
    ds_read_b128 v[72:75], v3 offset:34816
    ds_read_b128 v[76:79], v3 offset:35840
    ds_read_b128 v[80:83], v3 offset:36864
    ds_read_b128 v[84:87], v3 offset:37888
    s_waitcnt vmcnt(6)
    s_waitcnt lgkmcnt(11)
    v_mfma_f32_16x16x32_bf16 v[16:19], v[88:91], a[120:123], v[16:19]
    buffer_load_dwordx4 a[152:155], v2, s[4:7], s35 offen offset:3072 sc1
    v_mfma_f32_16x16x32_bf16 v[40:43], v[88:91], a[124:127], v[40:43]
    s_waitcnt lgkmcnt(10)
    v_mfma_f32_16x16x32_bf16 v[20:23], v[92:95], a[120:123], v[20:23]
    v_mfma_f32_16x16x32_bf16 v[44:47], v[92:95], a[124:127], v[44:47]
    s_waitcnt lgkmcnt(9)
    v_mfma_f32_16x16x32_bf16 v[24:27], v[96:99], a[120:123], v[24:27]
    v_mfma_f32_16x16x32_bf16 v[48:51], v[96:99], a[124:127], v[48:51]
    s_waitcnt lgkmcnt(8)
    v_mfma_f32_16x16x32_bf16 v[28:31], v[100:103], a[120:123], v[28:31]
    buffer_load_dwordx4 a[156:159], v2, s[4:7], s36 offen offset:3072 sc1
    v_mfma_f32_16x16x32_bf16 v[52:55], v[100:103], a[124:127], v[52:55]
    s_waitcnt lgkmcnt(7)
    v_mfma_f32_16x16x32_bf16 v[32:35], v[104:107], a[120:123], v[32:35]
    v_mfma_f32_16x16x32_bf16 v[56:59], v[104:107], a[124:127], v[56:59]
    s_waitcnt lgkmcnt(6)
    v_mfma_f32_16x16x32_bf16 v[36:39], v[108:111], a[120:123], v[36:39]
    v_mfma_f32_16x16x32_bf16 v[60:63], v[108:111], a[124:127], v[60:63]
    ds_read_b128 v[88:91], v3 offset:38912
    ds_read_b128 v[92:95], v3 offset:39936
    ds_read_b128 v[96:99], v3 offset:40960
    ds_read_b128 v[100:103], v3 offset:41984
    ds_read_b128 v[104:107], v3 offset:43008
    ds_read_b128 v[108:111], v3 offset:44032
    s_waitcnt vmcnt(6)
    s_waitcnt lgkmcnt(11)
    v_mfma_f32_16x16x32_bf16 v[16:19], v[64:67], a[128:131], v[16:19]
    v_mfma_f32_16x16x32_bf16 v[40:43], v[64:67], a[132:135], v[40:43]
    s_waitcnt lgkmcnt(10)
    v_mfma_f32_16x16x32_bf16 v[20:23], v[68:71], a[128:131], v[20:23]
    v_mfma_f32_16x16x32_bf16 v[44:47], v[68:71], a[132:135], v[44:47]
    s_waitcnt lgkmcnt(9)
    v_mfma_f32_16x16x32_bf16 v[24:27], v[72:75], a[128:131], v[24:27]
    v_mfma_f32_16x16x32_bf16 v[48:51], v[72:75], a[132:135], v[48:51]
    s_waitcnt lgkmcnt(8)
    v_mfma_f32_16x16x32_bf16 v[28:31], v[76:79], a[128:131], v[28:31]
    v_mfma_f32_16x16x32_bf16 v[52:55], v[76:79], a[132:135], v[52:55]
    s_waitcnt lgkmcnt(7)
    v_mfma_f32_16x16x32_bf16 v[32:35], v[80:83], a[128:131], v[32:35]
    v_mfma_f32_16x16x32_bf16 v[56:59], v[80:83], a[132:135], v[56:59]
    s_waitcnt lgkmcnt(6)
    v_mfma_f32_16x16x32_bf16 v[36:39], v[84:87], a[128:131], v[36:39]
    v_mfma_f32_16x16x32_bf16 v[60:63], v[84:87], a[132:135], v[60:63]
    ds_read_b128 v[64:67], v3 offset:45056
    ds_read_b128 v[68:71], v3 offset:46080
    ds_read_b128 v[72:75], v3 offset:47104
    ds_read_b128 v[76:79], v3 offset:48128
    ds_read_b128 v[80:83], v3 offset:49152
    ds_read_b128 v[84:87], v3 offset:50176
    s_waitcnt vmcnt(4)
    s_waitcnt lgkmcnt(11)
    v_mfma_f32_16x16x32_bf16 v[16:19], v[88:91], a[136:139], v[16:19]
    v_mfma_f32_16x16x32_bf16 v[40:43], v[88:91], a[140:143], v[40:43]
    s_waitcnt lgkmcnt(10)
    v_mfma_f32_16x16x32_bf16 v[20:23], v[92:95], a[136:139], v[20:23]
    v_mfma_f32_16x16x32_bf16 v[44:47], v[92:95], a[140:143], v[44:47]
    s_waitcnt lgkmcnt(9)
    v_mfma_f32_16x16x32_bf16 v[24:27], v[96:99], a[136:139], v[24:27]
    v_mfma_f32_16x16x32_bf16 v[48:51], v[96:99], a[140:143], v[48:51]
    s_waitcnt lgkmcnt(8)
    v_mfma_f32_16x16x32_bf16 v[28:31], v[100:103], a[136:139], v[28:31]
    v_mfma_f32_16x16x32_bf16 v[52:55], v[100:103], a[140:143], v[52:55]
    s_waitcnt lgkmcnt(7)
    v_mfma_f32_16x16x32_bf16 v[32:35], v[104:107], a[136:139], v[32:35]
    v_mfma_f32_16x16x32_bf16 v[56:59], v[104:107], a[140:143], v[56:59]
    s_waitcnt lgkmcnt(6)
    v_mfma_f32_16x16x32_bf16 v[36:39], v[108:111], a[136:139], v[36:39]
    v_mfma_f32_16x16x32_bf16 v[60:63], v[108:111], a[140:143], v[60:63]
    ds_read_b128 v[88:91], v3 offset:51200
    ds_read_b128 v[92:95], v3 offset:52224
    ds_read_b128 v[96:99], v3 offset:53248
    ds_read_b128 v[100:103], v3 offset:54272
    ds_read_b128 v[104:107], v3 offset:55296
    ds_read_b128 v[108:111], v3 offset:56320
    s_waitcnt vmcnt(2)
    s_waitcnt lgkmcnt(11)
    v_mfma_f32_16x16x32_bf16 v[16:19], v[64:67], a[144:147], v[16:19]
    v_mfma_f32_16x16x32_bf16 v[40:43], v[64:67], a[148:151], v[40:43]
    s_waitcnt lgkmcnt(10)
    v_mfma_f32_16x16x32_bf16 v[20:23], v[68:71], a[144:147], v[20:23]
    v_mfma_f32_16x16x32_bf16 v[44:47], v[68:71], a[148:151], v[44:47]
    s_waitcnt lgkmcnt(9)
    v_mfma_f32_16x16x32_bf16 v[24:27], v[72:75], a[144:147], v[24:27]
    v_mfma_f32_16x16x32_bf16 v[48:51], v[72:75], a[148:151], v[48:51]
    s_waitcnt lgkmcnt(8)
    v_mfma_f32_16x16x32_bf16 v[28:31], v[76:79], a[144:147], v[28:31]
    v_mfma_f32_16x16x32_bf16 v[52:55], v[76:79], a[148:151], v[52:55]
    s_waitcnt lgkmcnt(7)
    v_mfma_f32_16x16x32_bf16 v[32:35], v[80:83], a[144:147], v[32:35]
    v_mfma_f32_16x16x32_bf16 v[56:59], v[80:83], a[148:151], v[56:59]
    s_waitcnt lgkmcnt(6)
    v_mfma_f32_16x16x32_bf16 v[36:39], v[84:87], a[144:147], v[36:39]
    v_mfma_f32_16x16x32_bf16 v[60:63], v[84:87], a[148:151], v[60:63]
    s_waitcnt vmcnt(0)
    s_waitcnt lgkmcnt(5)
    v_mfma_f32_16x16x32_bf16 v[16:19], v[88:91], a[152:155], v[16:19]
    v_mfma_f32_16x16x32_bf16 v[40:43], v[88:91], a[156:159], v[40:43]
    s_waitcnt lgkmcnt(4)
    v_mfma_f32_16x16x32_bf16 v[20:23], v[92:95], a[152:155], v[20:23]
    v_mfma_f32_16x16x32_bf16 v[44:47], v[92:95], a[156:159], v[44:47]
    s_waitcnt lgkmcnt(3)
    v_mfma_f32_16x16x32_bf16 v[24:27], v[96:99], a[152:155], v[24:27]
    v_mfma_f32_16x16x32_bf16 v[48:51], v[96:99], a[156:159], v[48:51]
    s_waitcnt lgkmcnt(2)
    v_mfma_f32_16x16x32_bf16 v[28:31], v[100:103], a[152:155], v[28:31]
    v_mfma_f32_16x16x32_bf16 v[52:55], v[100:103], a[156:159], v[52:55]
    s_waitcnt lgkmcnt(1)
    v_mfma_f32_16x16x32_bf16 v[32:35], v[104:107], a[152:155], v[32:35]
    v_mfma_f32_16x16x32_bf16 v[56:59], v[104:107], a[156:159], v[56:59]
    s_waitcnt lgkmcnt(0)
    v_mfma_f32_16x16x32_bf16 v[36:39], v[108:111], a[152:155], v[36:39]
    v_mfma_f32_16x16x32_bf16 v[60:63], v[108:111], a[156:159], v[60:63]
    s_nop 7
    v_and_b32 v5, 48, v1
    v_add_u32 v5, 162048, v5
    ds_read_b128 v[112:115], v5 offset:0
    ds_read_b128 v[116:119], v5 offset:64
    ds_read_b128 v[120:123], v5 offset:128
    ds_read_b128 v[124:127], v5 offset:192
    ds_read_b128 v[128:131], v5 offset:256
    ds_read_b128 v[132:135], v5 offset:320
    v_add_f32 v8, v8, v10
    v_add_f32 v9, v9, v11
    v_add_f32 v10, v12, v14
    v_add_f32 v11, v13, v15
    v_xor_b32 v7, 32, v1
    v_lshlrev_b32 v7, 2, v7
    ds_swizzle_b32 v12, v8 offset:0x401F
    ds_swizzle_b32 v13, v9 offset:0x401F
    ds_swizzle_b32 v14, v10 offset:0x401F
    ds_swizzle_b32 v15, v11 offset:0x401F
    s_waitcnt lgkmcnt(0)
    v_add_f32 v8, v8, v12
    v_add_f32 v9, v9, v13
    v_add_f32 v10, v10, v14
    v_add_f32 v11, v11, v15
    ds_bpermute_b32 v12, v7, v8
    ds_bpermute_b32 v13, v7, v9
    ds_bpermute_b32 v14, v7, v10
    ds_bpermute_b32 v15, v7, v11
    s_waitcnt lgkmcnt(0)
    v_add_f32 v8, v8, v12
    v_add_f32 v9, v9, v13
    v_add_f32 v10, v10, v14
    v_add_f32 v11, v11, v15
    v_mul_f32 v8, 0x3acccccd, v8
    v_mul_f32 v9, 0x3acccccd, v9
    v_fma_f32 v9, -v8, v8, v9
    v_max_f32 v9, 0, v9
    v_cvt_pk_bf16_f32 v8, v8, v8
    v_and_b32 v8, 0xffff0000, v8
    v_cvt_pk_bf16_f32 v9, v9, v9
    v_and_b32 v9, 0xffff0000, v9
    v_add_f32 v9, 0x3727c5ac, v9
    v_cvt_pk_bf16_f32 v9, v9, v9
    v_and_b32 v9, 0xffff0000, v9
    v_sqrt_f32 v9, v9
    s_nop 0
    v_cvt_pk_bf16_f32 v9, v9, v9
    v_and_b32 v9, 0xffff0000, v9
    v_rcp_f32 v9, v9
    s_nop 0
    v_mul_f32 v10, 0x3acccccd, v10
    v_mul_f32 v11, 0x3acccccd, v11
    v_fma_f32 v11, -v10, v10, v11
    v_max_f32 v11, 0, v11
    v_cvt_pk_bf16_f32 v10, v10, v10
    v_and_b32 v10, 0xffff0000, v10
    v_cvt_pk_bf16_f32 v11, v11, v11
    v_and_b32 v11, 0xffff0000, v11
    v_add_f32 v11, 0x3727c5ac, v11
    v_cvt_pk_bf16_f32 v11, v11, v11
    v_and_b32 v11, 0xffff0000, v11
    v_sqrt_f32 v11, v11
    s_nop 0
    v_cvt_pk_bf16_f32 v11, v11, v11
    v_and_b32 v11, 0xffff0000, v11
    v_rcp_f32 v11, v11
    s_nop 0
    s_mov_b32 s40, 0xbdd2d3e8
    v_mov_b32 v5, 0xc0135761
    s_mul_i32 s38, s24, 49152
    s_mul_i32 s39, s45, 3072
    s_add_u32 s38, s38, s39
    s_add_u32 s38, s38, 10485760
    s_add_u32 s39, s38, 49152
    v_fma_f32 v16, -v8, v112, v16
    v_fma_f32 v17, -v8, v113, v17
    v_fma_f32 v18, -v8, v114, v18
    v_fma_f32 v19, -v8, v115, v19
    v_fma_f32 v20, -v8, v116, v20
    v_fma_f32 v21, -v8, v117, v21
    v_fma_f32 v22, -v8, v118, v22
    v_fma_f32 v23, -v8, v119, v23
    v_mul_f32 v16, v16, v9
    v_mul_f32 v17, v17, v9
    v_mul_f32 v18, v18, v9
    v_mul_f32 v19, v19, v9
    v_mul_f32 v20, v20, v9
    v_mul_f32 v21, v21, v9
    v_mul_f32 v22, v22, v9
    v_mul_f32 v23, v23, v9
    v_mul_f32 v64, v16, v16
    v_mul_f32 v65, v17, v17
    v_mul_f32 v66, v18, v18
    v_mul_f32 v67, v19, v19
    v_mul_f32 v68, v20, v20
    v_mul_f32 v69, v21, v21
    v_mul_f32 v70, v22, v22
    v_mul_f32 v71, v23, v23
    v_fma_f32 v64, v64, s40, v5
    v_fma_f32 v65, v65, s40, v5
    v_fma_f32 v66, v66, s40, v5
    v_fma_f32 v67, v67, s40, v5
    v_fma_f32 v68, v68, s40, v5
    v_fma_f32 v69, v69, s40, v5
    v_fma_f32 v70, v70, s40, v5
    v_fma_f32 v71, v71, s40, v5
    v_mul_f32 v64, v64, v16
    v_mul_f32 v65, v65, v17
    v_mul_f32 v66, v66, v18
    v_mul_f32 v67, v67, v19
    v_mul_f32 v68, v68, v20
    v_mul_f32 v69, v69, v21
    v_mul_f32 v70, v70, v22
    v_mul_f32 v71, v71, v23
    v_exp_f32 v64, v64
    v_exp_f32 v65, v65
    v_exp_f32 v66, v66
    v_exp_f32 v67, v67
    v_exp_f32 v68, v68
    v_exp_f32 v69, v69
    v_exp_f32 v70, v70
    v_exp_f32 v71, v71
    v_add_f32 v64, 1.0, v64
    v_add_f32 v65, 1.0, v65
    v_add_f32 v66, 1.0, v66
    v_add_f32 v67, 1.0, v67
    v_add_f32 v68, 1.0, v68
    v_add_f32 v69, 1.0, v69
    v_add_f32 v70, 1.0, v70
    v_add_f32 v71, 1.0, v71
    v_rcp_f32 v64, v64
    v_rcp_f32 v65, v65
    v_rcp_f32 v66, v66
    v_rcp_f32 v67, v67
    v_rcp_f32 v68, v68
    v_rcp_f32 v69, v69
    v_rcp_f32 v70, v70
    v_rcp_f32 v71, v71
    v_mul_f32 v16, v16, v64
    v_mul_f32 v17, v17, v65
    v_mul_f32 v18, v18, v66
    v_mul_f32 v19, v19, v67
    v_mul_f32 v20, v20, v68
    v_mul_f32 v21, v21, v69
    v_mul_f32 v22, v22, v70
    v_mul_f32 v23, v23, v71
    v_cvt_pk_bf16_f32 v88, v16, v17
    v_cvt_pk_bf16_f32 v89, v18, v19
    v_cvt_pk_bf16_f32 v90, v20, v21
    v_cvt_pk_bf16_f32 v91, v22, v23
    buffer_store_dwordx4 v[88:91], v2, s[4:7], s38 offen offset:0 sc1
    v_fma_f32 v24, -v8, v120, v24
    v_fma_f32 v25, -v8, v121, v25
    v_fma_f32 v26, -v8, v122, v26
    v_fma_f32 v27, -v8, v123, v27
    v_fma_f32 v28, -v8, v124, v28
    v_fma_f32 v29, -v8, v125, v29
    v_fma_f32 v30, -v8, v126, v30
    v_fma_f32 v31, -v8, v127, v31
    v_mul_f32 v24, v24, v9
    v_mul_f32 v25, v25, v9
    v_mul_f32 v26, v26, v9
    v_mul_f32 v27, v27, v9
    v_mul_f32 v28, v28, v9
    v_mul_f32 v29, v29, v9
    v_mul_f32 v30, v30, v9
    v_mul_f32 v31, v31, v9
    v_mul_f32 v64, v24, v24
    v_mul_f32 v65, v25, v25
    v_mul_f32 v66, v26, v26
    v_mul_f32 v67, v27, v27
    v_mul_f32 v68, v28, v28
    v_mul_f32 v69, v29, v29
    v_mul_f32 v70, v30, v30
    v_mul_f32 v71, v31, v31
    v_fma_f32 v64, v64, s40, v5
    v_fma_f32 v65, v65, s40, v5
    v_fma_f32 v66, v66, s40, v5
    v_fma_f32 v67, v67, s40, v5
    v_fma_f32 v68, v68, s40, v5
    v_fma_f32 v69, v69, s40, v5
    v_fma_f32 v70, v70, s40, v5
    v_fma_f32 v71, v71, s40, v5
    v_mul_f32 v64, v64, v24
    v_mul_f32 v65, v65, v25
    v_mul_f32 v66, v66, v26
    v_mul_f32 v67, v67, v27
    v_mul_f32 v68, v68, v28
    v_mul_f32 v69, v69, v29
    v_mul_f32 v70, v70, v30
    v_mul_f32 v71, v71, v31
    v_exp_f32 v64, v64
    v_exp_f32 v65, v65
    v_exp_f32 v66, v66
    v_exp_f32 v67, v67
    v_exp_f32 v68, v68
    v_exp_f32 v69, v69
    v_exp_f32 v70, v70
    v_exp_f32 v71, v71
    v_add_f32 v64, 1.0, v64
    v_add_f32 v65, 1.0, v65
    v_add_f32 v66, 1.0, v66
    v_add_f32 v67, 1.0, v67
    v_add_f32 v68, 1.0, v68
    v_add_f32 v69, 1.0, v69
    v_add_f32 v70, 1.0, v70
    v_add_f32 v71, 1.0, v71
    v_rcp_f32 v64, v64
    v_rcp_f32 v65, v65
    v_rcp_f32 v66, v66
    v_rcp_f32 v67, v67
    v_rcp_f32 v68, v68
    v_rcp_f32 v69, v69
    v_rcp_f32 v70, v70
    v_rcp_f32 v71, v71
    v_mul_f32 v24, v24, v64
    v_mul_f32 v25, v25, v65
    v_mul_f32 v26, v26, v66
    v_mul_f32 v27, v27, v67
    v_mul_f32 v28, v28, v68
    v_mul_f32 v29, v29, v69
    v_mul_f32 v30, v30, v70
    v_mul_f32 v31, v31, v71
    v_cvt_pk_bf16_f32 v92, v24, v25
    v_cvt_pk_bf16_f32 v93, v26, v27
    v_cvt_pk_bf16_f32 v94, v28, v29
    v_cvt_pk_bf16_f32 v95, v30, v31
    buffer_store_dwordx4 v[92:95], v2, s[4:7], s38 offen offset:1024 sc1
    v_fma_f32 v32, -v8, v128, v32
    v_fma_f32 v33, -v8, v129, v33
    v_fma_f32 v34, -v8, v130, v34
    v_fma_f32 v35, -v8, v131, v35
    v_fma_f32 v36, -v8, v132, v36
    v_fma_f32 v37, -v8, v133, v37
    v_fma_f32 v38, -v8, v134, v38
    v_fma_f32 v39, -v8, v135, v39
    v_mul_f32 v32, v32, v9
    v_mul_f32 v33, v33, v9
    v_mul_f32 v34, v34, v9
    v_mul_f32 v35, v35, v9
    v_mul_f32 v36, v36, v9
    v_mul_f32 v37, v37, v9
    v_mul_f32 v38, v38, v9
    v_mul_f32 v39, v39, v9
    v_mul_f32 v64, v32, v32
    v_mul_f32 v65, v33, v33
    v_mul_f32 v66, v34, v34
    v_mul_f32 v67, v35, v35
    v_mul_f32 v68, v36, v36
    v_mul_f32 v69, v37, v37
    v_mul_f32 v70, v38, v38
    v_mul_f32 v71, v39, v39
    v_fma_f32 v64, v64, s40, v5
    v_fma_f32 v65, v65, s40, v5
    v_fma_f32 v66, v66, s40, v5
    v_fma_f32 v67, v67, s40, v5
    v_fma_f32 v68, v68, s40, v5
    v_fma_f32 v69, v69, s40, v5
    v_fma_f32 v70, v70, s40, v5
    v_fma_f32 v71, v71, s40, v5
    v_mul_f32 v64, v64, v32
    v_mul_f32 v65, v65, v33
    v_mul_f32 v66, v66, v34
    v_mul_f32 v67, v67, v35
    v_mul_f32 v68, v68, v36
    v_mul_f32 v69, v69, v37
    v_mul_f32 v70, v70, v38
    v_mul_f32 v71, v71, v39
    v_exp_f32 v64, v64
    v_exp_f32 v65, v65
    v_exp_f32 v66, v66
    v_exp_f32 v67, v67
    v_exp_f32 v68, v68
    v_exp_f32 v69, v69
    v_exp_f32 v70, v70
    v_exp_f32 v71, v71
    v_add_f32 v64, 1.0, v64
    v_add_f32 v65, 1.0, v65
    v_add_f32 v66, 1.0, v66
    v_add_f32 v67, 1.0, v67
    v_add_f32 v68, 1.0, v68
    v_add_f32 v69, 1.0, v69
    v_add_f32 v70, 1.0, v70
    v_add_f32 v71, 1.0, v71
    v_rcp_f32 v64, v64
    v_rcp_f32 v65, v65
    v_rcp_f32 v66, v66
    v_rcp_f32 v67, v67
    v_rcp_f32 v68, v68
    v_rcp_f32 v69, v69
    v_rcp_f32 v70, v70
    v_rcp_f32 v71, v71
    v_mul_f32 v32, v32, v64
    v_mul_f32 v33, v33, v65
    v_mul_f32 v34, v34, v66
    v_mul_f32 v35, v35, v67
    v_mul_f32 v36, v36, v68
    v_mul_f32 v37, v37, v69
    v_mul_f32 v38, v38, v70
    v_mul_f32 v39, v39, v71
    v_cvt_pk_bf16_f32 v96, v32, v33
    v_cvt_pk_bf16_f32 v97, v34, v35
    v_cvt_pk_bf16_f32 v98, v36, v37
    v_cvt_pk_bf16_f32 v99, v38, v39
    buffer_store_dwordx4 v[96:99], v2, s[4:7], s38 offen offset:2048 sc1
    v_fma_f32 v40, -v10, v112, v40
    v_fma_f32 v41, -v10, v113, v41
    v_fma_f32 v42, -v10, v114, v42
    v_fma_f32 v43, -v10, v115, v43
    v_fma_f32 v44, -v10, v116, v44
    v_fma_f32 v45, -v10, v117, v45
    v_fma_f32 v46, -v10, v118, v46
    v_fma_f32 v47, -v10, v119, v47
    v_mul_f32 v40, v40, v11
    v_mul_f32 v41, v41, v11
    v_mul_f32 v42, v42, v11
    v_mul_f32 v43, v43, v11
    v_mul_f32 v44, v44, v11
    v_mul_f32 v45, v45, v11
    v_mul_f32 v46, v46, v11
    v_mul_f32 v47, v47, v11
    v_mul_f32 v64, v40, v40
    v_mul_f32 v65, v41, v41
    v_mul_f32 v66, v42, v42
    v_mul_f32 v67, v43, v43
    v_mul_f32 v68, v44, v44
    v_mul_f32 v69, v45, v45
    v_mul_f32 v70, v46, v46
    v_mul_f32 v71, v47, v47
    v_fma_f32 v64, v64, s40, v5
    v_fma_f32 v65, v65, s40, v5
    v_fma_f32 v66, v66, s40, v5
    v_fma_f32 v67, v67, s40, v5
    v_fma_f32 v68, v68, s40, v5
    v_fma_f32 v69, v69, s40, v5
    v_fma_f32 v70, v70, s40, v5
    v_fma_f32 v71, v71, s40, v5
    v_mul_f32 v64, v64, v40
    v_mul_f32 v65, v65, v41
    v_mul_f32 v66, v66, v42
    v_mul_f32 v67, v67, v43
    v_mul_f32 v68, v68, v44
    v_mul_f32 v69, v69, v45
    v_mul_f32 v70, v70, v46
    v_mul_f32 v71, v71, v47
    v_exp_f32 v64, v64
    v_exp_f32 v65, v65
    v_exp_f32 v66, v66
    v_exp_f32 v67, v67
    v_exp_f32 v68, v68
    v_exp_f32 v69, v69
    v_exp_f32 v70, v70
    v_exp_f32 v71, v71
    v_add_f32 v64, 1.0, v64
    v_add_f32 v65, 1.0, v65
    v_add_f32 v66, 1.0, v66
    v_add_f32 v67, 1.0, v67
    v_add_f32 v68, 1.0, v68
    v_add_f32 v69, 1.0, v69
    v_add_f32 v70, 1.0, v70
    v_add_f32 v71, 1.0, v71
    v_rcp_f32 v64, v64
    v_rcp_f32 v65, v65
    v_rcp_f32 v66, v66
    v_rcp_f32 v67, v67
    v_rcp_f32 v68, v68
    v_rcp_f32 v69, v69
    v_rcp_f32 v70, v70
    v_rcp_f32 v71, v71
    v_mul_f32 v40, v40, v64
    v_mul_f32 v41, v41, v65
    v_mul_f32 v42, v42, v66
    v_mul_f32 v43, v43, v67
    v_mul_f32 v44, v44, v68
    v_mul_f32 v45, v45, v69
    v_mul_f32 v46, v46, v70
    v_mul_f32 v47, v47, v71
    v_cvt_pk_bf16_f32 v100, v40, v41
    v_cvt_pk_bf16_f32 v101, v42, v43
    v_cvt_pk_bf16_f32 v102, v44, v45
    v_cvt_pk_bf16_f32 v103, v46, v47
    buffer_store_dwordx4 v[100:103], v2, s[4:7], s39 offen offset:0 sc1
    v_fma_f32 v48, -v10, v120, v48
    v_fma_f32 v49, -v10, v121, v49
    v_fma_f32 v50, -v10, v122, v50
    v_fma_f32 v51, -v10, v123, v51
    v_fma_f32 v52, -v10, v124, v52
    v_fma_f32 v53, -v10, v125, v53
    v_fma_f32 v54, -v10, v126, v54
    v_fma_f32 v55, -v10, v127, v55
    v_mul_f32 v48, v48, v11
    v_mul_f32 v49, v49, v11
    v_mul_f32 v50, v50, v11
    v_mul_f32 v51, v51, v11
    v_mul_f32 v52, v52, v11
    v_mul_f32 v53, v53, v11
    v_mul_f32 v54, v54, v11
    v_mul_f32 v55, v55, v11
    v_mul_f32 v64, v48, v48
    v_mul_f32 v65, v49, v49
    v_mul_f32 v66, v50, v50
    v_mul_f32 v67, v51, v51
    v_mul_f32 v68, v52, v52
    v_mul_f32 v69, v53, v53
    v_mul_f32 v70, v54, v54
    v_mul_f32 v71, v55, v55
    v_fma_f32 v64, v64, s40, v5
    v_fma_f32 v65, v65, s40, v5
    v_fma_f32 v66, v66, s40, v5
    v_fma_f32 v67, v67, s40, v5
    v_fma_f32 v68, v68, s40, v5
    v_fma_f32 v69, v69, s40, v5
    v_fma_f32 v70, v70, s40, v5
    v_fma_f32 v71, v71, s40, v5
    v_mul_f32 v64, v64, v48
    v_mul_f32 v65, v65, v49
    v_mul_f32 v66, v66, v50
    v_mul_f32 v67, v67, v51
    v_mul_f32 v68, v68, v52
    v_mul_f32 v69, v69, v53
    v_mul_f32 v70, v70, v54
    v_mul_f32 v71, v71, v55
    v_exp_f32 v64, v64
    v_exp_f32 v65, v65
    v_exp_f32 v66, v66
    v_exp_f32 v67, v67
    v_exp_f32 v68, v68
    v_exp_f32 v69, v69
    v_exp_f32 v70, v70
    v_exp_f32 v71, v71
    v_add_f32 v64, 1.0, v64
    v_add_f32 v65, 1.0, v65
    v_add_f32 v66, 1.0, v66
    v_add_f32 v67, 1.0, v67
    v_add_f32 v68, 1.0, v68
    v_add_f32 v69, 1.0, v69
    v_add_f32 v70, 1.0, v70
    v_add_f32 v71, 1.0, v71
    v_rcp_f32 v64, v64
    v_rcp_f32 v65, v65
    v_rcp_f32 v66, v66
    v_rcp_f32 v67, v67
    v_rcp_f32 v68, v68
    v_rcp_f32 v69, v69
    v_rcp_f32 v70, v70
    v_rcp_f32 v71, v71
    v_mul_f32 v48, v48, v64
    v_mul_f32 v49, v49, v65
    v_mul_f32 v50, v50, v66
    v_mul_f32 v51, v51, v67
    v_mul_f32 v52, v52, v68
    v_mul_f32 v53, v53, v69
    v_mul_f32 v54, v54, v70
    v_mul_f32 v55, v55, v71
    v_cvt_pk_bf16_f32 v104, v48, v49
    v_cvt_pk_bf16_f32 v105, v50, v51
    v_cvt_pk_bf16_f32 v106, v52, v53
    v_cvt_pk_bf16_f32 v107, v54, v55
    buffer_store_dwordx4 v[104:107], v2, s[4:7], s39 offen offset:1024 sc1
    v_fma_f32 v56, -v10, v128, v56
    v_fma_f32 v57, -v10, v129, v57
    v_fma_f32 v58, -v10, v130, v58
    v_fma_f32 v59, -v10, v131, v59
    v_fma_f32 v60, -v10, v132, v60
    v_fma_f32 v61, -v10, v133, v61
    v_fma_f32 v62, -v10, v134, v62
    v_fma_f32 v63, -v10, v135, v63
    v_mul_f32 v56, v56, v11
    v_mul_f32 v57, v57, v11
    v_mul_f32 v58, v58, v11
    v_mul_f32 v59, v59, v11
    v_mul_f32 v60, v60, v11
    v_mul_f32 v61, v61, v11
    v_mul_f32 v62, v62, v11
    v_mul_f32 v63, v63, v11
    v_mul_f32 v64, v56, v56
    v_mul_f32 v65, v57, v57
    v_mul_f32 v66, v58, v58
    v_mul_f32 v67, v59, v59
    v_mul_f32 v68, v60, v60
    v_mul_f32 v69, v61, v61
    v_mul_f32 v70, v62, v62
    v_mul_f32 v71, v63, v63
    v_fma_f32 v64, v64, s40, v5
    v_fma_f32 v65, v65, s40, v5
    v_fma_f32 v66, v66, s40, v5
    v_fma_f32 v67, v67, s40, v5
    v_fma_f32 v68, v68, s40, v5
    v_fma_f32 v69, v69, s40, v5
    v_fma_f32 v70, v70, s40, v5
    v_fma_f32 v71, v71, s40, v5
    v_mul_f32 v64, v64, v56
    v_mul_f32 v65, v65, v57
    v_mul_f32 v66, v66, v58
    v_mul_f32 v67, v67, v59
    v_mul_f32 v68, v68, v60
    v_mul_f32 v69, v69, v61
    v_mul_f32 v70, v70, v62
    v_mul_f32 v71, v71, v63
    v_exp_f32 v64, v64
    v_exp_f32 v65, v65
    v_exp_f32 v66, v66
    v_exp_f32 v67, v67
    v_exp_f32 v68, v68
    v_exp_f32 v69, v69
    v_exp_f32 v70, v70
    v_exp_f32 v71, v71
    v_add_f32 v64, 1.0, v64
    v_add_f32 v65, 1.0, v65
    v_add_f32 v66, 1.0, v66
    v_add_f32 v67, 1.0, v67
    v_add_f32 v68, 1.0, v68
    v_add_f32 v69, 1.0, v69
    v_add_f32 v70, 1.0, v70
    v_add_f32 v71, 1.0, v71
    v_rcp_f32 v64, v64
    v_rcp_f32 v65, v65
    v_rcp_f32 v66, v66
    v_rcp_f32 v67, v67
    v_rcp_f32 v68, v68
    v_rcp_f32 v69, v69
    v_rcp_f32 v70, v70
    v_rcp_f32 v71, v71
    v_mul_f32 v56, v56, v64
    v_mul_f32 v57, v57, v65
    v_mul_f32 v58, v58, v66
    v_mul_f32 v59, v59, v67
    v_mul_f32 v60, v60, v68
    v_mul_f32 v61, v61, v69
    v_mul_f32 v62, v62, v70
    v_mul_f32 v63, v63, v71
    v_cvt_pk_bf16_f32 v108, v56, v57
    v_cvt_pk_bf16_f32 v109, v58, v59
    v_cvt_pk_bf16_f32 v110, v60, v61
    v_cvt_pk_bf16_f32 v111, v62, v63
    buffer_store_dwordx4 v[108:111], v2, s[4:7], s39 offen offset:2048 sc1
    s_waitcnt vmcnt(0)
    s_barrier
    s_cmp_lg_u32 s30, 0
    s_cbranch_scc1 Lsig16
    s_lshl_b32 s20, s44, 7
    s_lshl_b32 s23, s45, 2
    s_add_u32 s20, s20, s23
    s_add_u32 s20, s20, 29896704
    v_mov_b32 v14, s31
    v_mov_b32 v15, 0
    s_mov_b64 exec, 1
    buffer_store_dword v14, v15, s[4:7], s20 offen sc1
    s_mov_b64 exec, -1
Lsig16:
    s_mov_b32 s46, 29886464
    s_mov_b32 s47, 0x40000
Lpoll17:
    buffer_load_dwordx4 v[12:15], v2, s[4:7], s46 offen sc1
    s_waitcnt vmcnt(0)
    v_xor_b32 v12, s31, v12
    v_xor_b32 v13, s31, v13
    v_xor_b32 v14, s31, v14
    v_xor_b32 v15, s31, v15
    v_or3_b32 v12, v12, v13, v14
    v_or_b32 v12, v12, v15
    v_cmp_ne_u32 vcc, 0, v12
    s_sub_u32 s47, s47, 1
    s_cmp_eq_u32 s47, 0
    s_cbranch_scc1 Lpoll17_x
    s_nop 2
    s_cbranch_vccnz Lpoll17
Lpoll17_x:
    s_lshl_b32 s24, s21, 2
    s_add_u32 s24, s24, s30
    s_mul_i32 s24, s24, 1
    s_mul_i32 s25, s24, 49152
    s_add_u32 s25, s25, 10485760
    s_add_u32 s26, s25, 49152
    s_mul_i32 s27, s22, 245760
    s_add_u32 s27, s27, 20971520
    s_mul_i32 s29, s30, 5120
    s_add_u32 s28, s27, s29
    s_mov_b32 s8, s48
    s_mov_b32 s9, s49
    s_mov_b32 s10, 0x280000
    s_mov_b32 s11, 0x20000
    s_mov_b32 s12, s70
    s_mov_b32 s13, s71
    s_mov_b32 s14, 0x280000
    s_mov_b32 s15, 0x20000
    v_lshrrev_b32 v5, 3, v1
    v_and_b32 v6, 7, v1
    v_lshlrev_b32 v5, 12, v5
    v_lshl_add_u32 v5, v6, 4, v5
    s_mul_i32 s36, s22, 80
    s_mul_i32 s37, s30, 24
    s_add_u32 s36, s36, s37
    s_lshl_b32 s36, s36, 12
    s_lshl_b32 s37, s21, 7
    s_add_u32 s36, s36, s37
    s_add_u32 s36, s36, 26214400
    s_mul_i32 s37, s30, 3072
    s_add_u32 s37, s37, 143360
    s_add_u32 m0, s29, 0
    s_add_u32 s33, s28, 0
    buffer_load_dwordx4 v2, s[4:7], s33 offen offset:0 sc1 lds
    buffer_load_dwordx4 v2, s[4:7], s33 offen offset:1024 sc1 lds
    buffer_load_dwordx4 v2, s[4:7], s33 offen offset:2048 sc1 lds
    buffer_load_dwordx4 v2, s[4:7], s33 offen offset:3072 sc1 lds
    s_add_u32 m0, s29, 4096
    s_add_u32 s33, s28, 4096
    buffer_load_dwordx4 v2, s[4:7], s33 offen offset:0 sc1 lds
    s_add_u32 m0, s29, 20480
    s_add_u32 s33, s28, 20480
    buffer_load_dwordx4 v2, s[4:7], s33 offen offset:0 sc1 lds
    buffer_load_dwordx4 v2, s[4:7], s33 offen offset:1024 sc1 lds
    buffer_load_dwordx4 v2, s[4:7], s33 offen offset:2048 sc1 lds
    buffer_load_dwordx4 v2, s[4:7], s33 offen offset:3072 sc1 lds
    s_add_u32 m0, s29, 24576
    s_add_u32 s33, s28, 24576
    buffer_load_dwordx4 v2, s[4:7], s33 offen offset:0 sc1 lds
    s_add_u32 m0, s29, 40960
    s_add_u32 s33, s28, 40960
    buffer_load_dwordx4 v2, s[4:7], s33 offen offset:0 sc1 lds
    buffer_load_dwordx4 v2, s[4:7], s33 offen offset:1024 sc1 lds
    buffer_load_dwordx4 v2, s[4:7], s33 offen offset:2048 sc1 lds
    buffer_load_dwordx4 v2, s[4:7], s33 offen offset:3072 sc1 lds
    s_add_u32 m0, s29, 45056
    s_add_u32 s33, s28, 45056
    buffer_load_dwordx4 v2, s[4:7], s33 offen offset:0 sc1 lds
    s_add_u32 m0, s29, 61440
    s_add_u32 s33, s28, 61440
    buffer_load_dwordx4 v2, s[4:7], s33 offen offset:0 sc1 lds
    buffer_load_dwordx4 v2, s[4:7], s33 offen offset:1024 sc1 lds
    buffer_load_dwordx4 v2, s[4:7], s33 offen offset:2048 sc1 lds
    buffer_load_dwordx4 v2, s[4:7], s33 offen offset:3072 sc1 lds
    s_add_u32 m0, s29, 65536
    s_add_u32 s33, s28, 65536
    buffer_load_dwordx4 v2, s[4:7], s33 offen offset:0 sc1 lds
    s_add_u32 m0, s29, 81920
    s_add_u32 s33, s28, 81920
    buffer_load_dwordx4 v2, s[4:7], s33 offen offset:0 sc1 lds
    buffer_load_dwordx4 v2, s[4:7], s33 offen offset:1024 sc1 lds
    buffer_load_dwordx4 v2, s[4:7], s33 offen offset:2048 sc1 lds
    buffer_load_dwordx4 v2, s[4:7], s33 offen offset:3072 sc1 lds
    s_add_u32 m0, s29, 86016
    s_add_u32 s33, s28, 86016
    buffer_load_dwordx4 v2, s[4:7], s33 offen offset:0 sc1 lds
    s_add_u32 m0, s29, 102400
    s_add_u32 s33, s28, 102400
    buffer_load_dwordx4 v2, s[4:7], s33 offen offset:0 sc1 lds
    buffer_load_dwordx4 v2, s[4:7], s33 offen offset:1024 sc1 lds
    buffer_load_dwordx4 v2, s[4:7], s33 offen offset:2048 sc1 lds
    buffer_load_dwordx4 v2, s[4:7], s33 offen offset:3072 sc1 lds
    s_add_u32 m0, s29, 106496
    s_add_u32 s33, s28, 106496
    buffer_load_dwordx4 v2, s[4:7], s33 offen offset:0 sc1 lds
    s_add_u32 m0, s29, 122880
    s_add_u32 s33, s28, 122880
    buffer_load_dwordx4 v2, s[4:7], s33 offen offset:0 sc1 lds
    buffer_load_dwordx4 v2, s[4:7], s33 offen offset:1024 sc1 lds
    buffer_load_dwordx4 v2, s[4:7], s33 offen offset:2048 sc1 lds
    buffer_load_dwordx4 v2, s[4:7], s33 offen offset:3072 sc1 lds
    s_add_u32 m0, s29, 126976
    s_add_u32 s33, s28, 126976
    buffer_load_dwordx4 v2, s[4:7], s33 offen offset:0 sc1 lds
    s_add_u32 m0, s37, 0
    s_nop 0
    buffer_load_dwordx4 v5, s[4:7], s36 offen sc1 lds
    s_add_u32 s36, s36, 32768
    s_add_u32 m0, s37, 1024
    s_nop 0
    buffer_load_dwordx4 v5, s[4:7], s36 offen sc1 lds
    s_add_u32 s36, s36, 32768
    s_add_u32 m0, s37, 2048
    s_nop 0
    buffer_load_dwordx4 v5, s[4:7], s36 offen sc1 lds
    s_add_u32 s36, s36, 32768
    s_mul_i32 s41, s24, 20480
    s_mul_i32 s42, s22, 160
    s_add_u32 s41, s41, s42
    s_mul_i32 s43, s30, 5376
    v_add_u32 v5, 0, v1
    v_mul_u32_u24 v6, 6554, v5
    v_lshrrev_b32 v6, 16, v6
    v_mul_u32_u24 v7, 10, v6
    v_sub_u32 v7, v5, v7
    v_mul_u32_u24 v8, 1280, v6
    v_lshl_add_u32 v8, v7, 4, v8
    v_mul_u32_u24 v168, 336, v6
    v_lshl_add_u32 v168, v7, 5, v168
    v_add_u32 v168, s43, v168
    buffer_load_dwordx4 v[156:159], v8, s[8:11], s41 offen
    v_add_u32 v5, 64, v1
    v_mul_u32_u24 v6, 6554, v5
    v_lshrrev_b32 v6, 16, v6
    v_mul_u32_u24 v7, 10, v6
    v_sub_u32 v7, v5, v7
    v_mul_u32_u24 v9, 1280, v6
    v_lshl_add_u32 v9, v7, 4, v9
    v_mul_u32_u24 v169, 336, v6
    v_lshl_add_u32 v169, v7, 5, v169
    v_add_u32 v169, s43, v169
    buffer_load_dwordx4 v[160:163], v9, s[8:11], s41 offen
    v_add_u32 v5, 128, v1
    v_mul_u32_u24 v6, 6554, v5
    v_lshrrev_b32 v6, 16, v6
    v_mul_u32_u24 v7, 10, v6
    v_sub_u32 v7, v5, v7
    v_mul_u32_u24 v10, 1280, v6
    v_lshl_add_u32 v10, v7, 4, v10
    v_mul_u32_u24 v170, 336, v6
    v_lshl_add_u32 v170, v7, 5, v170
    v_add_u32 v170, s43, v170
    v_mov_b32 v7, 0x7fff0000
    v_cmp_gt_u32 vcc, 32, v1
    s_nop 1
    v_cndmask_b32 v10, v7, v10, vcc
    buffer_load_dwordx4 v[164:167], v10, s[8:11], s41 offen
    s_cmp_lg_u32 s30, 3
    s_cbranch_scc1 L_g3j
    s_lshr_b32 s20, s21, 1
    s_lshl_b32 s20, s20, 7
    v_and_b32 v5, 15, v1
    v_lshlrev_b32 v5, 2, v5
    v_add_u32 v5, s20, v5
    s_mov_b32 s46, 29896704
    s_mov_b32 s47, 0x40000
Lpoll18:
    buffer_load_dword v12, v5, s[4:7], s46 offen sc1
    s_waitcnt vmcnt(0)
    v_cmp_ne_u32 vcc, s31, v12
    s_sub_u32 s47, s47, 1
    s_cmp_eq_u32 s47, 0
    s_cbranch_scc1 Lpoll18_x
    s_nop 2
    s_cbranch_vccnz Lpoll18
Lpoll18_x:
L_g3j:
    s_waitcnt vmcnt(0)
    s_barrier
    s_add_u32 s35, s25, 0
    buffer_load_dwordx4 a[0:3], v2, s[4:7], s35 offen offset:0 sc1
    buffer_load_dwordx4 a[4:7], v2, s[4:7], s35 offen offset:1024 sc1
    buffer_load_dwordx4 a[8:11], v2, s[4:7], s35 offen offset:2048 sc1
    buffer_load_dwordx4 a[12:15], v2, s[4:7], s35 offen offset:3072 sc1
    s_add_u32 s35, s25, 4096
    buffer_load_dwordx4 a[16:19], v2, s[4:7], s35 offen offset:0 sc1
    buffer_load_dwordx4 a[20:23], v2, s[4:7], s35 offen offset:1024 sc1
    buffer_load_dwordx4 a[24:27], v2, s[4:7], s35 offen offset:2048 sc1
    buffer_load_dwordx4 a[28:31], v2, s[4:7], s35 offen offset:3072 sc1
    s_add_u32 s35, s25, 8192
    buffer_load_dwordx4 a[32:35], v2, s[4:7], s35 offen offset:0 sc1
    buffer_load_dwordx4 a[36:39], v2, s[4:7], s35 offen offset:1024 sc1
    buffer_load_dwordx4 a[40:43], v2, s[4:7], s35 offen offset:2048 sc1
    buffer_load_dwordx4 a[44:47], v2, s[4:7], s35 offen offset:3072 sc1
    v_mov_b32 v16, 0
    v_mov_b32 v17, 0
    v_mov_b32 v18, 0
    v_mov_b32 v19, 0
    v_mov_b32 v20, 0
    v_mov_b32 v21, 0
    v_mov_b32 v22, 0
    v_mov_b32 v23, 0
    v_mov_b32 v24, 0
    v_mov_b32 v25, 0
    v_mov_b32 v26, 0
    v_mov_b32 v27, 0
    v_mov_b32 v28, 0
    v_mov_b32 v29, 0
    v_mov_b32 v30, 0
    v_mov_b32 v31, 0
    v_mov_b32 v32, 0
    v_mov_b32 v33, 0
    v_mov_b32 v34, 0
    v_mov_b32 v35, 0
    v_add_u32 v3, 0x10000, v2
    v_add_u32 v4, 0x20000, v2
    ds_read_b128 v[36:39], v2 offset:0
    ds_read_b128 v[40:43], v2 offset:1024
    ds_read_b128 v[44:47], v2 offset:2048
    ds_read_b128 v[48:51], v2 offset:3072
    ds_read_b128 v[52:55], v2 offset:4096
    ds_read_b128 v[56:59], v2 offset:5120
    ds_read_b128 v[60:63], v2 offset:6144
    ds_read_b128 v[64:67], v2 offset:7168
    ds_read_b128 v[68:71], v2 offset:8192
    ds_read_b128 v[72:75], v2 offset:9216
    s_waitcnt vmcnt(11)
    s_waitcnt lgkmcnt(9)
    v_mfma_f32_16x16x32_bf16 v[16:19], v[36:39], a[0:3], v[16:19]
    s_add_u32 s35, s25, 12288
    buffer_load_dwordx4 a[48:51], v2, s[4:7], s35 offen offset:0 sc1
    s_waitcnt lgkmcnt(8)
    v_mfma_f32_16x16x32_bf16 v[20:23], v[40:43], a[0:3], v[20:23]
    buffer_load_dwordx4 a[52:55], v2, s[4:7], s35 offen offset:1024 sc1
    s_waitcnt lgkmcnt(7)
    v_mfma_f32_16x16x32_bf16 v[24:27], v[44:47], a[0:3], v[24:27]
    s_waitcnt lgkmcnt(6)
    v_mfma_f32_16x16x32_bf16 v[28:31], v[48:51], a[0:3], v[28:31]
    buffer_load_dwordx4 a[56:59], v2, s[4:7], s35 offen offset:2048 sc1
    s_waitcnt lgkmcnt(5)
    v_mfma_f32_16x16x32_bf16 v[32:35], v[52:55], a[0:3], v[32:35]
    ds_read_b128 v[36:39], v2 offset:10240
    ds_read_b128 v[40:43], v2 offset:11264
    ds_read_b128 v[44:47], v2 offset:12288
    ds_read_b128 v[48:51], v2 offset:13312
    ds_read_b128 v[52:55], v2 offset:14336
    s_waitcnt vmcnt(13)
    s_waitcnt lgkmcnt(9)
    v_mfma_f32_16x16x32_bf16 v[16:19], v[56:59], a[4:7], v[16:19]
    buffer_load_dwordx4 a[60:63], v2, s[4:7], s35 offen offset:3072 sc1
    s_waitcnt lgkmcnt(8)
    v_mfma_f32_16x16x32_bf16 v[20:23], v[60:63], a[4:7], v[20:23]
    s_add_u32 s35, s25, 16384
    buffer_load_dwordx4 a[64:67], v2, s[4:7], s35 offen offset:0 sc1
    s_waitcnt lgkmcnt(7)
    v_mfma_f32_16x16x32_bf16 v[24:27], v[64:67], a[4:7], v[24:27]
    s_waitcnt lgkmcnt(6)
    v_mfma_f32_16x16x32_bf16 v[28:31], v[68:71], a[4:7], v[28:31]
    buffer_load_dwordx4 a[68:71], v2, s[4:7], s35 offen offset:1024 sc1
    s_waitcnt lgkmcnt(5)
    v_mfma_f32_16x16x32_bf16 v[32:35], v[72:75], a[4:7], v[32:35]
    ds_read_b128 v[56:59], v2 offset:15360
    ds_read_b128 v[60:63], v2 offset:16384
    ds_read_b128 v[64:67], v2 offset:17408
    ds_read_b128 v[68:71], v2 offset:18432
    ds_read_b128 v[72:75], v2 offset:19456
    s_waitcnt vmcnt(15)
    s_waitcnt lgkmcnt(9)
    v_mfma_f32_16x16x32_bf16 v[16:19], v[36:39], a[8:11], v[16:19]
    buffer_load_dwordx4 a[72:75], v2, s[4:7], s35 offen offset:2048 sc1
    s_waitcnt lgkmcnt(8)
    v_mfma_f32_16x16x32_bf16 v[20:23], v[40:43], a[8:11], v[20:23]
    buffer_load_dwordx4 a[76:79], v2, s[4:7], s35 offen offset:3072 sc1
    s_waitcnt lgkmcnt(7)
    v_mfma_f32_16x16x32_bf16 v[24:27], v[44:47], a[8:11], v[24:27]
    s_waitcnt lgkmcnt(6)
    v_mfma_f32_16x16x32_bf16 v[28:31], v[48:51], a[8:11], v[28:31]
    s_add_u32 s35, s25, 20480
    buffer_load_dwordx4 a[80:83], v2, s[4:7], s35 offen offset:0 sc1
    s_waitcnt lgkmcnt(5)
    v_mfma_f32_16x16x32_bf16 v[32:35], v[52:55], a[8:11], v[32:35]
    ds_read_b128 v[36:39], v2 offset:20480
    ds_read_b128 v[40:43], v2 offset:21504
    ds_read_b128 v[44:47], v2 offset:22528
    ds_read_b128 v[48:51], v2 offset:23552
    ds_read_b128 v[52:55], v2 offset:24576
    s_waitcnt vmcnt(17)
    s_waitcnt lgkmcnt(9)
    v_mfma_f32_16x16x32_bf16 v[16:19], v[56:59], a[12:15], v[16:19]
    buffer_load_dwordx4 a[84:87], v2, s[4:7], s35 offen offset:1024 sc1
    s_waitcnt lgkmcnt(8)
    v_mfma_f32_16x16x32_bf16 v[20:23], v[60:63], a[12:15], v[20:23]
    buffer_load_dwordx4 a[88:91], v2, s[4:7], s35 offen offset:2048 sc1
    s_waitcnt lgkmcnt(7)
    v_mfma_f32_16x16x32_bf16 v[24:27], v[64:67], a[12:15], v[24:27]
    s_waitcnt lgkmcnt(6)
    v_mfma_f32_16x16x32_bf16 v[28:31], v[68:71], a[12:15], v[28:31]
    buffer_load_dwordx4 a[92:95], v2, s[4:7], s35 offen offset:3072 sc1
    s_waitcnt lgkmcnt(5)
    v_mfma_f32_16x16x32_bf16 v[32:35], v[72:75], a[12:15], v[32:35]
    ds_read_b128 v[56:59], v2 offset:25600
    ds_read_b128 v[60:63], v2 offset:26624
    ds_read_b128 v[64:67], v2 offset:27648
    ds_read_b128 v[68:71], v2 offset:28672
    ds_read_b128 v[72:75], v2 offset:29696
    s_waitcnt vmcnt(19)
    s_waitcnt lgkmcnt(9)
    v_mfma_f32_16x16x32_bf16 v[16:19], v[36:39], a[16:19], v[16:19]
    s_waitcnt lgkmcnt(8)
    v_mfma_f32_16x16x32_bf16 v[20:23], v[40:43], a[16:19], v[20:23]
    s_waitcnt lgkmcnt(7)
    v_mfma_f32_16x16x32_bf16 v[24:27], v[44:47], a[16:19], v[24:27]
    s_waitcnt lgkmcnt(6)
    v_mfma_f32_16x16x32_bf16 v[28:31], v[48:51], a[16:19], v[28:31]
    s_waitcnt lgkmcnt(5)
    v_mfma_f32_16x16x32_bf16 v[32:35], v[52:55], a[16:19], v[32:35]
    ds_read_b128 v[36:39], v2 offset:30720
    ds_read_b128 v[40:43], v2 offset:31744
    ds_read_b128 v[44:47], v2 offset:32768
    ds_read_b128 v[48:51], v2 offset:33792
    ds_read_b128 v[52:55], v2 offset:34816
    s_waitcnt vmcnt(18)
    s_waitcnt lgkmcnt(9)
    v_mfma_f32_16x16x32_bf16 v[16:19], v[56:59], a[20:23], v[16:19]
    s_waitcnt lgkmcnt(8)
    v_mfma_f32_16x16x32_bf16 v[20:23], v[60:63], a[20:23], v[20:23]
    s_waitcnt lgkmcnt(7)
    v_mfma_f32_16x16x32_bf16 v[24:27], v[64:67], a[20:23], v[24:27]
    s_waitcnt lgkmcnt(6)
    v_mfma_f32_16x16x32_bf16 v[28:31], v[68:71], a[20:23], v[28:31]
    s_waitcnt lgkmcnt(5)
    v_mfma_f32_16x16x32_bf16 v[32:35], v[72:75], a[20:23], v[32:35]
    ds_read_b128 v[56:59], v2 offset:35840
    ds_read_b128 v[60:63], v2 offset:36864
    ds_read_b128 v[64:67], v2 offset:37888
    ds_read_b128 v[68:71], v2 offset:38912
    ds_read_b128 v[72:75], v2 offset:39936
    s_waitcnt vmcnt(17)
    s_waitcnt lgkmcnt(9)
    v_mfma_f32_16x16x32_bf16 v[16:19], v[36:39], a[24:27], v[16:19]
    s_waitcnt lgkmcnt(8)
    v_mfma_f32_16x16x32_bf16 v[20:23], v[40:43], a[24:27], v[20:23]
    s_waitcnt lgkmcnt(7)
    v_mfma_f32_16x16x32_bf16 v[24:27], v[44:47], a[24:27], v[24:27]
    s_waitcnt lgkmcnt(6)
    v_mfma_f32_16x16x32_bf16 v[28:31], v[48:51], a[24:27], v[28:31]
    s_waitcnt lgkmcnt(5)
    v_mfma_f32_16x16x32_bf16 v[32:35], v[52:55], a[24:27], v[32:35]
    s_barrier
    ds_read_b128 v[36:39], v2 offset:40960
    ds_read_b128 v[40:43], v2 offset:41984
    ds_read_b128 v[44:47], v2 offset:43008
    ds_read_b128 v[48:51], v2 offset:44032
    ds_read_b128 v[52:55], v2 offset:45056
    s_waitcnt vmcnt(16)
    s_waitcnt lgkmcnt(9)
    v_mfma_f32_16x16x32_bf16 v[16:19], v[56:59], a[28:31], v[16:19]
    s_add_u32 m0, s29, 0
    s_add_u32 s33, s28, 143360
    buffer_load_dwordx4 v2, s[4:7], s33 offen offset:0 sc1 lds
    s_waitcnt lgkmcnt(8)
    v_mfma_f32_16x16x32_bf16 v[20:23], v[60:63], a[28:31], v[20:23]
    buffer_load_dwordx4 v2, s[4:7], s33 offen offset:1024 sc1 lds
    s_waitcnt lgkmcnt(7)
    v_mfma_f32_16x16x32_bf16 v[24:27], v[64:67], a[28:31], v[24:27]
    s_waitcnt lgkmcnt(6)
    v_mfma_f32_16x16x32_bf16 v[28:31], v[68:71], a[28:31], v[28:31]
    buffer_load_dwordx4 v2, s[4:7], s33 offen offset:2048 sc1 lds
    s_waitcnt lgkmcnt(5)
    v_mfma_f32_16x16x32_bf16 v[32:35], v[72:75], a[28:31], v[32:35]
    ds_read_b128 v[56:59], v2 offset:46080
    ds_read_b128 v[60:63], v2 offset:47104
    ds_read_b128 v[64:67], v2 offset:48128
    ds_read_b128 v[68:71], v2 offset:49152
    ds_read_b128 v[72:75], v2 offset:50176
    s_waitcnt vmcnt(18)
    s_waitcnt lgkmcnt(9)
    v_mfma_f32_16x16x32_bf16 v[16:19], v[36:39], a[32:35], v[16:19]
    buffer_load_dwordx4 v2, s[4:7], s33 offen offset:3072 sc1 lds
    s_waitcnt lgkmcnt(8)
    v_mfma_f32_16x16x32_bf16 v[20:23], v[40:43], a[32:35], v[20:23]
    s_add_u32 m0, s29, 4096
    s_add_u32 s33, s28, 147456
    buffer_load_dwordx4 v2, s[4:7], s33 offen offset:0 sc1 lds
    s_waitcnt lgkmcnt(7)
    v_mfma_f32_16x16x32_bf16 v[24:27], v[44:47], a[32:35], v[24:27]
    s_waitcnt lgkmcnt(6)
    v_mfma_f32_16x16x32_bf16 v[28:31], v[48:51], a[32:35], v[28:31]
    s_add_u32 s35, s25, 24576
    buffer_load_dwordx4 a[96:99], v2, s[4:7], s35 offen offset:0 sc1
    s_waitcnt lgkmcnt(5)
    v_mfma_f32_16x16x32_bf16 v[32:35], v[52:55], a[32:35], v[32:35]
    ds_read_b128 v[36:39], v2 offset:51200
    ds_read_b128 v[40:43], v2 offset:52224
    ds_read_b128 v[44:47], v2 offset:53248
    ds_read_b128 v[48:51], v2 offset:54272
    ds_read_b128 v[52:55], v2 offset:55296
    s_waitcnt vmcnt(20)
    s_waitcnt lgkmcnt(9)
    v_mfma_f32_16x16x32_bf16 v[16:19], v[56:59], a[36:39], v[16:19]
    buffer_load_dwordx4 a[100:103], v2, s[4:7], s35 offen offset:1024 sc1
    s_waitcnt lgkmcnt(8)
    v_mfma_f32_16x16x32_bf16 v[20:23], v[60:63], a[36:39], v[20:23]
    buffer_load_dwordx4 a[104:107], v2, s[4:7], s35 offen offset:2048 sc1
    s_waitcnt lgkmcnt(7)
    v_mfma_f32_16x16x32_bf16 v[24:27], v[64:67], a[36:39], v[24:27]
    s_waitcnt lgkmcnt(6)
    v_mfma_f32_16x16x32_bf16 v[28:31], v[68:71], a[36:39], v[28:31]
    buffer_load_dwordx4 a[108:111], v2, s[4:7], s35 offen offset:3072 sc1
    s_waitcnt lgkmcnt(5)
    v_mfma_f32_16x16x32_bf16 v[32:35], v[72:75], a[36:39], v[32:35]
    ds_read_b128 v[56:59], v2 offset:56320
    ds_read_b128 v[60:63], v2 offset:57344
    ds_read_b128 v[64:67], v2 offset:58368
    ds_read_b128 v[68:71], v2 offset:59392
    ds_read_b128 v[72:75], v2 offset:60416
    s_waitcnt vmcnt(22)
    s_waitcnt lgkmcnt(9)
    v_mfma_f32_16x16x32_bf16 v[16:19], v[36:39], a[40:43], v[16:19]
    s_waitcnt lgkmcnt(8)
    v_mfma_f32_16x16x32_bf16 v[20:23], v[40:43], a[40:43], v[20:23]
    s_waitcnt lgkmcnt(7)
    v_mfma_f32_16x16x32_bf16 v[24:27], v[44:47], a[40:43], v[24:27]
    s_waitcnt lgkmcnt(6)
    v_mfma_f32_16x16x32_bf16 v[28:31], v[48:51], a[40:43], v[28:31]
    s_waitcnt lgkmcnt(5)
    v_mfma_f32_16x16x32_bf16 v[32:35], v[52:55], a[40:43], v[32:35]
    s_barrier
    ds_read_b128 v[36:39], v2 offset:61440
    ds_read_b128 v[40:43], v2 offset:62464
    ds_read_b128 v[44:47], v2 offset:63488
    ds_read_b128 v[48:51], v2 offset:64512
    ds_read_b128 v[52:55], v3 offset:0
    s_waitcnt vmcnt(21)
    s_waitcnt lgkmcnt(9)
    v_mfma_f32_16x16x32_bf16 v[16:19], v[56:59], a[44:47], v[16:19]
    s_add_u32 m0, s29, 20480
    s_add_u32 s33, s28, 163840
    buffer_load_dwordx4 v2, s[4:7], s33 offen offset:0 sc1 lds
    s_waitcnt lgkmcnt(8)
    v_mfma_f32_16x16x32_bf16 v[20:23], v[60:63], a[44:47], v[20:23]
    buffer_load_dwordx4 v2, s[4:7], s33 offen offset:1024 sc1 lds
    s_waitcnt lgkmcnt(7)
    v_mfma_f32_16x16x32_bf16 v[24:27], v[64:67], a[44:47], v[24:27]
    s_waitcnt lgkmcnt(6)
    v_mfma_f32_16x16x32_bf16 v[28:31], v[68:71], a[44:47], v[28:31]
    buffer_load_dwordx4 v2, s[4:7], s33 offen offset:2048 sc1 lds
    s_waitcnt lgkmcnt(5)
    v_mfma_f32_16x16x32_bf16 v[32:35], v[72:75], a[44:47], v[32:35]
    ds_read_b128 v[56:59], v3 offset:1024
    ds_read_b128 v[60:63], v3 offset:2048
    ds_read_b128 v[64:67], v3 offset:3072
    ds_read_b128 v[68:71], v3 offset:4096
    ds_read_b128 v[72:75], v3 offset:5120
    s_waitcnt vmcnt(23)
    s_waitcnt lgkmcnt(9)
    v_mfma_f32_16x16x32_bf16 v[16:19], v[36:39], a[48:51], v[16:19]
    buffer_load_dwordx4 v2, s[4:7], s33 offen offset:3072 sc1 lds
    s_waitcnt lgkmcnt(8)
    v_mfma_f32_16x16x32_bf16 v[20:23], v[40:43], a[48:51], v[20:23]
    s_add_u32 m0, s29, 24576
    s_add_u32 s33, s28, 167936
    buffer_load_dwordx4 v2, s[4:7], s33 offen offset:0 sc1 lds
    s_waitcnt lgkmcnt(7)
    v_mfma_f32_16x16x32_bf16 v[24:27], v[44:47], a[48:51], v[24:27]
    s_waitcnt lgkmcnt(6)
    v_mfma_f32_16x16x32_bf16 v[28:31], v[48:51], a[48:51], v[28:31]
    s_add_u32 s35, s25, 28672
    buffer_load_dwordx4 a[112:115], v2, s[4:7], s35 offen offset:0 sc1
    s_waitcnt lgkmcnt(5)
    v_mfma_f32_16x16x32_bf16 v[32:35], v[52:55], a[48:51], v[32:35]
    ds_read_b128 v[36:39], v3 offset:6144
    ds_read_b128 v[40:43], v3 offset:7168
    ds_read_b128 v[44:47], v3 offset:8192
    ds_read_b128 v[48:51], v3 offset:9216
    ds_read_b128 v[52:55], v3 offset:10240
    s_waitcnt vmcnt(25)
    s_waitcnt lgkmcnt(9)
    v_mfma_f32_16x16x32_bf16 v[16:19], v[56:59], a[52:55], v[16:19]
    buffer_load_dwordx4 a[116:119], v2, s[4:7], s35 offen offset:1024 sc1
    s_waitcnt lgkmcnt(8)
    v_mfma_f32_16x16x32_bf16 v[20:23], v[60:63], a[52:55], v[20:23]
    buffer_load_dwordx4 a[120:123], v2, s[4:7], s35 offen offset:2048 sc1
    s_waitcnt lgkmcnt(7)
    v_mfma_f32_16x16x32_bf16 v[24:27], v[64:67], a[52:55], v[24:27]
    s_waitcnt lgkmcnt(6)
    v_mfma_f32_16x16x32_bf16 v[28:31], v[68:71], a[52:55], v[28:31]
    buffer_load_dwordx4 a[124:127], v2, s[4:7], s35 offen offset:3072 sc1
    s_waitcnt lgkmcnt(5)
    v_mfma_f32_16x16x32_bf16 v[32:35], v[72:75], a[52:55], v[32:35]
    ds_read_b128 v[56:59], v3 offset:11264
    ds_read_b128 v[60:63], v3 offset:12288
    ds_read_b128 v[64:67], v3 offset:13312
    ds_read_b128 v[68:71], v3 offset:14336
    ds_read_b128 v[72:75], v3 offset:15360
    s_waitcnt vmcnt(27)
    s_waitcnt lgkmcnt(9)
    v_mfma_f32_16x16x32_bf16 v[16:19], v[36:39], a[56:59], v[16:19]
    s_waitcnt lgkmcnt(8)
    v_mfma_f32_16x16x32_bf16 v[20:23], v[40:43], a[56:59], v[20:23]
    s_waitcnt lgkmcnt(7)
    v_mfma_f32_16x16x32_bf16 v[24:27], v[44:47], a[56:59], v[24:27]
    s_waitcnt lgkmcnt(6)
    v_mfma_f32_16x16x32_bf16 v[28:31], v[48:51], a[56:59], v[28:31]
    s_waitcnt lgkmcnt(5)
    v_mfma_f32_16x16x32_bf16 v[32:35], v[52:55], a[56:59], v[32:35]
    s_barrier
    ds_read_b128 v[36:39], v3 offset:16384
    ds_read_b128 v[40:43], v3 offset:17408
    ds_read_b128 v[44:47], v3 offset:18432
    ds_read_b128 v[48:51], v3 offset:19456
    ds_read_b128 v[52:55], v3 offset:20480
    s_waitcnt vmcnt(26)
    s_waitcnt lgkmcnt(9)
    v_mfma_f32_16x16x32_bf16 v[16:19], v[56:59], a[60:63], v[16:19]
    s_add_u32 m0, s29, 40960
    s_add_u32 s33, s28, 184320
    buffer_load_dwordx4 v2, s[4:7], s33 offen offset:0 sc1 lds
    s_waitcnt lgkmcnt(8)
    v_mfma_f32_16x16x32_bf16 v[20:23], v[60:63], a[60:63], v[20:23]
    buffer_load_dwordx4 v2, s[4:7], s33 offen offset:1024 sc1 lds
    s_waitcnt lgkmcnt(7)
    v_mfma_f32_16x16x32_bf16 v[24:27], v[64:67], a[60:63], v[24:27]
    s_waitcnt lgkmcnt(6)
    v_mfma_f32_16x16x32_bf16 v[28:31], v[68:71], a[60:63], v[28:31]
    buffer_load_dwordx4 v2, s[4:7], s33 offen offset:2048 sc1 lds
    s_waitcnt lgkmcnt(5)
    v_mfma_f32_16x16x32_bf16 v[32:35], v[72:75], a[60:63], v[32:35]
    ds_read_b128 v[56:59], v3 offset:21504
    ds_read_b128 v[60:63], v3 offset:22528
    ds_read_b128 v[64:67], v3 offset:23552
    ds_read_b128 v[68:71], v3 offset:24576
    ds_read_b128 v[72:75], v3 offset:25600
    s_waitcnt vmcnt(28)
    s_waitcnt lgkmcnt(9)
    v_mfma_f32_16x16x32_bf16 v[16:19], v[36:39], a[64:67], v[16:19]
    buffer_load_dwordx4 v2, s[4:7], s33 offen offset:3072 sc1 lds
    s_waitcnt lgkmcnt(8)
    v_mfma_f32_16x16x32_bf16 v[20:23], v[40:43], a[64:67], v[20:23]
    s_add_u32 m0, s29, 45056
    s_add_u32 s33, s28, 188416
    buffer_load_dwordx4 v2, s[4:7], s33 offen offset:0 sc1 lds
    s_waitcnt lgkmcnt(7)
    v_mfma_f32_16x16x32_bf16 v[24:27], v[44:47], a[64:67], v[24:27]
    s_waitcnt lgkmcnt(6)
    v_mfma_f32_16x16x32_bf16 v[28:31], v[48:51], a[64:67], v[28:31]
    s_add_u32 s35, s25, 32768
    buffer_load_dwordx4 a[128:131], v2, s[4:7], s35 offen offset:0 sc1
    s_waitcnt lgkmcnt(5)
    v_mfma_f32_16x16x32_bf16 v[32:35], v[52:55], a[64:67], v[32:35]
    ds_read_b128 v[36:39], v3 offset:26624
    ds_read_b128 v[40:43], v3 offset:27648
    ds_read_b128 v[44:47], v3 offset:28672
    ds_read_b128 v[48:51], v3 offset:29696
    ds_read_b128 v[52:55], v3 offset:30720
    s_waitcnt vmcnt(30)
    s_waitcnt lgkmcnt(9)
    v_mfma_f32_16x16x32_bf16 v[16:19], v[56:59], a[68:71], v[16:19]
    buffer_load_dwordx4 a[132:135], v2, s[4:7], s35 offen offset:1024 sc1
    s_waitcnt lgkmcnt(8)
    v_mfma_f32_16x16x32_bf16 v[20:23], v[60:63], a[68:71], v[20:23]
    buffer_load_dwordx4 a[136:139], v2, s[4:7], s35 offen offset:2048 sc1
    s_waitcnt lgkmcnt(7)
    v_mfma_f32_16x16x32_bf16 v[24:27], v[64:67], a[68:71], v[24:27]
    s_waitcnt lgkmcnt(6)
    v_mfma_f32_16x16x32_bf16 v[28:31], v[68:71], a[68:71], v[28:31]
    buffer_load_dwordx4 a[140:143], v2, s[4:7], s35 offen offset:3072 sc1
    s_waitcnt lgkmcnt(5)
    v_mfma_f32_16x16x32_bf16 v[32:35], v[72:75], a[68:71], v[32:35]
    ds_read_b128 v[56:59], v3 offset:31744
    ds_read_b128 v[60:63], v3 offset:32768
    ds_read_b128 v[64:67], v3 offset:33792
    ds_read_b128 v[68:71], v3 offset:34816
    ds_read_b128 v[72:75], v3 offset:35840
    s_waitcnt vmcnt(32)
    s_waitcnt lgkmcnt(9)
    v_mfma_f32_16x16x32_bf16 v[16:19], v[36:39], a[72:75], v[16:19]
    s_waitcnt lgkmcnt(8)
    v_mfma_f32_16x16x32_bf16 v[20:23], v[40:43], a[72:75], v[20:23]
    s_waitcnt lgkmcnt(7)
    v_mfma_f32_16x16x32_bf16 v[24:27], v[44:47], a[72:75], v[24:27]
    s_waitcnt lgkmcnt(6)
    v_mfma_f32_16x16x32_bf16 v[28:31], v[48:51], a[72:75], v[28:31]
    s_waitcnt lgkmcnt(5)
    v_mfma_f32_16x16x32_bf16 v[32:35], v[52:55], a[72:75], v[32:35]
    s_barrier
    ds_read_b128 v[36:39], v3 offset:36864
    ds_read_b128 v[40:43], v3 offset:37888
    ds_read_b128 v[44:47], v3 offset:38912
    ds_read_b128 v[48:51], v3 offset:39936
    ds_read_b128 v[52:55], v3 offset:40960
    s_waitcnt vmcnt(31)
    s_waitcnt lgkmcnt(9)
    v_mfma_f32_16x16x32_bf16 v[16:19], v[56:59], a[76:79], v[16:19]
    s_add_u32 m0, s29, 61440
    s_add_u32 s33, s28, 204800
    buffer_load_dwordx4 v2, s[4:7], s33 offen offset:0 sc1 lds
    s_waitcnt lgkmcnt(8)
    v_mfma_f32_16x16x32_bf16 v[20:23], v[60:63], a[76:79], v[20:23]
    buffer_load_dwordx4 v2, s[4:7], s33 offen offset:1024 sc1 lds
    s_waitcnt lgkmcnt(7)
    v_mfma_f32_16x16x32_bf16 v[24:27], v[64:67], a[76:79], v[24:27]
    s_waitcnt lgkmcnt(6)
    v_mfma_f32_16x16x32_bf16 v[28:31], v[68:71], a[76:79], v[28:31]
    buffer_load_dwordx4 v2, s[4:7], s33 offen offset:2048 sc1 lds
    s_waitcnt lgkmcnt(5)
    v_mfma_f32_16x16x32_bf16 v[32:35], v[72:75], a[76:79], v[32:35]
    ds_read_b128 v[56:59], v3 offset:41984
    ds_read_b128 v[60:63], v3 offset:43008
    ds_read_b128 v[64:67], v3 offset:44032
    ds_read_b128 v[68:71], v3 offset:45056
    ds_read_b128 v[72:75], v3 offset:46080
    s_waitcnt vmcnt(33)
    s_waitcnt lgkmcnt(9)
    v_mfma_f32_16x16x32_bf16 v[16:19], v[36:39], a[80:83], v[16:19]
    buffer_load_dwordx4 v2, s[4:7], s33 offen offset:3072 sc1 lds
    s_waitcnt lgkmcnt(8)
    v_mfma_f32_16x16x32_bf16 v[20:23], v[40:43], a[80:83], v[20:23]
    s_add_u32 m0, s29, 65536
    s_add_u32 s33, s28, 208896
    buffer_load_dwordx4 v2, s[4:7], s33 offen offset:0 sc1 lds
    s_waitcnt lgkmcnt(7)
    v_mfma_f32_16x16x32_bf16 v[24:27], v[44:47], a[80:83], v[24:27]
    s_waitcnt lgkmcnt(6)
    v_mfma_f32_16x16x32_bf16 v[28:31], v[48:51], a[80:83], v[28:31]
    s_add_u32 s35, s25, 36864
    buffer_load_dwordx4 a[144:147], v2, s[4:7], s35 offen offset:0 sc1
    s_waitcnt lgkmcnt(5)
    v_mfma_f32_16x16x32_bf16 v[32:35], v[52:55], a[80:83], v[32:35]
    ds_read_b128 v[36:39], v3 offset:47104
    ds_read_b128 v[40:43], v3 offset:48128
    ds_read_b128 v[44:47], v3 offset:49152
    ds_read_b128 v[48:51], v3 offset:50176
    ds_read_b128 v[52:55], v3 offset:51200
    s_waitcnt vmcnt(35)
    s_waitcnt lgkmcnt(9)
    v_mfma_f32_16x16x32_bf16 v[16:19], v[56:59], a[84:87], v[16:19]
    buffer_load_dwordx4 a[148:151], v2, s[4:7], s35 offen offset:1024 sc1
    s_waitcnt lgkmcnt(8)
    v_mfma_f32_16x16x32_bf16 v[20:23], v[60:63], a[84:87], v[20:23]
    buffer_load_dwordx4 a[152:155], v2, s[4:7], s35 offen offset:2048 sc1
    s_waitcnt lgkmcnt(7)
    v_mfma_f32_16x16x32_bf16 v[24:27], v[64:67], a[84:87], v[24:27]
    s_waitcnt lgkmcnt(6)
    v_mfma_f32_16x16x32_bf16 v[28:31], v[68:71], a[84:87], v[28:31]
    buffer_load_dwordx4 a[156:159], v2, s[4:7], s35 offen offset:3072 sc1
    s_waitcnt lgkmcnt(5)
    v_mfma_f32_16x16x32_bf16 v[32:35], v[72:75], a[84:87], v[32:35]
    ds_read_b128 v[56:59], v3 offset:52224
    ds_read_b128 v[60:63], v3 offset:53248
    ds_read_b128 v[64:67], v3 offset:54272
    ds_read_b128 v[68:71], v3 offset:55296
    ds_read_b128 v[72:75], v3 offset:56320
    s_waitcnt vmcnt(37)
    s_waitcnt lgkmcnt(9)
    v_mfma_f32_16x16x32_bf16 v[16:19], v[36:39], a[88:91], v[16:19]
    s_waitcnt lgkmcnt(8)
    v_mfma_f32_16x16x32_bf16 v[20:23], v[40:43], a[88:91], v[20:23]
    s_waitcnt lgkmcnt(7)
    v_mfma_f32_16x16x32_bf16 v[24:27], v[44:47], a[88:91], v[24:27]
    s_waitcnt lgkmcnt(6)
    v_mfma_f32_16x16x32_bf16 v[28:31], v[48:51], a[88:91], v[28:31]
    s_waitcnt lgkmcnt(5)
    v_mfma_f32_16x16x32_bf16 v[32:35], v[52:55], a[88:91], v[32:35]
    s_barrier
    ds_read_b128 v[36:39], v3 offset:57344
    ds_read_b128 v[40:43], v3 offset:58368
    ds_read_b128 v[44:47], v3 offset:59392
    ds_read_b128 v[48:51], v3 offset:60416
    ds_read_b128 v[52:55], v3 offset:61440
    s_waitcnt vmcnt(36)
    s_waitcnt lgkmcnt(9)
    v_mfma_f32_16x16x32_bf16 v[16:19], v[56:59], a[92:95], v[16:19]
    s_add_u32 m0, s29, 81920
    s_add_u32 s33, s28, 225280
    buffer_load_dwordx4 v2, s[4:7], s33 offen offset:0 sc1 lds
    s_waitcnt lgkmcnt(8)
    v_mfma_f32_16x16x32_bf16 v[20:23], v[60:63], a[92:95], v[20:23]
    buffer_load_dwordx4 v2, s[4:7], s33 offen offset:1024 sc1 lds
    s_waitcnt lgkmcnt(7)
    v_mfma_f32_16x16x32_bf16 v[24:27], v[64:67], a[92:95], v[24:27]
    s_waitcnt lgkmcnt(6)
    v_mfma_f32_16x16x32_bf16 v[28:31], v[68:71], a[92:95], v[28:31]
    buffer_load_dwordx4 v2, s[4:7], s33 offen offset:2048 sc1 lds
    s_waitcnt lgkmcnt(5)
    v_mfma_f32_16x16x32_bf16 v[32:35], v[72:75], a[92:95], v[32:35]
    ds_read_b128 v[56:59], v3 offset:62464
    ds_read_b128 v[60:63], v3 offset:63488
    ds_read_b128 v[64:67], v3 offset:64512
    ds_read_b128 v[68:71], v4 offset:0
    ds_read_b128 v[72:75], v4 offset:1024
    s_waitcnt vmcnt(33)
    s_waitcnt lgkmcnt(9)
    v_mfma_f32_16x16x32_bf16 v[16:19], v[36:39], a[96:99], v[16:19]
    buffer_load_dwordx4 v2, s[4:7], s33 offen offset:3072 sc1 lds
    s_waitcnt lgkmcnt(8)
    v_mfma_f32_16x16x32_bf16 v[20:23], v[40:43], a[96:99], v[20:23]
    s_add_u32 m0, s29, 86016
    s_add_u32 s33, s28, 229376
    buffer_load_dwordx4 v2, s[4:7], s33 offen offset:0 sc1 lds
    s_waitcnt lgkmcnt(7)
    v_mfma_f32_16x16x32_bf16 v[24:27], v[44:47], a[96:99], v[24:27]
    s_waitcnt lgkmcnt(6)
    v_mfma_f32_16x16x32_bf16 v[28:31], v[48:51], a[96:99], v[28:31]
    s_add_u32 s35, s25, 40960
    buffer_load_dwordx4 a[160:163], v2, s[4:7], s35 offen offset:0 sc1
    s_waitcnt lgkmcnt(5)
    v_mfma_f32_16x16x32_bf16 v[32:35], v[52:55], a[96:99], v[32:35]
    ds_read_b128 v[36:39], v4 offset:2048
    ds_read_b128 v[40:43], v4 offset:3072
    ds_read_b128 v[44:47], v4 offset:4096
    ds_read_b128 v[48:51], v4 offset:5120
    ds_read_b128 v[52:55], v4 offset:6144
    s_waitcnt vmcnt(35)
    s_waitcnt lgkmcnt(9)
    v_mfma_f32_16x16x32_bf16 v[16:19], v[56:59], a[100:103], v[16:19]
    buffer_load_dwordx4 a[164:167], v2, s[4:7], s35 offen offset:1024 sc1
    s_waitcnt lgkmcnt(8)
    v_mfma_f32_16x16x32_bf16 v[20:23], v[60:63], a[100:103], v[20:23]
    buffer_load_dwordx4 a[168:171], v2, s[4:7], s35 offen offset:2048 sc1
    s_waitcnt lgkmcnt(7)
    v_mfma_f32_16x16x32_bf16 v[24:27], v[64:67], a[100:103], v[24:27]
    s_waitcnt lgkmcnt(6)
    v_mfma_f32_16x16x32_bf16 v[28:31], v[68:71], a[100:103], v[28:31]
    buffer_load_dwordx4 a[172:175], v2, s[4:7], s35 offen offset:3072 sc1
    s_waitcnt lgkmcnt(5)
    v_mfma_f32_16x16x32_bf16 v[32:35], v[72:75], a[100:103], v[32:35]
    ds_read_b128 v[56:59], v4 offset:7168
    ds_read_b128 v[60:63], v4 offset:8192
    ds_read_b128 v[64:67], v4 offset:9216
    ds_read_b128 v[68:71], v4 offset:10240
    ds_read_b128 v[72:75], v4 offset:11264
    s_waitcnt vmcnt(37)
    s_waitcnt lgkmcnt(9)
    v_mfma_f32_16x16x32_bf16 v[16:19], v[36:39], a[104:107], v[16:19]
    s_add_u32 s35, s25, 45056
    buffer_load_dwordx4 a[176:179], v2, s[4:7], s35 offen offset:0 sc1
    s_waitcnt lgkmcnt(8)
    v_mfma_f32_16x16x32_bf16 v[20:23], v[40:43], a[104:107], v[20:23]
    buffer_load_dwordx4 a[180:183], v2, s[4:7], s35 offen offset:1024 sc1
    s_waitcnt lgkmcnt(7)
    v_mfma_f32_16x16x32_bf16 v[24:27], v[44:47], a[104:107], v[24:27]
    s_waitcnt lgkmcnt(6)
    v_mfma_f32_16x16x32_bf16 v[28:31], v[48:51], a[104:107], v[28:31]
    buffer_load_dwordx4 a[184:187], v2, s[4:7], s35 offen offset:2048 sc1
    s_waitcnt lgkmcnt(5)
    v_mfma_f32_16x16x32_bf16 v[32:35], v[52:55], a[104:107], v[32:35]
    s_barrier
    ds_read_b128 v[36:39], v2 offset:0
    ds_read_b128 v[40:43], v2 offset:1024
    ds_read_b128 v[44:47], v2 offset:2048
    ds_read_b128 v[48:51], v2 offset:3072
    ds_read_b128 v[52:55], v2 offset:4096
    s_waitcnt vmcnt(39)
    s_waitcnt lgkmcnt(9)
    v_mfma_f32_16x16x32_bf16 v[16:19], v[56:59], a[108:111], v[16:19]
    buffer_load_dwordx4 a[188:191], v2, s[4:7], s35 offen offset:3072 sc1
    s_waitcnt lgkmcnt(8)
    v_mfma_f32_16x16x32_bf16 v[20:23], v[60:63], a[108:111], v[20:23]
    s_waitcnt lgkmcnt(7)
    v_mfma_f32_16x16x32_bf16 v[24:27], v[64:67], a[108:111], v[24:27]
    s_waitcnt lgkmcnt(6)
    v_mfma_f32_16x16x32_bf16 v[28:31], v[68:71], a[108:111], v[28:31]
    s_waitcnt lgkmcnt(5)
    v_mfma_f32_16x16x32_bf16 v[32:35], v[72:75], a[108:111], v[32:35]
    ds_read_b128 v[56:59], v2 offset:5120
    ds_read_b128 v[60:63], v2 offset:6144
    ds_read_b128 v[64:67], v2 offset:7168
    ds_read_b128 v[68:71], v2 offset:8192
    ds_read_b128 v[72:75], v2 offset:9216
    s_waitcnt vmcnt(34)
    s_waitcnt lgkmcnt(9)
    v_mfma_f32_16x16x32_bf16 v[16:19], v[36:39], a[112:115], v[16:19]
    s_waitcnt lgkmcnt(8)
    v_mfma_f32_16x16x32_bf16 v[20:23], v[40:43], a[112:115], v[20:23]
    s_waitcnt lgkmcnt(7)
    v_mfma_f32_16x16x32_bf16 v[24:27], v[44:47], a[112:115], v[24:27]
    s_waitcnt lgkmcnt(6)
    v_mfma_f32_16x16x32_bf16 v[28:31], v[48:51], a[112:115], v[28:31]
    s_waitcnt lgkmcnt(5)
    v_mfma_f32_16x16x32_bf16 v[32:35], v[52:55], a[112:115], v[32:35]
    ds_read_b128 v[36:39], v2 offset:10240
    ds_read_b128 v[40:43], v2 offset:11264
    ds_read_b128 v[44:47], v2 offset:12288
    ds_read_b128 v[48:51], v2 offset:13312
    ds_read_b128 v[52:55], v2 offset:14336
    s_waitcnt vmcnt(33)
    s_waitcnt lgkmcnt(9)
    v_mfma_f32_16x16x32_bf16 v[16:19], v[56:59], a[116:119], v[16:19]
    s_waitcnt lgkmcnt(8)
    v_mfma_f32_16x16x32_bf16 v[20:23], v[60:63], a[116:119], v[20:23]
    s_waitcnt lgkmcnt(7)
    v_mfma_f32_16x16x32_bf16 v[24:27], v[64:67], a[116:119], v[24:27]
    s_waitcnt lgkmcnt(6)
    v_mfma_f32_16x16x32_bf16 v[28:31], v[68:71], a[116:119], v[28:31]
    s_waitcnt lgkmcnt(5)
    v_mfma_f32_16x16x32_bf16 v[32:35], v[72:75], a[116:119], v[32:35]
    ds_read_b128 v[56:59], v2 offset:15360
    ds_read_b128 v[60:63], v2 offset:16384
    ds_read_b128 v[64:67], v2 offset:17408
    ds_read_b128 v[68:71], v2 offset:18432
    ds_read_b128 v[72:75], v2 offset:19456
    s_waitcnt vmcnt(32)
    s_waitcnt lgkmcnt(9)
    v_mfma_f32_16x16x32_bf16 v[16:19], v[36:39], a[120:123], v[16:19]
    s_waitcnt lgkmcnt(8)
    v_mfma_f32_16x16x32_bf16 v[20:23], v[40:43], a[120:123], v[20:23]
    s_waitcnt lgkmcnt(7)
    v_mfma_f32_16x16x32_bf16 v[24:27], v[44:47], a[120:123], v[24:27]
    s_waitcnt lgkmcnt(6)
    v_mfma_f32_16x16x32_bf16 v[28:31], v[48:51], a[120:123], v[28:31]
    s_waitcnt lgkmcnt(5)
    v_mfma_f32_16x16x32_bf16 v[32:35], v[52:55], a[120:123], v[32:35]
    s_barrier
    ds_read_b128 v[36:39], v2 offset:20480
    ds_read_b128 v[40:43], v2 offset:21504
    ds_read_b128 v[44:47], v2 offset:22528
    ds_read_b128 v[48:51], v2 offset:23552
    ds_read_b128 v[52:55], v2 offset:24576
    s_waitcnt vmcnt(31)
    s_waitcnt lgkmcnt(9)
    v_mfma_f32_16x16x32_bf16 v[16:19], v[56:59], a[124:127], v[16:19]
    s_waitcnt lgkmcnt(8)
    v_mfma_f32_16x16x32_bf16 v[20:23], v[60:63], a[124:127], v[20:23]
    s_waitcnt lgkmcnt(7)
    v_mfma_f32_16x16x32_bf16 v[24:27], v[64:67], a[124:127], v[24:27]
    s_waitcnt lgkmcnt(6)
    v_mfma_f32_16x16x32_bf16 v[28:31], v[68:71], a[124:127], v[28:31]
    s_waitcnt lgkmcnt(5)
    v_mfma_f32_16x16x32_bf16 v[32:35], v[72:75], a[124:127], v[32:35]
    ds_read_b128 v[56:59], v2 offset:25600
    ds_read_b128 v[60:63], v2 offset:26624
    ds_read_b128 v[64:67], v2 offset:27648
    ds_read_b128 v[68:71], v2 offset:28672
    ds_read_b128 v[72:75], v2 offset:29696
    s_waitcnt vmcnt(25)
    s_waitcnt lgkmcnt(9)
    v_mfma_f32_16x16x32_bf16 v[16:19], v[36:39], a[128:131], v[16:19]
    s_waitcnt lgkmcnt(8)
    v_mfma_f32_16x16x32_bf16 v[20:23], v[40:43], a[128:131], v[20:23]
    s_waitcnt lgkmcnt(7)
    v_mfma_f32_16x16x32_bf16 v[24:27], v[44:47], a[128:131], v[24:27]
    s_waitcnt lgkmcnt(6)
    v_mfma_f32_16x16x32_bf16 v[28:31], v[48:51], a[128:131], v[28:31]
    s_waitcnt lgkmcnt(5)
    v_mfma_f32_16x16x32_bf16 v[32:35], v[52:55], a[128:131], v[32:35]
    ds_read_b128 v[36:39], v2 offset:30720
    ds_read_b128 v[40:43], v2 offset:31744
    ds_read_b128 v[44:47], v2 offset:32768
    ds_read_b128 v[48:51], v2 offset:33792
    ds_read_b128 v[52:55], v2 offset:34816
    s_waitcnt vmcnt(24)
    s_waitcnt lgkmcnt(9)
    v_mfma_f32_16x16x32_bf16 v[16:19], v[56:59], a[132:135], v[16:19]
    s_waitcnt lgkmcnt(8)
    v_mfma_f32_16x16x32_bf16 v[20:23], v[60:63], a[132:135], v[20:23]
    s_waitcnt lgkmcnt(7)
    v_mfma_f32_16x16x32_bf16 v[24:27], v[64:67], a[132:135], v[24:27]
    s_waitcnt lgkmcnt(6)
    v_mfma_f32_16x16x32_bf16 v[28:31], v[68:71], a[132:135], v[28:31]
    s_waitcnt lgkmcnt(5)
    v_mfma_f32_16x16x32_bf16 v[32:35], v[72:75], a[132:135], v[32:35]
    ds_read_b128 v[56:59], v2 offset:35840
    ds_read_b128 v[60:63], v2 offset:36864
    ds_read_b128 v[64:67], v2 offset:37888
    ds_read_b128 v[68:71], v2 offset:38912
    ds_read_b128 v[72:75], v2 offset:39936
    s_waitcnt vmcnt(23)
    s_waitcnt lgkmcnt(9)
    v_mfma_f32_16x16x32_bf16 v[16:19], v[36:39], a[136:139], v[16:19]
    s_waitcnt lgkmcnt(8)
    v_mfma_f32_16x16x32_bf16 v[20:23], v[40:43], a[136:139], v[20:23]
    s_waitcnt lgkmcnt(7)
    v_mfma_f32_16x16x32_bf16 v[24:27], v[44:47], a[136:139], v[24:27]
    s_waitcnt lgkmcnt(6)
    v_mfma_f32_16x16x32_bf16 v[28:31], v[48:51], a[136:139], v[28:31]
    s_waitcnt lgkmcnt(5)
    v_mfma_f32_16x16x32_bf16 v[32:35], v[52:55], a[136:139], v[32:35]
    s_barrier
    ds_read_b128 v[36:39], v2 offset:40960
    ds_read_b128 v[40:43], v2 offset:41984
    ds_read_b128 v[44:47], v2 offset:43008
    ds_read_b128 v[48:51], v2 offset:44032
    ds_read_b128 v[52:55], v2 offset:45056
    s_waitcnt vmcnt(22)
    s_waitcnt lgkmcnt(9)
    v_mfma_f32_16x16x32_bf16 v[16:19], v[56:59], a[140:143], v[16:19]
    s_waitcnt lgkmcnt(8)
    v_mfma_f32_16x16x32_bf16 v[20:23], v[60:63], a[140:143], v[20:23]
    s_waitcnt lgkmcnt(7)
    v_mfma_f32_16x16x32_bf16 v[24:27], v[64:67], a[140:143], v[24:27]
    s_waitcnt lgkmcnt(6)
    v_mfma_f32_16x16x32_bf16 v[28:31], v[68:71], a[140:143], v[28:31]
    s_waitcnt lgkmcnt(5)
    v_mfma_f32_16x16x32_bf16 v[32:35], v[72:75], a[140:143], v[32:35]
    ds_read_b128 v[56:59], v2 offset:46080
    ds_read_b128 v[60:63], v2 offset:47104
    ds_read_b128 v[64:67], v2 offset:48128
    ds_read_b128 v[68:71], v2 offset:49152
    ds_read_b128 v[72:75], v2 offset:50176
    s_waitcnt vmcnt(16)
    s_waitcnt lgkmcnt(9)
    v_mfma_f32_16x16x32_bf16 v[16:19], v[36:39], a[144:147], v[16:19]
    s_waitcnt lgkmcnt(8)
    v_mfma_f32_16x16x32_bf16 v[20:23], v[40:43], a[144:147], v[20:23]
    s_waitcnt lgkmcnt(7)
    v_mfma_f32_16x16x32_bf16 v[24:27], v[44:47], a[144:147], v[24:27]
    s_waitcnt lgkmcnt(6)
    v_mfma_f32_16x16x32_bf16 v[28:31], v[48:51], a[144:147], v[28:31]
    s_waitcnt lgkmcnt(5)
    v_mfma_f32_16x16x32_bf16 v[32:35], v[52:55], a[144:147], v[32:35]
    ds_read_b128 v[36:39], v2 offset:51200
    ds_read_b128 v[40:43], v2 offset:52224
    ds_read_b128 v[44:47], v2 offset:53248
    ds_read_b128 v[48:51], v2 offset:54272
    ds_read_b128 v[52:55], v2 offset:55296
    s_waitcnt vmcnt(15)
    s_waitcnt lgkmcnt(9)
    v_mfma_f32_16x16x32_bf16 v[16:19], v[56:59], a[148:151], v[16:19]
    s_waitcnt lgkmcnt(8)
    v_mfma_f32_16x16x32_bf16 v[20:23], v[60:63], a[148:151], v[20:23]
    s_waitcnt lgkmcnt(7)
    v_mfma_f32_16x16x32_bf16 v[24:27], v[64:67], a[148:151], v[24:27]
    s_waitcnt lgkmcnt(6)
    v_mfma_f32_16x16x32_bf16 v[28:31], v[68:71], a[148:151], v[28:31]
    s_waitcnt lgkmcnt(5)
    v_mfma_f32_16x16x32_bf16 v[32:35], v[72:75], a[148:151], v[32:35]
    ds_read_b128 v[56:59], v2 offset:56320
    ds_read_b128 v[60:63], v2 offset:57344
    ds_read_b128 v[64:67], v2 offset:58368
    ds_read_b128 v[68:71], v2 offset:59392
    ds_read_b128 v[72:75], v2 offset:60416
    s_waitcnt vmcnt(14)
    s_waitcnt lgkmcnt(9)
    v_mfma_f32_16x16x32_bf16 v[16:19], v[36:39], a[152:155], v[16:19]
    s_waitcnt lgkmcnt(8)
    v_mfma_f32_16x16x32_bf16 v[20:23], v[40:43], a[152:155], v[20:23]
    s_waitcnt lgkmcnt(7)
    v_mfma_f32_16x16x32_bf16 v[24:27], v[44:47], a[152:155], v[24:27]
    s_waitcnt lgkmcnt(6)
    v_mfma_f32_16x16x32_bf16 v[28:31], v[48:51], a[152:155], v[28:31]
    s_waitcnt lgkmcnt(5)
    v_mfma_f32_16x16x32_bf16 v[32:35], v[52:55], a[152:155], v[32:35]
    s_barrier
    ds_read_b128 v[36:39], v2 offset:61440
    ds_read_b128 v[40:43], v2 offset:62464
    ds_read_b128 v[44:47], v2 offset:63488
    ds_read_b128 v[48:51], v2 offset:64512
    ds_read_b128 v[52:55], v3 offset:0
    s_waitcnt vmcnt(13)
    s_waitcnt lgkmcnt(9)
    v_mfma_f32_16x16x32_bf16 v[16:19], v[56:59], a[156:159], v[16:19]
    s_waitcnt lgkmcnt(8)
    v_mfma_f32_16x16x32_bf16 v[20:23], v[60:63], a[156:159], v[20:23]
    s_waitcnt lgkmcnt(7)
    v_mfma_f32_16x16x32_bf16 v[24:27], v[64:67], a[156:159], v[24:27]
    s_waitcnt lgkmcnt(6)
    v_mfma_f32_16x16x32_bf16 v[28:31], v[68:71], a[156:159], v[28:31]
    s_waitcnt lgkmcnt(5)
    v_mfma_f32_16x16x32_bf16 v[32:35], v[72:75], a[156:159], v[32:35]
    ds_read_b128 v[56:59], v3 offset:1024
    ds_read_b128 v[60:63], v3 offset:2048
    ds_read_b128 v[64:67], v3 offset:3072
    ds_read_b128 v[68:71], v3 offset:4096
    ds_read_b128 v[72:75], v3 offset:5120
    s_waitcnt vmcnt(7)
    s_waitcnt lgkmcnt(9)
    v_mfma_f32_16x16x32_bf16 v[16:19], v[36:39], a[160:163], v[16:19]
    s_waitcnt lgkmcnt(8)
    v_mfma_f32_16x16x32_bf16 v[20:23], v[40:43], a[160:163], v[20:23]
    s_waitcnt lgkmcnt(7)
    v_mfma_f32_16x16x32_bf16 v[24:27], v[44:47], a[160:163], v[24:27]
    s_waitcnt lgkmcnt(6)
    v_mfma_f32_16x16x32_bf16 v[28:31], v[48:51], a[160:163], v[28:31]
    s_waitcnt lgkmcnt(5)
    v_mfma_f32_16x16x32_bf16 v[32:35], v[52:55], a[160:163], v[32:35]
    ds_read_b128 v[36:39], v3 offset:6144
    ds_read_b128 v[40:43], v3 offset:7168
    ds_read_b128 v[44:47], v3 offset:8192
    ds_read_b128 v[48:51], v3 offset:9216
    ds_read_b128 v[52:55], v3 offset:10240
    s_waitcnt vmcnt(6)
    s_waitcnt lgkmcnt(9)
    v_mfma_f32_16x16x32_bf16 v[16:19], v[56:59], a[164:167], v[16:19]
    s_waitcnt lgkmcnt(8)
    v_mfma_f32_16x16x32_bf16 v[20:23], v[60:63], a[164:167], v[20:23]
    s_waitcnt lgkmcnt(7)
    v_mfma_f32_16x16x32_bf16 v[24:27], v[64:67], a[164:167], v[24:27]
    s_waitcnt lgkmcnt(6)
    v_mfma_f32_16x16x32_bf16 v[28:31], v[68:71], a[164:167], v[28:31]
    s_waitcnt lgkmcnt(5)
    v_mfma_f32_16x16x32_bf16 v[32:35], v[72:75], a[164:167], v[32:35]
    ds_read_b128 v[56:59], v3 offset:11264
    ds_read_b128 v[60:63], v3 offset:12288
    ds_read_b128 v[64:67], v3 offset:13312
    ds_read_b128 v[68:71], v3 offset:14336
    ds_read_b128 v[72:75], v3 offset:15360
    s_waitcnt vmcnt(5)
    s_waitcnt lgkmcnt(9)
    v_mfma_f32_16x16x32_bf16 v[16:19], v[36:39], a[168:171], v[16:19]
    s_waitcnt lgkmcnt(8)
    v_mfma_f32_16x16x32_bf16 v[20:23], v[40:43], a[168:171], v[20:23]
    s_waitcnt lgkmcnt(7)
    v_mfma_f32_16x16x32_bf16 v[24:27], v[44:47], a[168:171], v[24:27]
    s_waitcnt lgkmcnt(6)
    v_mfma_f32_16x16x32_bf16 v[28:31], v[48:51], a[168:171], v[28:31]
    s_waitcnt lgkmcnt(5)
    v_mfma_f32_16x16x32_bf16 v[32:35], v[52:55], a[168:171], v[32:35]
    s_barrier
    ds_read_b128 v[36:39], v3 offset:16384
    ds_read_b128 v[40:43], v3 offset:17408
    ds_read_b128 v[44:47], v3 offset:18432
    ds_read_b128 v[48:51], v3 offset:19456
    ds_read_b128 v[52:55], v3 offset:20480
    s_waitcnt vmcnt(4)
    s_waitcnt lgkmcnt(9)
    v_mfma_f32_16x16x32_bf16 v[16:19], v[56:59], a[172:175], v[16:19]
    s_waitcnt lgkmcnt(8)
    v_mfma_f32_16x16x32_bf16 v[20:23], v[60:63], a[172:175], v[20:23]
    s_waitcnt lgkmcnt(7)
    v_mfma_f32_16x16x32_bf16 v[24:27], v[64:67], a[172:175], v[24:27]
    s_waitcnt lgkmcnt(6)
    v_mfma_f32_16x16x32_bf16 v[28:31], v[68:71], a[172:175], v[28:31]
    s_waitcnt lgkmcnt(5)
    v_mfma_f32_16x16x32_bf16 v[32:35], v[72:75], a[172:175], v[32:35]
    ds_read_b128 v[56:59], v3 offset:21504
    ds_read_b128 v[60:63], v3 offset:22528
    ds_read_b128 v[64:67], v3 offset:23552
    ds_read_b128 v[68:71], v3 offset:24576
    ds_read_b128 v[72:75], v3 offset:25600
    s_waitcnt vmcnt(3)
    s_waitcnt lgkmcnt(9)
    v_mfma_f32_16x16x32_bf16 v[16:19], v[36:39], a[176:179], v[16:19]
    s_waitcnt lgkmcnt(8)
    v_mfma_f32_16x16x32_bf16 v[20:23], v[40:43], a[176:179], v[20:23]
    s_waitcnt lgkmcnt(7)
    v_mfma_f32_16x16x32_bf16 v[24:27], v[44:47], a[176:179], v[24:27]
    s_waitcnt lgkmcnt(6)
    v_mfma_f32_16x16x32_bf16 v[28:31], v[48:51], a[176:179], v[28:31]
    s_waitcnt lgkmcnt(5)
    v_mfma_f32_16x16x32_bf16 v[32:35], v[52:55], a[176:179], v[32:35]
    ds_read_b128 v[36:39], v3 offset:26624
    ds_read_b128 v[40:43], v3 offset:27648
    ds_read_b128 v[44:47], v3 offset:28672
    ds_read_b128 v[48:51], v3 offset:29696
    ds_read_b128 v[52:55], v3 offset:30720
    s_waitcnt vmcnt(2)
    s_waitcnt lgkmcnt(9)
    v_mfma_f32_16x16x32_bf16 v[16:19], v[56:59], a[180:183], v[16:19]
    s_waitcnt lgkmcnt(8)
    v_mfma_f32_16x16x32_bf16 v[20:23], v[60:63], a[180:183], v[20:23]
    s_waitcnt lgkmcnt(7)
    v_mfma_f32_16x16x32_bf16 v[24:27], v[64:67], a[180:183], v[24:27]
    s_waitcnt lgkmcnt(6)
    v_mfma_f32_16x16x32_bf16 v[28:31], v[68:71], a[180:183], v[28:31]
    s_waitcnt lgkmcnt(5)
    v_mfma_f32_16x16x32_bf16 v[32:35], v[72:75], a[180:183], v[32:35]
    ds_read_b128 v[56:59], v3 offset:31744
    ds_read_b128 v[60:63], v3 offset:32768
    ds_read_b128 v[64:67], v3 offset:33792
    ds_read_b128 v[68:71], v3 offset:34816
    ds_read_b128 v[72:75], v3 offset:35840
    s_waitcnt vmcnt(1)
    s_waitcnt lgkmcnt(9)
    v_mfma_f32_16x16x32_bf16 v[16:19], v[36:39], a[184:187], v[16:19]
    s_waitcnt lgkmcnt(8)
    v_mfma_f32_16x16x32_bf16 v[20:23], v[40:43], a[184:187], v[20:23]
    s_waitcnt lgkmcnt(7)
    v_mfma_f32_16x16x32_bf16 v[24:27], v[44:47], a[184:187], v[24:27]
    s_waitcnt lgkmcnt(6)
    v_mfma_f32_16x16x32_bf16 v[28:31], v[48:51], a[184:187], v[28:31]
    s_waitcnt lgkmcnt(5)
    v_mfma_f32_16x16x32_bf16 v[32:35], v[52:55], a[184:187], v[32:35]
    s_waitcnt vmcnt(0)
    s_waitcnt lgkmcnt(4)
    v_mfma_f32_16x16x32_bf16 v[16:19], v[56:59], a[188:191], v[16:19]
    s_waitcnt lgkmcnt(3)
    v_mfma_f32_16x16x32_bf16 v[20:23], v[60:63], a[188:191], v[20:23]
    s_waitcnt lgkmcnt(2)
    v_mfma_f32_16x16x32_bf16 v[24:27], v[64:67], a[188:191], v[24:27]
    s_waitcnt lgkmcnt(1)
    v_mfma_f32_16x16x32_bf16 v[28:31], v[68:71], a[188:191], v[28:31]
    s_waitcnt lgkmcnt(0)
    v_mfma_f32_16x16x32_bf16 v[32:35], v[72:75], a[188:191], v[32:35]
    s_nop 7
    v_lshrrev_b32 v5, 2, v1
    v_and_b32 v6, 3, v1
    v_lshlrev_b32 v5, 7, v5
    v_lshl_add_u32 v5, v6, 3, v5
    s_lshl_b32 s36, s30, 5
    s_add_u32 s36, s36, 143360
    v_add_u32 v5, s36, v5
    ds_read_b64_tr_b16 v[40:41], v5 offset:0
    ds_read_b64_tr_b16 v[42:43], v5 offset:2048
    ds_read_b64_tr_b16 v[44:45], v5 offset:4096
    ds_read_b64_tr_b16 v[46:47], v5 offset:6144
    ds_read_b64_tr_b16 v[48:49], v5 offset:8192
    v_lshlrev_b32 v76, 16, v136
    v_and_b32 v77, 0xffff0000, v136
    v_lshlrev_b32 v78, 16, v137
    v_and_b32 v79, 0xffff0000, v137
    v_lshlrev_b32 v80, 16, v138
    v_and_b32 v81, 0xffff0000, v138
    v_lshlrev_b32 v82, 16, v139
    v_and_b32 v83, 0xffff0000, v139
    v_lshlrev_b32 v84, 16, v140
    v_and_b32 v85, 0xffff0000, v140
    v_lshlrev_b32 v86, 16, v141
    v_and_b32 v87, 0xffff0000, v141
    v_lshlrev_b32 v88, 16, v142
    v_and_b32 v89, 0xffff0000, v142
    v_lshlrev_b32 v90, 16, v143
    v_and_b32 v91, 0xffff0000, v143
    v_lshlrev_b32 v92, 16, v144
    v_and_b32 v93, 0xffff0000, v144
    v_lshlrev_b32 v94, 16, v145
    v_and_b32 v95, 0xffff0000, v145
    v_lshlrev_b32 v96, 16, v146
    v_and_b32 v97, 0xffff0000, v146
    v_lshlrev_b32 v98, 16, v147
    v_and_b32 v99, 0xffff0000, v147
    v_lshlrev_b32 v100, 16, v148
    v_and_b32 v101, 0xffff0000, v148
    v_lshlrev_b32 v102, 16, v149
    v_and_b32 v103, 0xffff0000, v149
    v_lshlrev_b32 v104, 16, v150
    v_and_b32 v105, 0xffff0000, v150
    v_lshlrev_b32 v106, 16, v151
    v_and_b32 v107, 0xffff0000, v151
    v_lshlrev_b32 v108, 16, v152
    v_and_b32 v109, 0xffff0000, v152
    v_lshlrev_b32 v110, 16, v153
    v_and_b32 v111, 0xffff0000, v153
    v_lshlrev_b32 v112, 16, v154
    v_and_b32 v113, 0xffff0000, v154
    v_lshlrev_b32 v114, 16, v155
    v_and_b32 v115, 0xffff0000, v155
    s_waitcnt lgkmcnt(0)
    v_lshlrev_b32 v116, 16, v40
    v_and_b32 v117, 0xffff0000, v40
    v_lshlrev_b32 v118, 16, v41
    v_and_b32 v119, 0xffff0000, v41
    v_lshlrev_b32 v120, 16, v42
    v_and_b32 v121, 0xffff0000, v42
    v_lshlrev_b32 v122, 16, v43
    v_and_b32 v123, 0xffff0000, v43
    v_lshlrev_b32 v124, 16, v44
    v_and_b32 v125, 0xffff0000, v44
    v_lshlrev_b32 v126, 16, v45
    v_and_b32 v127, 0xffff0000, v45
    v_lshlrev_b32 v128, 16, v46
    v_and_b32 v129, 0xffff0000, v46
    v_lshlrev_b32 v130, 16, v47
    v_and_b32 v131, 0xffff0000, v47
    v_lshlrev_b32 v132, 16, v48
    v_and_b32 v133, 0xffff0000, v48
    v_lshlrev_b32 v134, 16, v49
    v_and_b32 v135, 0xffff0000, v49
    v_add_f32 v16, v16, v96
    v_fmac_f32 v16, v76, v116
    v_add_f32 v17, v17, v97
    v_fmac_f32 v17, v77, v117
    v_add_f32 v18, v18, v98
    v_fmac_f32 v18, v78, v118
    v_add_f32 v19, v19, v99
    v_fmac_f32 v19, v79, v119
    v_add_f32 v20, v20, v100
    v_fmac_f32 v20, v80, v120
    v_add_f32 v21, v21, v101
    v_fmac_f32 v21, v81, v121
    v_add_f32 v22, v22, v102
    v_fmac_f32 v22, v82, v122
    v_add_f32 v23, v23, v103
    v_fmac_f32 v23, v83, v123
    v_add_f32 v24, v24, v104
    v_fmac_f32 v24, v84, v124
    v_add_f32 v25, v25, v105
    v_fmac_f32 v25, v85, v125
    v_add_f32 v26, v26, v106
    v_fmac_f32 v26, v86, v126
    v_add_f32 v27, v27, v107
    v_fmac_f32 v27, v87, v127
    v_add_f32 v28, v28, v108
    v_fmac_f32 v28, v88, v128
    v_add_f32 v29, v29, v109
    v_fmac_f32 v29, v89, v129
    v_add_f32 v30, v30, v110
    v_fmac_f32 v30, v90, v130
    v_add_f32 v31, v31, v111
    v_fmac_f32 v31, v91, v131
    v_add_f32 v32, v32, v112
    v_fmac_f32 v32, v92, v132
    v_add_f32 v33, v33, v113
    v_fmac_f32 v33, v93, v133
    v_add_f32 v34, v34, v114
    v_fmac_f32 v34, v94, v134
    v_add_f32 v35, v35, v115
    v_fmac_f32 v35, v95, v135
    v_and_b32 v5, 15, v1
    v_lshrrev_b32 v6, 4, v1
    v_mul_u32_u24 v5, 336, v5
    v_lshl_add_u32 v5, v6, 4, v5
    v_add_u32 v5, s43, v5
    ds_write_b128 v5, v[16:19] offset:0
    ds_write_b128 v5, v[20:23] offset:64
    ds_write_b128 v5, v[24:27] offset:128
    ds_write_b128 v5, v[28:31] offset:192
    ds_write_b128 v5, v[32:35] offset:256
    v_lshlrev_b32 v76, 16, v156
    v_and_b32 v77, 0xffff0000, v156
    v_lshlrev_b32 v78, 16, v157
    v_and_b32 v79, 0xffff0000, v157
    v_lshlrev_b32 v80, 16, v158
    v_and_b32 v81, 0xffff0000, v158
    v_lshlrev_b32 v82, 16, v159
    v_and_b32 v83, 0xffff0000, v159
    v_lshlrev_b32 v84, 16, v160
    v_and_b32 v85, 0xffff0000, v160
    v_lshlrev_b32 v86, 16, v161
    v_and_b32 v87, 0xffff0000, v161
    v_lshlrev_b32 v88, 16, v162
    v_and_b32 v89, 0xffff0000, v162
    v_lshlrev_b32 v90, 16, v163
    v_and_b32 v91, 0xffff0000, v163
    v_lshlrev_b32 v92, 16, v164
    v_and_b32 v93, 0xffff0000, v164
    v_lshlrev_b32 v94, 16, v165
    v_and_b32 v95, 0xffff0000, v165
    v_lshlrev_b32 v96, 16, v166
    v_and_b32 v97, 0xffff0000, v166
    v_lshlrev_b32 v98, 16, v167
    v_and_b32 v99, 0xffff0000, v167
    s_waitcnt lgkmcnt(0)
    ds_read_b128 v[40:43], v168
    ds_read_b128 v[44:47], v168 offset:16
    ds_read_b128 v[48:51], v169
    ds_read_b128 v[52:55], v169 offset:16
    ds_read_b128 v[56:59], v170
    ds_read_b128 v[60:63], v170 offset:16
    s_waitcnt lgkmcnt(4)
    v_add_f32 v40, v40, v76
    v_add_f32 v41, v41, v77
    v_add_f32 v42, v42, v78
    v_add_f32 v43, v43, v79
    v_add_f32 v44, v44, v80
    v_add_f32 v45, v45, v81
    v_add_f32 v46, v46, v82
    v_add_f32 v47, v47, v83
    v_cvt_pk_bf16_f32 v16, v40, v41
    v_cvt_pk_bf16_f32 v17, v42, v43
    v_cvt_pk_bf16_f32 v18, v44, v45
    v_cvt_pk_bf16_f32 v19, v46, v47
    buffer_store_dwordx4 v[16:19], v8, s[12:15], s41 offen
    s_waitcnt lgkmcnt(2)
    v_add_f32 v48, v48, v84
    v_add_f32 v49, v49, v85
    v_add_f32 v50, v50, v86
    v_add_f32 v51, v51, v87
    v_add_f32 v52, v52, v88
    v_add_f32 v53, v53, v89
    v_add_f32 v54, v54, v90
    v_add_f32 v55, v55, v91
    v_cvt_pk_bf16_f32 v20, v48, v49
    v_cvt_pk_bf16_f32 v21, v50, v51
    v_cvt_pk_bf16_f32 v22, v52, v53
    v_cvt_pk_bf16_f32 v23, v54, v55
    buffer_store_dwordx4 v[20:23], v9, s[12:15], s41 offen
    s_waitcnt lgkmcnt(0)
    v_add_f32 v56, v56, v92
    v_add_f32 v57, v57, v93
    v_add_f32 v58, v58, v94
    v_add_f32 v59, v59, v95
    v_add_f32 v60, v60, v96
    v_add_f32 v61, v61, v97
    v_add_f32 v62, v62, v98
    v_add_f32 v63, v63, v99
    v_cvt_pk_bf16_f32 v24, v56, v57
    v_cvt_pk_bf16_f32 v25, v58, v59
    v_cvt_pk_bf16_f32 v26, v60, v61
    v_cvt_pk_bf16_f32 v27, v62, v63
    buffer_store_dwordx4 v[24:27], v10, s[12:15], s41 offen
L_end:
    s_endpgm
.section .rodata,"a"
.p2align 6
.amdhsa_kernel parallel_sum__ssm_conv_h3__mixer_s_mlp__prompt_kernel
  .amdhsa_next_free_vgpr 512
  .amdhsa_next_free_sgpr 102
  .amdhsa_accum_offset 256
  .amdhsa_group_segment_fixed_size 0
  .amdhsa_kernarg_size 112
  .amdhsa_user_sgpr_count 2
  .amdhsa_user_sgpr_kernarg_segment_ptr 1
  .amdhsa_system_sgpr_workgroup_id_x 1
.end_amdhsa_kernel
```
